```python
import torch

def _softmax(x, axis=-1):
    return torch.softmax(x, dim=axis)
def _gelu(x):
    return torch.nn.functional.gelu(x, approximate="tanh")
def _silu(x):
    return torch.nn.functional.silu(x)
def _sigmoid(x):
    return torch.sigmoid(x)
def _layernorm(x, axis=-1, eps=1e-5):
    m = x.mean(dim=axis, keepdim=True)
    v = x.var(dim=axis, keepdim=True, unbiased=False)
    return (x - m) / torch.sqrt(v + eps)
def _scatter_add(tgt, idx, src, axis=0):
    return tgt.clone().index_add_(axis, idx, src)
def _segment_sum(src, seg, n):
    out = torch.zeros((n,) + src.shape[1:], dtype=src.dtype)
    return out.index_add_(0, seg, src)
def _pad(x, pw):
    flat = tuple(v for pair in reversed(pw) for v in pair)
    return torch.nn.functional.pad(x, flat)

kernel_name = 'concat_heads__mha_block_cached__gqa_block_cached__near_ridge'

def setup_inputs():

    _w = (lambda a: (lambda t: t.to(torch.bfloat16) if t.is_floating_point() else t)(torch.as_tensor(a)))
    def _A_setup():
        B, Sq, D = 8, 128, 448
        H, Sk, Dh = 16, 512, 256
        return {
            "x": _w((lambda *s: torch.randn(*s, dtype=torch.bfloat16) * 0.8)(B, Sq, D)),
            "k_cache": _w((lambda *s: torch.randn(*s, dtype=torch.bfloat16) * 0.8)(B, H, Sk, Dh)),
            "v_cache": _w((lambda *s: torch.randn(*s, dtype=torch.bfloat16) * 0.05)(B, H, Sk, Dh)),
            "wq": _w((lambda *s: torch.randn(*s, dtype=torch.bfloat16) * 0.8)(D, H * Dh) * (D ** -0.5)),
            "wo": _w((lambda *s: torch.randn(*s, dtype=torch.bfloat16) * 0.05)(H * Dh, D) * ((H * Dh) ** -0.5)),
        }
    _A_in = _A_setup()

    def _B_setup():
        B, Sq, D = 8, 128, 448
        Hq, Hkv, Sk, Dh = 16, 16, 512, 256
        assert Hq % Hkv == 0, (Hq, Hkv)
        return {
            "x": _w((lambda *s: torch.randn(*s, dtype=torch.bfloat16) * 0.8)(B, Sq, D)),
            "k_cache": _w((lambda *s: torch.randn(*s, dtype=torch.bfloat16) * 0.8)(B, Hkv, Sk, Dh)),
            "v_cache": _w((lambda *s: torch.randn(*s, dtype=torch.bfloat16) * 0.05)(B, Hkv, Sk, Dh)),
            "wq": _w((lambda *s: torch.randn(*s, dtype=torch.bfloat16) * 0.8)(D, Hq * Dh) * (D ** -0.5)),
            "wo": _w((lambda *s: torch.randn(*s, dtype=torch.bfloat16) * 0.05)(Hq * Dh, D) * ((Hq * Dh) ** -0.5)),
        }
    _B_in = _B_setup()

    return {
        "A_x": _A_in["x"],
        "A_k_cache": _A_in["k_cache"],
        "A_v_cache": _A_in["v_cache"],
        "A_wq": _A_in["wq"],
        "A_wo": _A_in["wo"],
        "B_x": _B_in["x"],
        "B_k_cache": _B_in["k_cache"],
        "B_v_cache": _B_in["v_cache"],
        "B_wq": _B_in["wq"],
        "B_wo": _B_in["wo"],
    }

def reference(A_x, A_k_cache, A_v_cache, A_wq, A_wo, B_x, B_k_cache, B_v_cache, B_wq, B_wo):
    def _A_ref(x, k_cache, v_cache, wq, wo):
        B, Sq, D = x.shape
        H, Dh = 16, 256
        q = (lambda x, *d: x.permute(*d))((x @ wq).reshape(B, Sq, H, Dh), 0, 2, 1, 3)
        scores = torch.einsum("bhqd,bhkd->bhqk", q, k_cache) * (Dh ** -0.5)
        p = _softmax(scores, axis=-1)
        o = torch.einsum("bhqk,bhkd->bhqd", p, v_cache)
        return (lambda x, *d: x.permute(*d))(o, 0, 2, 1, 3).reshape(B, Sq, H * Dh) @ wo

    def _B_ref(x, k_cache, v_cache, wq, wo):
        B, Sq, D = x.shape
        Hq, Dh = 16, 256
        Hkv = k_cache.shape[1]
        rep = Hq // Hkv
        q = (lambda x, *d: x.permute(*d))((x @ wq).reshape(B, Sq, Hq, Dh), 0, 2, 1, 3)
        k = (lambda x, n, axis: torch.repeat_interleave(x, n, dim=axis))(k_cache, rep, axis=1)
        v = (lambda x, n, axis: torch.repeat_interleave(x, n, dim=axis))(v_cache, rep, axis=1)
        scores = torch.einsum("bhqd,bhkd->bhqk", q, k) * (Dh ** -0.5)
        p = _softmax(scores, axis=-1)
        o = torch.einsum("bhqk,bhkd->bhqd", p, v)
        return (lambda x, *d: x.permute(*d))(o, 0, 2, 1, 3).reshape(B, Sq, Hq * Dh) @ wo

    a = _A_ref(A_x, A_k_cache, A_v_cache, A_wq, A_wo)
    b = _B_ref(B_x, B_k_cache, B_v_cache, B_wq, B_wo)
    return torch.concatenate([a, b], axis=-1)
```

```asm
; @launch kernel=concat_heads__mha_block_cached__gqa_block_cached__near_ridge_kernel grid=(256,1,1) block=(256,1,1) lds=163840
.amdgcn_target "amdgcn-amd-amdhsa--gfx950"
.text
.globl concat_heads__mha_block_cached__gqa_block_cached__near_ridge_kernel
.p2align 12
.p2align 8
.type concat_heads__mha_block_cached__gqa_block_cached__near_ridge_kernel,@function
concat_heads__mha_block_cached__gqa_block_cached__near_ridge_kernel:
    s_cmp_ge_u32 s2, 256
    s_cbranch_scc1 L_k1_done
    s_and_b32 s3, s2, 7
    s_lshr_b32 s7, s3, 2
    s_mul_i32 s60, s7, 40
    s_add_u32 s44, s0, s60
    s_addc_u32 s45, s1, 0
    s_load_dwordx2 s[64:65], s[44:45], 0
    s_load_dwordx4 s[72:75], s[44:45], 24
    s_load_dwordx4 s[68:71], s[44:45], 8
    s_load_dwordx4 s[76:79], s[0:1], 80
    s_load_dwordx2 s[80:81], s[0:1], 96
    v_lshrrev_b32 v1, 6, v0
    v_and_b32 v2, 63, v0
    v_readfirstlane_b32 s4, v1
    s_and_b32 s6, s2, 3
    s_lshl_b32 s6, s6, 1
    s_lshr_b32 s3, s2, 7
    s_add_u32 s6, s6, s3
    s_bfe_u32 s5, s2, 0x40003
    s_mul_i32 s60, s6, 1
    s_mul_i32 s3, s5, 2
    s_add_u32 s60, s60, s3
    s_mul_i32 s3, s60, 37
    s_lshr_b32 s3, s3, 8
    s_mul_i32 s3, s3, 7
    s_sub_u32 s60, s60, s3
    s_lshl_b32 s49, s60, 7
    s_lshl_b32 s50, s60, 19
    v_and_b32 v3, 15, v2
    v_lshrrev_b32 v4, 4, v2
    s_lshl_b32 s48, s4, 12
    v_lshrrev_b32 v5, 3, v2
    v_mul_u32_u24 v5, 896, v5
    s_mul_i32 s3, s4, 28672
    v_and_b32 v6, 7, v2
    v_add_u32 v30, s3, v5
    v_xor_b32 v6, v6, v4
    v_lshl_add_u32 v100, v6, 4, v30
    v_xor_b32 v5, 64, v100
    v_add_u32 v101, 6144, v5
    v_add_u32 v102, 12288, v100
    v_add_u32 v103, 18432, v5
    s_lshl_b32 s3, s4, 17
    s_lshl_b32 s60, s5, 9
    s_add_u32 s3, s3, s60
    v_lshlrev_b32 v6, 1, v4
    v_xor_b32 v6, v6, v3
    v_lshlrev_b32 v6, 4, v6
    v_lshl_add_u32 v6, v4, 13, v6
    v_add_u32 v96, s3, v6
    v_xor_b32 v7, 0x80, v96
    v_add_u32 v97, 31744, v96
    v_add_u32 v98, 63488, v7
    v_add_u32 v99, 95232, v7
    s_mov_b32 s26, 114688
    s_mov_b32 s27, 0x00020000
    s_mov_b32 s18, 3670016
    s_mov_b32 s19, 0x00020000
    s_mov_b32 s10, 262144
    s_mov_b32 s11, 0x00020000
    s_mov_b32 s14, 262144
    s_mov_b32 s15, 0x00020000
    s_mul_i32 s46, s6, 114688
    s_lshl_b32 s47, s6, 4
    s_add_u32 s47, s47, s5
    s_lshl_b32 s47, s47, 18
    s_waitcnt lgkmcnt(0)
    s_add_u32 s24, s64, s46
    s_addc_u32 s25, s65, 0
    s_mov_b32 s16, s72
    s_mov_b32 s17, s73
    s_add_u32 s8, s68, s47
    s_addc_u32 s9, s69, 0
    s_add_u32 s12, s70, s47
    s_addc_u32 s13, s71, 0
    s_add_u32 m0, s48, 131072
    s_nop 0
    buffer_load_dwordx4 v100, s[24:27], s49 offen  lds
    buffer_load_dwordx4 v101, s[24:27], s49 offen offset:1024  lds
    buffer_load_dwordx4 v102, s[24:27], s49 offen offset:2048  lds
    buffer_load_dwordx4 v103, s[24:27], s49 offen offset:3072  lds
    s_add_u32 s49, s49, 128
    s_cmp_eq_u32 s49, 896
    s_cselect_b32 s49, 0, s49
    s_add_u32 m0, s48, 147456
    s_nop 0
    buffer_load_dwordx4 v96, s[16:19], s50 offen  lds
    buffer_load_dwordx4 v97, s[16:19], s50 offen offset:1024  lds
    buffer_load_dwordx4 v98, s[16:19], s50 offen offset:2048  lds
    buffer_load_dwordx4 v99, s[16:19], s50 offen offset:3072  lds
    s_add_u32 s50, s50, 524288
    s_cmp_eq_u32 s50, 3670016
    s_cselect_b32 s50, 0, s50
    s_add_u32 m0, s48, 16384
    s_nop 0
    buffer_load_dwordx4 v100, s[24:27], s49 offen  lds
    buffer_load_dwordx4 v101, s[24:27], s49 offen offset:1024  lds
    buffer_load_dwordx4 v102, s[24:27], s49 offen offset:2048  lds
    buffer_load_dwordx4 v103, s[24:27], s49 offen offset:3072  lds
    s_add_u32 s49, s49, 128
    s_cmp_eq_u32 s49, 896
    s_cselect_b32 s49, 0, s49
    s_add_u32 m0, s48, 32768
    s_nop 0
    buffer_load_dwordx4 v96, s[16:19], s50 offen  lds
    buffer_load_dwordx4 v97, s[16:19], s50 offen offset:1024  lds
    buffer_load_dwordx4 v98, s[16:19], s50 offen offset:2048  lds
    buffer_load_dwordx4 v99, s[16:19], s50 offen offset:3072  lds
    s_add_u32 s50, s50, 524288
    s_cmp_eq_u32 s50, 3670016
    s_cselect_b32 s50, 0, s50
    s_getpc_b64 s[62:63]
L_pc:
    s_lshr_b32 s3, s2, 3
    s_lshl_b32 s3, s3, 12
    v_lshlrev_b32 v5, 4, v0
    v_add_u32 v5, s3, v5
    v_min_u32 v5, L_k1_end-L_pc-8, v5
    global_load_dword a160, v5, s[62:63]
    s_lshl_b32 s3, s7, 3
    s_add_u32 s3, s3, s6
    s_lshl_b32 s3, s3, 22
    s_add_u32 s3, s3, 134217728
    s_add_u32 s28, s80, s3
    s_addc_u32 s29, s81, 0
    s_lshl_b32 s3, s4, 4
    s_add_u32 s3, s3, s5
    s_lshl_b32 s47, s3, 16
    s_add_u32 s64, s28, s47
    s_addc_u32 s65, s29, 0
    v_bfe_u32 v6, v2, 2, 2
    v_and_b32 v7, 3, v2
    v_bfe_u32 v5, v2, 2, 3
    v_lshl_add_u32 v8, v4, 3, v6
    v_lshlrev_b32 v9, 5, v5
    v_lshl_add_u32 v9, v7, 3, v9
    v_lshl_add_u32 v9, v8, 8, v9
    v_lshl_add_u32 v8, v8, 8, v9
    v_add_u32 v14, 0x10000, v8
    v_add_u32 v80, 131072, v9
    v_xor_b32 v81, 32, v80
    v_xor_b32 v82, 64, v80
    v_xor_b32 v83, 96, v80
    v_xor_b32 v84, 128, v80
    v_xor_b32 v85, 160, v80
    v_xor_b32 v86, 192, v80
    v_xor_b32 v87, 224, v80
    v_add_u32 v64, 0, v9
    v_xor_b32 v65, 32, v64
    v_xor_b32 v66, 64, v64
    v_xor_b32 v67, 96, v64
    v_xor_b32 v68, 128, v64
    v_xor_b32 v69, 160, v64
    v_xor_b32 v70, 192, v64
    v_xor_b32 v71, 224, v64
    v_add_u32 v72, 65536, v9
    v_xor_b32 v73, 32, v72
    v_xor_b32 v74, 64, v72
    v_xor_b32 v75, 96, v72
    v_xor_b32 v76, 128, v72
    v_xor_b32 v77, 160, v72
    v_xor_b32 v78, 192, v72
    v_xor_b32 v79, 224, v72
    v_lshrrev_b32 v5, 1, v3
    v_xor_b32 v5, v5, v4
    v_lshlrev_b32 v5, 4, v5
    v_lshl_add_u32 v5, v3, 7, v5
    v_add_u32 v88, s48, v5
    v_xor_b32 v89, 64, v88
    v_add_u32 v92, 131072, v88
    v_add_u32 v93, 131072, v89
    v_add_u32 v90, 65536, v88
    v_add_u32 v91, 65536, v89
    s_mov_b32 s22, 229376
    s_mov_b32 s23, 0x00020000
    s_mov_b32 s30, 4194304
    s_mov_b32 s31, 0x00020000
    s_mov_b32 s34, 4194304
    s_mov_b32 s35, 0x00020000
    s_mov_b32 s38, 256
    s_mov_b32 s39, 0x00020000
    s_mov_b32 s42, 229376
    s_mov_b32 s43, 0x00020000
    s_cmp_eq_u32 s6, 7
    s_cselect_b32 s3, 0, s6
    s_lshl_b32 s51, s3, 7
    s_lshl_b32 s52, s3, 12
    s_lshr_b32 s3, s3, 1
    s_lshl_b32 s3, s3, 13
    s_add_u32 s56, s52, s3
    s_mul_i32 s3, s5, 229376
    s_add_u32 s20, s74, s3
    s_addc_u32 s21, s75, 0
    s_lshl_b32 s46, s7, 3
    s_add_u32 s46, s46, s6
    s_mov_b32 s32, s28
    s_mov_b32 s33, s29
    s_mov_b32 s36, s78
    s_mov_b32 s37, s79
    s_mul_i32 s3, s6, 229376
    s_add_u32 s40, s76, s3
    s_addc_u32 s41, s77, 0
    s_mov_b32 s54, 0x3db8aa3b
    s_mov_b32 s55, 0x49800000
    s_mov_b32 s98, 0x30800000
    s_mov_b32 s57, 0x8000
    v_lshrrev_b32 v5, 5, v2
    v_and_b32 v9, 31, v2
    v_lshlrev_b32 v8, 9, v5
    v_add_u32 v8, s48, v8
    s_lshl_b32 s3, s4, 2
    v_xor_b32 v1, v9, v5
    v_xor_b32 v1, s3, v1
    v_lshl_add_u32 v26, v1, 4, v8
    v_xor_b32 v27, 32, v26
    s_and_b32 s3, s4, 1
    s_lshl_b32 s3, s3, 3
    v_lshlrev_b32 v5, 1, v5
    v_xor_b32 v1, v9, v5
    v_xor_b32 v1, s3, v1
    v_lshl_add_u32 v28, v1, 4, v8
    v_xor_b32 v29, 64, v28
    v_lshl_add_u32 v5, v3, 2, v4
    v_lshl_add_u32 v34, v5, 4, s47
    v_xor_b32 v15, 32, v14
    v_xor_b32 v16, 64, v14
    v_xor_b32 v17, 96, v14
    v_xor_b32 v18, 128, v14
    v_xor_b32 v19, 160, v14
    v_xor_b32 v20, 192, v14
    v_xor_b32 v21, 224, v14
    s_lshl_b32 s3, s4, 8
    s_add_u32 s3, s3, s5
    s_add_u32 s3, s3, 53248
    v_lshl_add_u32 v5, v7, 6, s3
    v_lshrrev_b32 v8, 2, v2
    v_lshl_add_u32 v45, v8, 16, v5
    v_lshrrev_b32 v8, 5, v2
    v_lshl_add_u32 v45, v8, 22, v45
    s_lshl_b32 s78, s5, 6
    s_add_u32 s78, s78, 53248
    v_mov_b32 v46, s78
    v_and_b32 v62, 7, v2
    s_lshl_b32 s3, s4, 4
    s_add_u32 s3, s3, s5
    s_add_u32 s3, s3, 57088
    v_lshl_add_u32 v63, v2, 22, s3
    v_lshlrev_b32 v5, 6, v3
    v_lshl_add_u32 v5, v4, 16, v5
    s_or_b32 s3, s5, s4
    s_cmp_eq_u32 s3, 0
    s_cselect_b32 s45, 0, 0x400000
    s_add_u32 s3, s45, 53248
    v_mov_b32 v35, 0
    v_mov_b32 v36, 0
    v_add_u32 v5, s3, v5
    v_mov_b32 v112, 0
    v_mov_b32 v113, 0
    v_mov_b32 v114, 0
    v_mov_b32 v115, 0
    s_mov_b32 s3, 0
    buffer_store_dwordx4 v[112:115], v5, s[32:35], s3 offen sc1
    s_mov_b32 s3, 262144
    buffer_store_dwordx4 v[112:115], v5, s[32:35], s3 offen sc1
    s_lshl_b32 s44, s46, 4
    s_add_u32 s45, s45, s44
    s_getreg_b32 s100, hwreg(HW_REG_XCC_ID, 0, 4)
    s_mul_i32 s101, s100, s100
    s_lshl_b32 s101, s101, 8
    s_add_u32 s101, s101, s100
    s_lshl_b32 s101, s101, 8
    s_add_u32 s101, s101, 1
    v_mov_b32 v5, s101
    v_lshl_add_u32 v8, v0, 12, s44
    buffer_atomic_add v5, v8, s[36:39], 0 offen offset:4 sc1
    s_lshl_b32 s101, s101, 4
    v_lshl_add_u32 v47, v2, 12, s45
    v_mov_b32 v48, s44
    v_mov_b32 v50, 1
    v_lshrrev_b32 v5, 1, v4
    v_and_b32 v8, 1, v4
    v_lshl_add_u32 v5, v8, 1, v5
    v_xor_b32 v5, v5, v3
    v_lshlrev_b32 v5, 4, v5
    v_lshl_add_u32 v8, v6, 3, v7
    v_lshl_add_u32 v10, v8, 9, v5
    v_xor_b32 v11, 64, v10
    v_xor_b32 v12, 128, v10
    v_xor_b32 v13, 192, v10
    v_lshrrev_b32 v5, 2, v2
    v_lshlrev_b32 v5, 7, v5
    v_bfe_u32 v8, v2, 3, 2
    v_lshl_add_u32 v5, v8, 5, v5
    v_lshl_add_u32 v5, v7, 3, v5
    v_add_u32 v22, 0x20000, v5
    v_xor_b32 v23, 32, v22
    v_xor_b32 v24, 64, v22
    v_xor_b32 v25, 96, v22
    v_and_b32 v8, 7, v2
    v_lshlrev_b32 v9, 1, v4
    v_xor_b32 v8, v8, v9
    v_lshl_add_u32 v30, v8, 4, v30
    v_add_u32 v31, 6144, v30
    v_add_u32 v32, 12288, v30
    v_add_u32 v33, 18432, v30
    v_mov_b32 v112, 0
    v_mov_b32 v113, 0
    v_mov_b32 v114, 0
    v_mov_b32 v115, 0
    v_mov_b32 v116, 0
    v_mov_b32 v117, 0
    v_mov_b32 v118, 0
    v_mov_b32 v119, 0
    s_lshr_b32 s44, s5, 2
    s_mul_i32 s3, s44, 1048576
    s_and_b32 s45, s5, 3
    s_lshl_b32 s45, s45, 10
    s_add_u32 s3, s3, s45
    s_lshl_b32 s45, s4, 8
    s_add_u32 s3, s3, s45
    v_mul_u32_u24 v5, 65536, v4
    v_lshl_add_u32 v5, v3, 4, v5
    v_add_u32 v56, s3, v5
    s_lshl_b32 s3, s44, 5
    s_and_b32 s45, s5, 1
    s_lshl_b32 s45, s45, 4
    s_add_u32 s3, s3, s45
    s_lshl_b32 s45, s4, 2
    s_add_u32 s3, s3, s45
    s_mul_i32 s3, s3, 1792
    s_mul_i32 s45, s7, 896
    s_add_u32 s3, s3, s45
    s_and_b32 s45, s5, 2
    s_lshl_b32 s45, s45, 5
    s_add_u32 s3, s3, s45
    v_mul_u32_u24 v5, 1792, v6
    v_lshl_add_u32 v5, v7, 3, v5
    v_and_b32 v8, 1, v4
    v_lshl_add_u32 v5, v8, 5, v5
    v_lshrrev_b32 v8, 1, v4
    v_lshl_add_u32 v5, v8, 24, v5
    v_add_u32 v57, s3, v5
    v_and_b32 v5, 1, v2
    v_lshlrev_b32 v5, 4, v5
    v_mov_b32 v8, 0x3f80
    v_lshlrev_b32 v5, v5, v8
    v_bfe_u32 v8, v2, 1, 2
    v_cmp_eq_u32 vcc, 0, v8
    s_nop 0
    s_nop 0
    v_cndmask_b32 v52, 0, v5, vcc
    v_cmp_eq_u32 vcc, 1, v8
    s_nop 0
    s_nop 0
    v_cndmask_b32 v53, 0, v5, vcc
    v_cmp_eq_u32 vcc, 2, v8
    s_nop 0
    s_nop 0
    v_cndmask_b32 v54, 0, v5, vcc
    v_cmp_eq_u32 vcc, 3, v8
    s_nop 0
    s_nop 0
    v_cndmask_b32 v55, 0, v5, vcc
    v_and_b32 v5, 1, v2
    v_bfe_u32 v8, v2, 1, 2
    v_lshrrev_b32 v9, 3, v2
    v_lshlrev_b32 v5, 13, v5
    v_lshl_add_u32 v5, v8, 9, v5
    v_lshl_add_u32 v5, v9, 22, v5
    s_add_u32 s3, s47, 55296
    v_add_u32 v5, s3, v5
    buffer_store_dword v35, v5, s[28:31], 0 offen sc1
    s_mov_b32 s66, 0
    s_mov_b32 s67, 0
    s_mov_b32 s79, 0
    s_add_u32 m0, s48, 65536
    s_nop 0
    buffer_load_dwordx4 v100, s[24:27], s49 offen  lds
    buffer_load_dwordx4 v101, s[24:27], s49 offen offset:1024  lds
    buffer_load_dwordx4 v102, s[24:27], s49 offen offset:2048  lds
    buffer_load_dwordx4 v103, s[24:27], s49 offen offset:3072  lds
    s_add_u32 s49, s49, 128
    s_cmp_eq_u32 s49, 896
    s_cselect_b32 s49, 0, s49
    s_waitcnt vmcnt(17)
    s_barrier
    ds_read_b128 a[0:3], v92 offset:0
    ds_read_b128 a[4:7], v92 offset:2048
    ds_read_b64_tr_b16 a[224:225], v80 offset:16384
    ds_read_b64_tr_b16 a[226:227], v80 offset:17408
    ds_read_b128 a[8:11], v93 offset:0
    ds_read_b128 a[12:15], v93 offset:2048
    ds_read_b64_tr_b16 a[228:229], v80 offset:24576
    ds_read_b64_tr_b16 a[230:231], v80 offset:25600
    ds_read_b64_tr_b16 a[232:233], v81 offset:16384
    ds_read_b64_tr_b16 a[234:235], v81 offset:17408
    ds_read_b64_tr_b16 a[236:237], v81 offset:24576
    ds_read_b64_tr_b16 a[238:239], v81 offset:25600
    ds_read_b64_tr_b16 a[240:241], v82 offset:16384
    ds_read_b64_tr_b16 a[242:243], v82 offset:17408
    ds_read_b64_tr_b16 a[244:245], v82 offset:24576
    ds_read_b64_tr_b16 a[246:247], v82 offset:25600
    ds_read_b64_tr_b16 a[248:249], v83 offset:16384
    ds_read_b64_tr_b16 a[250:251], v83 offset:17408
    ds_read_b64_tr_b16 a[252:253], v83 offset:24576
    ds_read_b64_tr_b16 a[254:255], v83 offset:25600
    ds_read_b64_tr_b16 a[112:113], v84 offset:16384
    ds_read_b64_tr_b16 a[114:115], v84 offset:17408
    ds_read_b64_tr_b16 a[116:117], v84 offset:24576
    ds_read_b64_tr_b16 a[118:119], v84 offset:25600
    s_waitcnt lgkmcnt(12)
    v_mfma_f32_16x16x32_bf16 v[128:131], a[224:227], a[0:3], 0
    ds_read_b64_tr_b16 a[120:121], v85 offset:16384
    ds_read_b64_tr_b16 a[122:123], v85 offset:17408
    v_mfma_f32_16x16x32_bf16 v[136:139], a[224:227], a[4:7], 0
    s_add_u32 m0, s48, 49152
    s_nop 0
    buffer_load_dwordx4 v96, s[16:19], s50 offen  lds
    v_mfma_f32_16x16x32_bf16 v[128:131], a[228:231], a[8:11], v[128:131]
    ds_read_b64_tr_b16 a[124:125], v85 offset:24576
    ds_read_b64_tr_b16 a[126:127], v85 offset:25600
    v_mfma_f32_16x16x32_bf16 v[136:139], a[228:231], a[12:15], v[136:139]
    buffer_load_dwordx4 v97, s[16:19], s50 offen offset:1024  lds
    v_mfma_f32_16x16x32_bf16 v[132:135], a[232:235], a[0:3], 0
    ds_read_b64_tr_b16 a[128:129], v86 offset:16384
    ds_read_b64_tr_b16 a[130:131], v86 offset:17408
    v_mfma_f32_16x16x32_bf16 v[140:143], a[232:235], a[4:7], 0
    buffer_load_dwordx4 v98, s[16:19], s50 offen offset:2048  lds
    v_mfma_f32_16x16x32_bf16 v[132:135], a[236:239], a[8:11], v[132:135]
    buffer_load_dwordx4 v99, s[16:19], s50 offen offset:3072  lds
    s_add_u32 s50, s50, 524288
    s_cmp_eq_u32 s50, 3670016
    s_cselect_b32 s50, 0, s50
    v_mfma_f32_16x16x32_bf16 v[140:143], a[236:239], a[12:15], v[140:143]
    ds_read_b64_tr_b16 a[132:133], v86 offset:24576
    ds_read_b64_tr_b16 a[134:135], v86 offset:25600
    s_waitcnt lgkmcnt(12)
    v_mfma_f32_16x16x32_bf16 v[144:147], a[240:243], a[0:3], 0
    ds_read_b64_tr_b16 a[136:137], v87 offset:16384
    ds_read_b64_tr_b16 a[138:139], v87 offset:17408
    v_mfma_f32_16x16x32_bf16 v[152:155], a[240:243], a[4:7], 0
    s_add_u32 m0, s48, 81920
    s_nop 0
    buffer_load_dwordx4 v100, s[24:27], s49 offen  lds
    v_mfma_f32_16x16x32_bf16 v[144:147], a[244:247], a[8:11], v[144:147]
    ds_read_b64_tr_b16 a[140:141], v87 offset:24576
    ds_read_b64_tr_b16 a[142:143], v87 offset:25600
    v_mfma_f32_16x16x32_bf16 v[152:155], a[244:247], a[12:15], v[152:155]
    buffer_load_dwordx4 v101, s[24:27], s49 offen offset:1024  lds
    v_mfma_f32_16x16x32_bf16 v[148:151], a[248:251], a[0:3], 0
    s_waitcnt vmcnt(15)
    s_barrier
    ds_read_b128 a[16:19], v88 offset:16384
    ds_read_b128 a[20:23], v88 offset:18432
    v_mfma_f32_16x16x32_bf16 v[156:159], a[248:251], a[4:7], 0
    ds_read_b64_tr_b16 a[224:225], v64 offset:32768
    ds_read_b64_tr_b16 a[226:227], v64 offset:33792
    buffer_load_dwordx4 v102, s[24:27], s49 offen offset:2048  lds
    v_mfma_f32_16x16x32_bf16 v[148:151], a[252:255], a[8:11], v[148:151]
    ds_read_b128 a[24:27], v89 offset:16384
    ds_read_b128 a[28:31], v89 offset:18432
    ds_read_b64_tr_b16 a[228:229], v64 offset:40960
    ds_read_b64_tr_b16 a[230:231], v64 offset:41984
    v_mfma_f32_16x16x32_bf16 v[156:159], a[252:255], a[12:15], v[156:159]
    buffer_load_dwordx4 v103, s[24:27], s49 offen offset:3072  lds
    s_add_u32 s49, s49, 128
    s_cmp_eq_u32 s49, 896
    s_cselect_b32 s49, 0, s49
    s_waitcnt lgkmcnt(15)
    v_mfma_f32_16x16x32_bf16 v[160:163], a[112:115], a[0:3], 0
    ds_read_b64_tr_b16 a[232:233], v65 offset:32768
    ds_read_b64_tr_b16 a[234:235], v65 offset:33792
    v_mfma_f32_16x16x32_bf16 v[168:171], a[112:115], a[4:7], 0
    s_add_u32 m0, s48, 114688
    s_nop 0
    buffer_load_dwordx4 v96, s[16:19], s50 offen  lds
    v_mfma_f32_16x16x32_bf16 v[160:163], a[116:119], a[8:11], v[160:163]
    ds_read_b64_tr_b16 a[236:237], v65 offset:40960
    ds_read_b64_tr_b16 a[238:239], v65 offset:41984
    buffer_load_dwordx4 v97, s[16:19], s50 offen offset:1024  lds
    v_mfma_f32_16x16x32_bf16 v[168:171], a[116:119], a[12:15], v[168:171]
    s_mov_b64 exec, 0
    s_cmp_eq_u32 s4, 1
    s_cbranch_scc1 L_pg2
    s_cmp_eq_u32 s4, 2
    s_cbranch_scc1 L_pg3
    s_cmp_eq_u32 s4, 3
    s_cbranch_scc1 L_pg4
    s_branch L_pg1
L_pgr1:
    s_mov_b64 exec, -1
    s_nop 3
    v_mfma_f32_16x16x32_bf16 v[164:167], a[120:123], a[0:3], 0
    ds_read_b64_tr_b16 a[240:241], v66 offset:32768
    ds_read_b64_tr_b16 a[242:243], v66 offset:33792
    v_mfma_f32_16x16x32_bf16 v[172:175], a[120:123], a[4:7], 0
    buffer_load_dwordx4 v98, s[16:19], s50 offen offset:2048  lds
    v_mfma_f32_16x16x32_bf16 v[164:167], a[124:127], a[8:11], v[164:167]
    buffer_load_dwordx4 v99, s[16:19], s50 offen offset:3072  lds
    s_add_u32 s50, s50, 524288
    s_cmp_eq_u32 s50, 3670016
    s_cselect_b32 s50, 0, s50
    v_mfma_f32_16x16x32_bf16 v[172:175], a[124:127], a[12:15], v[172:175]
    ds_read_b64_tr_b16 a[244:245], v66 offset:40960
    ds_read_b64_tr_b16 a[246:247], v66 offset:41984
    s_waitcnt lgkmcnt(15)
    v_mfma_f32_16x16x32_bf16 v[176:179], a[128:131], a[0:3], 0
    ds_read_b64_tr_b16 a[248:249], v67 offset:32768
    ds_read_b64_tr_b16 a[250:251], v67 offset:33792
    v_mfma_f32_16x16x32_bf16 v[184:187], a[128:131], a[4:7], 0
    s_add_u32 m0, s48, 98304
    s_nop 0
    buffer_load_dwordx4 v100, s[24:27], s49 offen  lds
    v_mfma_f32_16x16x32_bf16 v[176:179], a[132:135], a[8:11], v[176:179]
    ds_read_b64_tr_b16 a[252:253], v67 offset:40960
    ds_read_b64_tr_b16 a[254:255], v67 offset:41984
    v_mfma_f32_16x16x32_bf16 v[184:187], a[132:135], a[12:15], v[184:187]
    buffer_load_dwordx4 v101, s[24:27], s49 offen offset:1024  lds
    v_mfma_f32_16x16x32_bf16 v[180:183], a[136:139], a[0:3], 0
    ds_read_b64_tr_b16 a[112:113], v68 offset:32768
    ds_read_b64_tr_b16 a[114:115], v68 offset:33792
    v_mfma_f32_16x16x32_bf16 v[188:191], a[136:139], a[4:7], 0
    buffer_load_dwordx4 v102, s[24:27], s49 offen offset:2048  lds
    v_mfma_f32_16x16x32_bf16 v[180:183], a[140:143], a[8:11], v[180:183]
    buffer_load_dwordx4 v103, s[24:27], s49 offen offset:3072  lds
    s_add_u32 s49, s49, 128
    s_cmp_eq_u32 s49, 896
    s_cselect_b32 s49, 0, s49
    v_mfma_f32_16x16x32_bf16 v[188:191], a[140:143], a[12:15], v[188:191]
    ds_read_b64_tr_b16 a[116:117], v68 offset:40960
    ds_read_b64_tr_b16 a[118:119], v68 offset:41984
    s_waitcnt lgkmcnt(12)
    v_mfma_f32_16x16x32_bf16 v[128:131], a[224:227], a[16:19], v[128:131]
    ds_read_b64_tr_b16 a[120:121], v69 offset:32768
    ds_read_b64_tr_b16 a[122:123], v69 offset:33792
    v_mfma_f32_16x16x32_bf16 v[136:139], a[224:227], a[20:23], v[136:139]
    s_add_u32 m0, s48, 0
    s_nop 0
    buffer_load_dwordx4 v96, s[16:19], s50 offen  lds
    v_mfma_f32_16x16x32_bf16 v[128:131], a[228:231], a[24:27], v[128:131]
    ds_read_b64_tr_b16 a[124:125], v69 offset:40960
    ds_read_b64_tr_b16 a[126:127], v69 offset:41984
    v_mfma_f32_16x16x32_bf16 v[136:139], a[228:231], a[28:31], v[136:139]
    buffer_load_dwordx4 v97, s[16:19], s50 offen offset:1024  lds
    v_mfma_f32_16x16x32_bf16 v[132:135], a[232:235], a[16:19], v[132:135]
    ds_read_b64_tr_b16 a[128:129], v70 offset:32768
    ds_read_b64_tr_b16 a[130:131], v70 offset:33792
    v_mfma_f32_16x16x32_bf16 v[140:143], a[232:235], a[20:23], v[140:143]
    buffer_load_dwordx4 v98, s[16:19], s50 offen offset:2048  lds
    v_mfma_f32_16x16x32_bf16 v[132:135], a[236:239], a[24:27], v[132:135]
    buffer_load_dwordx4 v99, s[16:19], s50 offen offset:3072  lds
    s_add_u32 s50, s50, 524288
    s_cmp_eq_u32 s50, 3670016
    s_cselect_b32 s50, 0, s50
    v_mfma_f32_16x16x32_bf16 v[140:143], a[236:239], a[28:31], v[140:143]
    ds_read_b64_tr_b16 a[132:133], v70 offset:40960
    ds_read_b64_tr_b16 a[134:135], v70 offset:41984
    s_waitcnt lgkmcnt(12)
    v_mfma_f32_16x16x32_bf16 v[144:147], a[240:243], a[16:19], v[144:147]
    ds_read_b64_tr_b16 a[136:137], v71 offset:32768
    ds_read_b64_tr_b16 a[138:139], v71 offset:33792
    v_mfma_f32_16x16x32_bf16 v[152:155], a[240:243], a[20:23], v[152:155]
    s_add_u32 m0, s48, 131072
    s_nop 0
    buffer_load_dwordx4 v100, s[24:27], s49 offen  lds
    v_mfma_f32_16x16x32_bf16 v[144:147], a[244:247], a[24:27], v[144:147]
    ds_read_b64_tr_b16 a[140:141], v71 offset:40960
    ds_read_b64_tr_b16 a[142:143], v71 offset:41984
    v_mfma_f32_16x16x32_bf16 v[152:155], a[244:247], a[28:31], v[152:155]
    buffer_load_dwordx4 v101, s[24:27], s49 offen offset:1024  lds
    v_mfma_f32_16x16x32_bf16 v[148:151], a[248:251], a[16:19], v[148:151]
    s_waitcnt vmcnt(18)
    s_barrier
    ds_read_b128 a[32:35], v90 offset:0
    ds_read_b128 a[36:39], v90 offset:2048
    v_mfma_f32_16x16x32_bf16 v[156:159], a[248:251], a[20:23], v[156:159]
    ds_read_b64_tr_b16 a[224:225], v64 offset:49152
    ds_read_b64_tr_b16 a[226:227], v64 offset:50176
    buffer_load_dwordx4 v102, s[24:27], s49 offen offset:2048  lds
    v_mfma_f32_16x16x32_bf16 v[148:151], a[252:255], a[24:27], v[148:151]
    ds_read_b128 a[40:43], v91 offset:0
    ds_read_b128 a[44:47], v91 offset:2048
    ds_read_b64_tr_b16 a[228:229], v64 offset:57344
    s_cmp_lg_u32 s4, 0
    s_cbranch_scc1 L_npr0_0
    s_mov_b64 s[66:67], -1
    s_load_dword s66, s[64:65], 55296
    s_load_dword s67, s[64:65], 63488
L_npr0_0:
    v_mfma_f32_16x16x32_bf16 v[156:159], a[252:255], a[28:31], v[156:159]
    ds_read_b64_tr_b16 a[230:231], v64 offset:58368
    buffer_load_dwordx4 v103, s[24:27], s49 offen offset:3072  lds
    s_add_u32 s49, s49, 128
    s_cmp_eq_u32 s49, 896
    s_cselect_b32 s49, 0, s49
    s_waitcnt lgkmcnt(15)
    v_mfma_f32_16x16x32_bf16 v[160:163], a[112:115], a[16:19], v[160:163]
    ds_read_b64_tr_b16 a[232:233], v65 offset:49152
    ds_read_b64_tr_b16 a[234:235], v65 offset:50176
    v_mfma_f32_16x16x32_bf16 v[168:171], a[112:115], a[20:23], v[168:171]
    s_add_u32 m0, s48, 16384
    s_nop 0
    buffer_load_dwordx4 v96, s[16:19], s50 offen  lds
    v_mfma_f32_16x16x32_bf16 v[160:163], a[116:119], a[24:27], v[160:163]
    ds_read_b64_tr_b16 a[236:237], v65 offset:57344
    ds_read_b64_tr_b16 a[238:239], v65 offset:58368
    v_mfma_f32_16x16x32_bf16 v[168:171], a[116:119], a[28:31], v[168:171]
    buffer_load_dwordx4 v97, s[16:19], s50 offen offset:1024  lds
    v_mfma_f32_16x16x32_bf16 v[164:167], a[120:123], a[16:19], v[164:167]
    ds_read_b64_tr_b16 a[240:241], v66 offset:49152
    ds_read_b64_tr_b16 a[242:243], v66 offset:50176
    v_mfma_f32_16x16x32_bf16 v[172:175], a[120:123], a[20:23], v[172:175]
    buffer_load_dwordx4 v98, s[16:19], s50 offen offset:2048  lds
    v_mfma_f32_16x16x32_bf16 v[164:167], a[124:127], a[24:27], v[164:167]
    ds_read_b64_tr_b16 a[244:245], v66 offset:57344
    ds_read_b64_tr_b16 a[246:247], v66 offset:58368
    s_cmp_lg_u32 s66, s67
    s_subb_u32 s79, s79, 0
    v_mfma_f32_16x16x32_bf16 v[172:175], a[124:127], a[28:31], v[172:175]
    buffer_load_dwordx4 v99, s[16:19], s50 offen offset:3072  lds
    s_add_u32 s50, s50, 524288
    s_cmp_eq_u32 s50, 3670016
    s_cselect_b32 s50, 0, s50
    s_waitcnt lgkmcnt(15)
    v_mfma_f32_16x16x32_bf16 v[176:179], a[128:131], a[16:19], v[176:179]
    ds_read_b64_tr_b16 a[248:249], v67 offset:49152
    ds_read_b64_tr_b16 a[250:251], v67 offset:50176
    v_mfma_f32_16x16x32_bf16 v[184:187], a[128:131], a[20:23], v[184:187]
    s_add_u32 m0, s48, 147456
    s_nop 0
    buffer_load_dwordx4 v100, s[24:27], s49 offen  lds
    v_mfma_f32_16x16x32_bf16 v[176:179], a[132:135], a[24:27], v[176:179]
    ds_read_b64_tr_b16 a[252:253], v67 offset:57344
    ds_read_b64_tr_b16 a[254:255], v67 offset:58368
    v_mfma_f32_16x16x32_bf16 v[184:187], a[132:135], a[28:31], v[184:187]
    s_cmp_lg_u32 s66, s67
    s_subb_u32 s79, s79, 0
    buffer_load_dwordx4 v101, s[24:27], s49 offen offset:1024  lds
    v_mfma_f32_16x16x32_bf16 v[180:183], a[136:139], a[16:19], v[180:183]
    ds_read_b64_tr_b16 a[112:113], v68 offset:49152
    ds_read_b64_tr_b16 a[114:115], v68 offset:50176
    v_mfma_f32_16x16x32_bf16 v[188:191], a[136:139], a[20:23], v[188:191]
    buffer_load_dwordx4 v102, s[24:27], s49 offen offset:2048  lds
    v_mfma_f32_16x16x32_bf16 v[180:183], a[140:143], a[24:27], v[180:183]
    ds_read_b64_tr_b16 a[116:117], v68 offset:57344
    ds_read_b64_tr_b16 a[118:119], v68 offset:58368
    s_cmp_lg_u32 s4, 1
    s_cbranch_scc1 L_npr0_1
L_pg1:
    s_cbranch_execz L_pgr1
    s_mov_b64 s[66:67], -1
    s_load_dword s66, s[64:65], 55296
    s_load_dword s67, s[64:65], 63488
L_npr0_1:
    v_mfma_f32_16x16x32_bf16 v[188:191], a[140:143], a[28:31], v[188:191]
    s_cmp_lg_u32 s66, s67
    s_subb_u32 s79, s79, 0
    buffer_load_dwordx4 v103, s[24:27], s49 offen offset:3072  lds
    s_waitcnt lgkmcnt(12)
    v_mfma_f32_16x16x32_bf16 v[128:131], a[224:227], a[32:35], v[128:131]
    ds_read_b64_tr_b16 a[120:121], v69 offset:49152
    v_mfma_f32_16x16x32_bf16 v[136:139], a[224:227], a[36:39], v[136:139]
    ds_read_b64_tr_b16 a[122:123], v69 offset:50176
    v_mfma_f32_16x16x32_bf16 v[128:131], a[228:231], a[40:43], v[128:131]
    ds_read_b64_tr_b16 a[124:125], v69 offset:57344
    ds_read_b64_tr_b16 a[126:127], v69 offset:58368
    v_mfma_f32_16x16x32_bf16 v[136:139], a[228:231], a[44:47], v[136:139]
    s_cmp_lg_u32 s66, s67
    s_subb_u32 s79, s79, 0
    v_mfma_f32_16x16x32_bf16 v[132:135], a[232:235], a[32:35], v[132:135]
    ds_read_b64_tr_b16 a[128:129], v70 offset:49152
    ds_read_b64_tr_b16 a[130:131], v70 offset:50176
    v_mfma_f32_16x16x32_bf16 v[140:143], a[232:235], a[36:39], v[140:143]
    s_add_u32 m0, s48, 65536
    s_nop 0
    buffer_load_dwordx4 v96, s[16:19], s50 offen  lds
    v_mfma_f32_16x16x32_bf16 v[132:135], a[236:239], a[40:43], v[132:135]
    ds_read_b64_tr_b16 a[132:133], v70 offset:57344
    ds_read_b64_tr_b16 a[134:135], v70 offset:58368
    buffer_load_dwordx4 v97, s[16:19], s50 offen offset:1024  lds
    v_mfma_f32_16x16x32_bf16 v[140:143], a[236:239], a[44:47], v[140:143]
    s_cmp_lg_u32 s66, s67
    s_subb_u32 s79, s79, 0
    s_waitcnt lgkmcnt(12)
    v_mfma_f32_16x16x32_bf16 v[144:147], a[240:243], a[32:35], v[144:147]
    ds_read_b64_tr_b16 a[136:137], v71 offset:49152
    ds_read_b64_tr_b16 a[138:139], v71 offset:50176
    v_mfma_f32_16x16x32_bf16 v[152:155], a[240:243], a[36:39], v[152:155]
    buffer_load_dwordx4 v98, s[16:19], s50 offen offset:2048  lds
    v_mfma_f32_16x16x32_bf16 v[144:147], a[244:247], a[40:43], v[144:147]
    ds_read_b64_tr_b16 a[140:141], v71 offset:57344
    ds_read_b64_tr_b16 a[142:143], v71 offset:58368
    s_cmp_lg_u32 s66, s67
    s_subb_u32 s79, s79, 0
    v_mfma_f32_16x16x32_bf16 v[152:155], a[244:247], a[44:47], v[152:155]
    buffer_load_dwordx4 v99, s[16:19], s50 offen offset:3072  lds
    s_add_u32 s50, s50, 524288
    s_cmp_eq_u32 s50, 3670016
    s_cselect_b32 s50, 0, s50
    v_mfma_f32_16x16x32_bf16 v[148:151], a[248:251], a[32:35], v[148:151]
    s_waitcnt vmcnt(24)
    s_barrier
    ds_read_b128 a[48:51], v90 offset:16384
    ds_read_b128 a[52:55], v90 offset:18432
    ds_read_b64_tr_b16 a[224:225], v72 offset:49152
    v_mfma_f32_16x16x32_bf16 v[156:159], a[248:251], a[36:39], v[156:159]
    ds_read_b64_tr_b16 a[226:227], v72 offset:50176
    s_add_u32 m0, s48, 32768
    s_add_u32 s16, s16, 256
    s_addc_u32 s17, s17, 0
    buffer_load_dwordx4 v96, s[16:19], s50 offen  lds
    v_mfma_f32_16x16x32_bf16 v[148:151], a[252:255], a[40:43], v[148:151]
    ds_read_b128 a[56:59], v91 offset:16384
    ds_read_b128 a[60:63], v91 offset:18432
    ds_read_b64_tr_b16 a[228:229], v72 offset:57344
    ds_read_b64_tr_b16 a[230:231], v72 offset:58368
    buffer_load_dwordx4 v97, s[16:19], s50 offen offset:1024  lds
    v_mfma_f32_16x16x32_bf16 v[156:159], a[252:255], a[44:47], v[156:159]
    s_cmp_lg_u32 s4, 2
    s_cbranch_scc1 L_npr0_2
    s_mov_b64 s[66:67], -1
    s_load_dword s66, s[64:65], 55296
    s_load_dword s67, s[64:65], 63488
L_npr0_2:
    s_cmp_lg_u32 s66, s67
    s_subb_u32 s79, s79, 0
    s_waitcnt lgkmcnt(15)
    v_mfma_f32_16x16x32_bf16 v[160:163], a[112:115], a[32:35], v[160:163]
    ds_read_b64_tr_b16 a[232:233], v73 offset:49152
    ds_read_b64_tr_b16 a[234:235], v73 offset:50176
    v_mfma_f32_16x16x32_bf16 v[168:171], a[112:115], a[36:39], v[168:171]
    buffer_load_dwordx4 v98, s[16:19], s50 offen offset:2048  lds
    v_mfma_f32_16x16x32_bf16 v[160:163], a[116:119], a[40:43], v[160:163]
    ds_read_b64_tr_b16 a[236:237], v73 offset:57344
    ds_read_b64_tr_b16 a[238:239], v73 offset:58368
    s_cmp_lg_u32 s66, s67
    s_subb_u32 s79, s79, 0
    v_mfma_f32_16x16x32_bf16 v[168:171], a[116:119], a[44:47], v[168:171]
    buffer_load_dwordx4 v99, s[16:19], s50 offen offset:3072  lds
    s_add_u32 s50, s50, 524288
    s_cmp_eq_u32 s50, 3670016
    s_cselect_b32 s50, 0, s50
    v_mfma_f32_16x16x32_bf16 v[164:167], a[120:123], a[32:35], v[164:167]
    ds_read_b64_tr_b16 a[240:241], v74 offset:49152
    v_mfma_f32_16x16x32_bf16 v[172:175], a[120:123], a[36:39], v[172:175]
    ds_read_b64_tr_b16 a[242:243], v74 offset:50176
    v_mfma_f32_16x16x32_bf16 v[164:167], a[124:127], a[40:43], v[164:167]
    ds_read_b64_tr_b16 a[244:245], v74 offset:57344
    ds_read_b64_tr_b16 a[246:247], v74 offset:58368
    v_mfma_f32_16x16x32_bf16 v[172:175], a[124:127], a[44:47], v[172:175]
    s_cmp_lg_u32 s66, s67
    s_subb_u32 s79, s79, 0
    s_waitcnt lgkmcnt(15)
    v_mfma_f32_16x16x32_bf16 v[176:179], a[128:131], a[32:35], v[176:179]
    ds_read_b64_tr_b16 a[248:249], v75 offset:49152
    v_mfma_f32_16x16x32_bf16 v[184:187], a[128:131], a[36:39], v[184:187]
    ds_read_b64_tr_b16 a[250:251], v75 offset:50176
    v_mfma_f32_16x16x32_bf16 v[176:179], a[132:135], a[40:43], v[176:179]
    ds_read_b64_tr_b16 a[252:253], v75 offset:57344
    ds_read_b64_tr_b16 a[254:255], v75 offset:58368
    v_mfma_f32_16x16x32_bf16 v[184:187], a[132:135], a[44:47], v[184:187]
    s_cmp_lg_u32 s66, s67
    s_subb_u32 s79, s79, 0
    v_mfma_f32_16x16x32_bf16 v[180:183], a[136:139], a[32:35], v[180:183]
    ds_read_b64_tr_b16 a[112:113], v76 offset:49152
    v_mfma_f32_16x16x32_bf16 v[188:191], a[136:139], a[36:39], v[188:191]
    ds_read_b64_tr_b16 a[114:115], v76 offset:50176
    v_mfma_f32_16x16x32_bf16 v[180:183], a[140:143], a[40:43], v[180:183]
    ds_read_b64_tr_b16 a[116:117], v76 offset:57344
    s_cmp_lg_u32 s4, 3
    s_cbranch_scc1 L_npr0_3
    s_mov_b64 s[66:67], -1
    s_load_dword s66, s[64:65], 55296
    s_load_dword s67, s[64:65], 63488
L_npr0_3:
    v_mfma_f32_16x16x32_bf16 v[188:191], a[140:143], a[44:47], v[188:191]
    ds_read_b64_tr_b16 a[118:119], v76 offset:58368
    s_cmp_lg_u32 s66, s67
    s_subb_u32 s79, s79, 0
    s_waitcnt lgkmcnt(12)
    v_mfma_f32_16x16x32_bf16 v[128:131], a[224:227], a[48:51], v[128:131]
    ds_read_b64_tr_b16 a[120:121], v77 offset:49152
    v_mfma_f32_16x16x32_bf16 v[136:139], a[224:227], a[52:55], v[136:139]
    ds_read_b64_tr_b16 a[122:123], v77 offset:50176
    v_mfma_f32_16x16x32_bf16 v[128:131], a[228:231], a[56:59], v[128:131]
    ds_read_b64_tr_b16 a[124:125], v77 offset:57344
    ds_read_b64_tr_b16 a[126:127], v77 offset:58368
    v_mfma_f32_16x16x32_bf16 v[136:139], a[228:231], a[60:63], v[136:139]
    s_cmp_lg_u32 s66, s67
    s_subb_u32 s79, s79, 0
    v_mfma_f32_16x16x32_bf16 v[132:135], a[232:235], a[48:51], v[132:135]
    ds_read_b64_tr_b16 a[128:129], v78 offset:49152
    ds_read_b64_tr_b16 a[130:131], v78 offset:50176
    v_mfma_f32_16x16x32_bf16 v[140:143], a[232:235], a[52:55], v[140:143]
    s_add_u32 m0, s48, 81920
    s_nop 0
    buffer_load_dwordx4 v96, s[16:19], s50 offen  lds
    v_mfma_f32_16x16x32_bf16 v[132:135], a[236:239], a[56:59], v[132:135]
    ds_read_b64_tr_b16 a[132:133], v78 offset:57344
    ds_read_b64_tr_b16 a[134:135], v78 offset:58368
    buffer_load_dwordx4 v97, s[16:19], s50 offen offset:1024  lds
    v_mfma_f32_16x16x32_bf16 v[140:143], a[236:239], a[60:63], v[140:143]
    s_cmp_lg_u32 s66, s67
    s_subb_u32 s79, s79, 0
    s_waitcnt lgkmcnt(12)
    v_mfma_f32_16x16x32_bf16 v[144:147], a[240:243], a[48:51], v[144:147]
    ds_read_b64_tr_b16 a[136:137], v79 offset:49152
    ds_read_b64_tr_b16 a[138:139], v79 offset:50176
    v_mfma_f32_16x16x32_bf16 v[152:155], a[240:243], a[52:55], v[152:155]
    buffer_load_dwordx4 v98, s[16:19], s50 offen offset:2048  lds
    v_mfma_f32_16x16x32_bf16 v[144:147], a[244:247], a[56:59], v[144:147]
    ds_read_b64_tr_b16 a[140:141], v79 offset:57344
    ds_read_b64_tr_b16 a[142:143], v79 offset:58368
    s_cmp_lg_u32 s66, s67
    s_subb_u32 s79, s79, 0
    v_mfma_f32_16x16x32_bf16 v[152:155], a[244:247], a[60:63], v[152:155]
    buffer_load_dwordx4 v99, s[16:19], s50 offen offset:3072  lds
    s_add_u32 s50, s50, 524288
    s_cmp_eq_u32 s50, 3670016
    s_cselect_b32 s50, 0, s50
    v_mfma_f32_16x16x32_bf16 v[148:151], a[248:251], a[48:51], v[148:151]
    s_waitcnt vmcnt(24)
    s_barrier
    ds_read_b128 a[64:67], v90 offset:32768
    ds_read_b128 a[68:71], v90 offset:34816
    v_mfma_f32_16x16x32_bf16 v[156:159], a[248:251], a[52:55], v[156:159]
    ds_read_b64_tr_b16 a[224:225], v64 offset:0
    ds_read_b64_tr_b16 a[226:227], v64 offset:1024
    s_add_u32 m0, s48, 49152
    s_nop 0
    buffer_load_dwordx4 v96, s[16:19], s50 offen  lds
    v_mfma_f32_16x16x32_bf16 v[148:151], a[252:255], a[56:59], v[148:151]
    ds_read_b128 a[72:75], v91 offset:32768
    ds_read_b128 a[76:79], v91 offset:34816
    ds_read_b64_tr_b16 a[228:229], v64 offset:8192
    ds_read_b64_tr_b16 a[230:231], v64 offset:9216
    v_mfma_f32_16x16x32_bf16 v[156:159], a[252:255], a[60:63], v[156:159]
    s_cmp_lg_u32 s66, s67
    s_subb_u32 s79, s79, 0
    buffer_load_dwordx4 v97, s[16:19], s50 offen offset:1024  lds
    s_waitcnt lgkmcnt(15)
    v_mfma_f32_16x16x32_bf16 v[160:163], a[112:115], a[48:51], v[160:163]
    ds_read_b64_tr_b16 a[232:233], v65 offset:0
    ds_read_b64_tr_b16 a[234:235], v65 offset:1024
    v_mfma_f32_16x16x32_bf16 v[168:171], a[112:115], a[52:55], v[168:171]
    buffer_load_dwordx4 v98, s[16:19], s50 offen offset:2048  lds
    v_mfma_f32_16x16x32_bf16 v[160:163], a[116:119], a[56:59], v[160:163]
    ds_read_b64_tr_b16 a[236:237], v65 offset:8192
    ds_read_b64_tr_b16 a[238:239], v65 offset:9216
    s_cmp_lg_u32 s66, s67
    s_subb_u32 s79, s79, 0
    v_mfma_f32_16x16x32_bf16 v[168:171], a[116:119], a[60:63], v[168:171]
    buffer_load_dwordx4 v99, s[16:19], s50 offen offset:3072  lds
    s_add_u32 s50, s50, 524288
    s_cmp_eq_u32 s50, 3670016
    s_cselect_b32 s50, 0, s50
    v_mfma_f32_16x16x32_bf16 v[164:167], a[120:123], a[48:51], v[164:167]
    ds_read_b64_tr_b16 a[240:241], v66 offset:0
    v_mfma_f32_16x16x32_bf16 v[172:175], a[120:123], a[52:55], v[172:175]
    ds_read_b64_tr_b16 a[242:243], v66 offset:1024
    v_mfma_f32_16x16x32_bf16 v[164:167], a[124:127], a[56:59], v[164:167]
    ds_read_b64_tr_b16 a[244:245], v66 offset:8192
    ds_read_b64_tr_b16 a[246:247], v66 offset:9216
    v_mfma_f32_16x16x32_bf16 v[172:175], a[124:127], a[60:63], v[172:175]
    s_cmp_lg_u32 s66, s67
    s_subb_u32 s79, s79, 0
    s_waitcnt lgkmcnt(15)
    v_mfma_f32_16x16x32_bf16 v[176:179], a[128:131], a[48:51], v[176:179]
    ds_read_b64_tr_b16 a[248:249], v67 offset:0
    v_mfma_f32_16x16x32_bf16 v[184:187], a[128:131], a[52:55], v[184:187]
    ds_read_b64_tr_b16 a[250:251], v67 offset:1024
    v_mfma_f32_16x16x32_bf16 v[176:179], a[132:135], a[56:59], v[176:179]
    ds_read_b64_tr_b16 a[252:253], v67 offset:8192
    ds_read_b64_tr_b16 a[254:255], v67 offset:9216
    v_mfma_f32_16x16x32_bf16 v[184:187], a[132:135], a[60:63], v[184:187]
    s_cmp_lg_u32 s66, s67
    s_subb_u32 s79, s79, 0
    v_mfma_f32_16x16x32_bf16 v[180:183], a[136:139], a[48:51], v[180:183]
    ds_read_b64_tr_b16 a[112:113], v68 offset:0
    v_mfma_f32_16x16x32_bf16 v[188:191], a[136:139], a[52:55], v[188:191]
    ds_read_b64_tr_b16 a[114:115], v68 offset:1024
    v_mfma_f32_16x16x32_bf16 v[180:183], a[140:143], a[56:59], v[180:183]
    ds_read_b64_tr_b16 a[116:117], v68 offset:8192
    ds_read_b64_tr_b16 a[118:119], v68 offset:9216
    v_mfma_f32_16x16x32_bf16 v[188:191], a[140:143], a[60:63], v[188:191]
    s_cmp_lg_u32 s66, s67
    s_subb_u32 s79, s79, 0
    s_waitcnt lgkmcnt(12)
    v_mfma_f32_16x16x32_bf16 v[128:131], a[224:227], a[64:67], v[128:131]
    ds_read_b64_tr_b16 a[120:121], v69 offset:0
    v_mfma_f32_16x16x32_bf16 v[136:139], a[224:227], a[68:71], v[136:139]
    ds_read_b64_tr_b16 a[122:123], v69 offset:1024
    v_mfma_f32_16x16x32_bf16 v[128:131], a[228:231], a[72:75], v[128:131]
    ds_read_b64_tr_b16 a[124:125], v69 offset:8192
    ds_read_b64_tr_b16 a[126:127], v69 offset:9216
    v_mfma_f32_16x16x32_bf16 v[136:139], a[228:231], a[76:79], v[136:139]
    s_cmp_lg_u32 s66, s67
    s_subb_u32 s79, s79, 0
    v_mfma_f32_16x16x32_bf16 v[132:135], a[232:235], a[64:67], v[132:135]
    ds_read_b64_tr_b16 a[128:129], v70 offset:0
    ds_read_b64_tr_b16 a[130:131], v70 offset:1024
    v_mfma_f32_16x16x32_bf16 v[140:143], a[232:235], a[68:71], v[140:143]
    s_add_u32 m0, s48, 98304
    s_nop 0
    buffer_load_dwordx4 v96, s[16:19], s50 offen  lds
    v_mfma_f32_16x16x32_bf16 v[132:135], a[236:239], a[72:75], v[132:135]
    ds_read_b64_tr_b16 a[132:133], v70 offset:8192
    ds_read_b64_tr_b16 a[134:135], v70 offset:9216
    buffer_load_dwordx4 v97, s[16:19], s50 offen offset:1024  lds
    v_mfma_f32_16x16x32_bf16 v[140:143], a[236:239], a[76:79], v[140:143]
    s_cmp_lg_u32 s66, s67
    s_subb_u32 s79, s79, 0
    s_waitcnt lgkmcnt(12)
    v_mfma_f32_16x16x32_bf16 v[144:147], a[240:243], a[64:67], v[144:147]
    ds_read_b64_tr_b16 a[136:137], v71 offset:0
    ds_read_b64_tr_b16 a[138:139], v71 offset:1024
    v_mfma_f32_16x16x32_bf16 v[152:155], a[240:243], a[68:71], v[152:155]
    buffer_load_dwordx4 v98, s[16:19], s50 offen offset:2048  lds
    v_mfma_f32_16x16x32_bf16 v[144:147], a[244:247], a[72:75], v[144:147]
    ds_read_b64_tr_b16 a[140:141], v71 offset:8192
    ds_read_b64_tr_b16 a[142:143], v71 offset:9216
    s_cmp_lg_u32 s66, s67
    s_subb_u32 s79, s79, 0
    v_mfma_f32_16x16x32_bf16 v[152:155], a[244:247], a[76:79], v[152:155]
    buffer_load_dwordx4 v99, s[16:19], s50 offen offset:3072  lds
    s_add_u32 s50, s50, 524288
    s_cmp_eq_u32 s50, 3670016
    s_cselect_b32 s50, 0, s50
    v_mfma_f32_16x16x32_bf16 v[148:151], a[248:251], a[64:67], v[148:151]
    s_waitcnt vmcnt(24)
    s_barrier
    ds_read_b128 a[80:83], v92 offset:0
    ds_read_b128 a[84:87], v92 offset:2048
    v_mfma_f32_16x16x32_bf16 v[156:159], a[248:251], a[68:71], v[156:159]
    ds_read_b64_tr_b16 a[224:225], v64 offset:16384
    ds_read_b64_tr_b16 a[226:227], v64 offset:17408
    s_add_u32 m0, s48, 114688
    s_nop 0
    buffer_load_dwordx4 v96, s[16:19], s50 offen  lds
    v_mfma_f32_16x16x32_bf16 v[148:151], a[252:255], a[72:75], v[148:151]
    ds_read_b128 a[88:91], v93 offset:0
    ds_read_b128 a[92:95], v93 offset:2048
    ds_read_b64_tr_b16 a[228:229], v64 offset:24576
    ds_read_b64_tr_b16 a[230:231], v64 offset:25600
    v_mfma_f32_16x16x32_bf16 v[156:159], a[252:255], a[76:79], v[156:159]
    s_cmp_lg_u32 s4, 0
    s_cbranch_scc1 L_npr1_0
    s_mov_b64 s[66:67], -1
    s_load_dword s66, s[64:65], 64000
    s_load_dword s67, s[64:65], 55808
L_npr1_0:
    buffer_load_dwordx4 v97, s[16:19], s50 offen offset:1024  lds
    s_waitcnt lgkmcnt(15)
    v_mfma_f32_16x16x32_bf16 v[160:163], a[112:115], a[64:67], v[160:163]
    ds_read_b64_tr_b16 a[232:233], v65 offset:16384
    ds_read_b64_tr_b16 a[234:235], v65 offset:17408
    v_mfma_f32_16x16x32_bf16 v[168:171], a[112:115], a[68:71], v[168:171]
    buffer_load_dwordx4 v98, s[16:19], s50 offen offset:2048  lds
    v_mfma_f32_16x16x32_bf16 v[160:163], a[116:119], a[72:75], v[160:163]
    ds_read_b64_tr_b16 a[236:237], v65 offset:24576
    ds_read_b64_tr_b16 a[238:239], v65 offset:25600
    v_mfma_f32_16x16x32_bf16 v[168:171], a[116:119], a[76:79], v[168:171]
    buffer_load_dwordx4 v99, s[16:19], s50 offen offset:3072  lds
    s_add_u32 s50, s50, 524288
    s_cmp_eq_u32 s50, 3670016
    s_cselect_b32 s50, 0, s50
    v_mfma_f32_16x16x32_bf16 v[164:167], a[120:123], a[64:67], v[164:167]
    ds_read_b64_tr_b16 a[240:241], v66 offset:16384
    v_mfma_f32_16x16x32_bf16 v[172:175], a[120:123], a[68:71], v[172:175]
    ds_read_b64_tr_b16 a[242:243], v66 offset:17408
    v_mfma_f32_16x16x32_bf16 v[164:167], a[124:127], a[72:75], v[164:167]
    ds_read_b64_tr_b16 a[244:245], v66 offset:24576
    ds_read_b64_tr_b16 a[246:247], v66 offset:25600
    v_mfma_f32_16x16x32_bf16 v[172:175], a[124:127], a[76:79], v[172:175]
    s_cmp_lg_u32 s66, s67
    s_addc_u32 s79, s79, 0
    s_waitcnt lgkmcnt(15)
    v_mfma_f32_16x16x32_bf16 v[176:179], a[128:131], a[64:67], v[176:179]
    ds_read_b64_tr_b16 a[248:249], v67 offset:16384
    v_mfma_f32_16x16x32_bf16 v[184:187], a[128:131], a[68:71], v[184:187]
    ds_read_b64_tr_b16 a[250:251], v67 offset:17408
    v_mfma_f32_16x16x32_bf16 v[176:179], a[132:135], a[72:75], v[176:179]
    ds_read_b64_tr_b16 a[252:253], v67 offset:24576
    ds_read_b64_tr_b16 a[254:255], v67 offset:25600
    v_mfma_f32_16x16x32_bf16 v[184:187], a[132:135], a[76:79], v[184:187]
    s_cmp_lg_u32 s66, s67
    s_addc_u32 s79, s79, 0
    v_mfma_f32_16x16x32_bf16 v[180:183], a[136:139], a[64:67], v[180:183]
    ds_read_b64_tr_b16 a[112:113], v68 offset:16384
    v_mfma_f32_16x16x32_bf16 v[188:191], a[136:139], a[68:71], v[188:191]
    ds_read_b64_tr_b16 a[114:115], v68 offset:17408
    v_mfma_f32_16x16x32_bf16 v[180:183], a[140:143], a[72:75], v[180:183]
    ds_read_b64_tr_b16 a[116:117], v68 offset:24576
    s_cmp_lg_u32 s4, 1
    s_cbranch_scc1 L_npr1_1
    s_mov_b64 s[66:67], -1
    s_load_dword s66, s[64:65], 64000
    s_load_dword s67, s[64:65], 55808
L_npr1_1:
    v_mfma_f32_16x16x32_bf16 v[188:191], a[140:143], a[76:79], v[188:191]
    ds_read_b64_tr_b16 a[118:119], v68 offset:25600
    s_cmp_lg_u32 s66, s67
    s_addc_u32 s79, s79, 0
    s_waitcnt lgkmcnt(12)
    v_mfma_f32_16x16x32_bf16 v[128:131], a[224:227], a[80:83], v[128:131]
    ds_read_b64_tr_b16 a[120:121], v69 offset:16384
    v_mfma_f32_16x16x32_bf16 v[136:139], a[224:227], a[84:87], v[136:139]
    ds_read_b64_tr_b16 a[122:123], v69 offset:17408
    v_mfma_f32_16x16x32_bf16 v[128:131], a[228:231], a[88:91], v[128:131]
    ds_read_b64_tr_b16 a[124:125], v69 offset:24576
    ds_read_b64_tr_b16 a[126:127], v69 offset:25600
    v_mfma_f32_16x16x32_bf16 v[136:139], a[228:231], a[92:95], v[136:139]
    s_cmp_lg_u32 s66, s67
    s_addc_u32 s79, s79, 0
    v_mfma_f32_16x16x32_bf16 v[132:135], a[232:235], a[80:83], v[132:135]
    ds_read_b64_tr_b16 a[128:129], v70 offset:16384
    ds_read_b64_tr_b16 a[130:131], v70 offset:17408
    v_mfma_f32_16x16x32_bf16 v[140:143], a[232:235], a[84:87], v[140:143]
    s_add_u32 m0, s48, 131072
    s_nop 0
    buffer_load_dwordx4 v96, s[16:19], s50 offen  lds
    v_mfma_f32_16x16x32_bf16 v[132:135], a[236:239], a[88:91], v[132:135]
    ds_read_b64_tr_b16 a[132:133], v70 offset:24576
    ds_read_b64_tr_b16 a[134:135], v70 offset:25600
    buffer_load_dwordx4 v97, s[16:19], s50 offen offset:1024  lds
    v_mfma_f32_16x16x32_bf16 v[140:143], a[236:239], a[92:95], v[140:143]
    s_cmp_lg_u32 s66, s67
    s_addc_u32 s79, s79, 0
    s_waitcnt lgkmcnt(12)
    v_mfma_f32_16x16x32_bf16 v[144:147], a[240:243], a[80:83], v[144:147]
    ds_read_b64_tr_b16 a[136:137], v71 offset:16384
    ds_read_b64_tr_b16 a[138:139], v71 offset:17408
    v_mfma_f32_16x16x32_bf16 v[152:155], a[240:243], a[84:87], v[152:155]
    buffer_load_dwordx4 v98, s[16:19], s50 offen offset:2048  lds
    v_mfma_f32_16x16x32_bf16 v[144:147], a[244:247], a[88:91], v[144:147]
    ds_read_b64_tr_b16 a[140:141], v71 offset:24576
    ds_read_b64_tr_b16 a[142:143], v71 offset:25600
    s_cmp_lg_u32 s66, s67
    s_addc_u32 s79, s79, 0
    v_mfma_f32_16x16x32_bf16 v[152:155], a[244:247], a[92:95], v[152:155]
    buffer_load_dwordx4 v99, s[16:19], s50 offen offset:3072  lds
    s_add_u32 s50, s50, 524288
    s_cmp_eq_u32 s50, 3670016
    s_cselect_b32 s50, 0, s50
    v_mfma_f32_16x16x32_bf16 v[148:151], a[248:251], a[80:83], v[148:151]
    s_waitcnt vmcnt(24)
    s_barrier
    ds_read_b128 a[96:99], v92 offset:16384
    v_mfma_f32_16x16x32_bf16 v[156:159], a[248:251], a[84:87], v[156:159]
    ds_read_b128 a[100:103], v92 offset:18432
    ds_read_b64_tr_b16 a[224:225], v72 offset:0
    ds_read_b64_tr_b16 a[226:227], v72 offset:1024
    v_mfma_f32_16x16x32_bf16 v[148:151], a[252:255], a[88:91], v[148:151]
    ds_read_b128 a[104:107], v93 offset:16384
    ds_read_b128 a[108:111], v93 offset:18432
    s_cmp_lg_u32 s4, 2
    s_cbranch_scc1 L_npr1_2
    s_mov_b64 s[66:67], -1
    s_load_dword s66, s[64:65], 64000
    s_load_dword s67, s[64:65], 55808
L_npr1_2:
    v_mfma_f32_16x16x32_bf16 v[156:159], a[252:255], a[92:95], v[156:159]
    ds_read_b64_tr_b16 a[228:229], v72 offset:8192
    ds_read_b64_tr_b16 a[230:231], v72 offset:9216
    s_cmp_lg_u32 s66, s67
    s_addc_u32 s79, s79, 0
    s_waitcnt lgkmcnt(15)
    v_mfma_f32_16x16x32_bf16 v[160:163], a[112:115], a[80:83], v[160:163]
    ds_read_b64_tr_b16 a[232:233], v73 offset:0
    v_mfma_f32_16x16x32_bf16 v[168:171], a[112:115], a[84:87], v[168:171]
    ds_read_b64_tr_b16 a[234:235], v73 offset:1024
    v_mfma_f32_16x16x32_bf16 v[160:163], a[116:119], a[88:91], v[160:163]
    ds_read_b64_tr_b16 a[236:237], v73 offset:8192
    ds_read_b64_tr_b16 a[238:239], v73 offset:9216
    v_mfma_f32_16x16x32_bf16 v[168:171], a[116:119], a[92:95], v[168:171]
    s_cmp_lg_u32 s66, s67
    s_addc_u32 s79, s79, 0
    v_mfma_f32_16x16x32_bf16 v[164:167], a[120:123], a[80:83], v[164:167]
    ds_read_b64_tr_b16 a[240:241], v74 offset:0
    v_mfma_f32_16x16x32_bf16 v[172:175], a[120:123], a[84:87], v[172:175]
    ds_read_b64_tr_b16 a[242:243], v74 offset:1024
    v_mfma_f32_16x16x32_bf16 v[164:167], a[124:127], a[88:91], v[164:167]
    ds_read_b64_tr_b16 a[244:245], v74 offset:8192
    ds_read_b64_tr_b16 a[246:247], v74 offset:9216
    v_mfma_f32_16x16x32_bf16 v[172:175], a[124:127], a[92:95], v[172:175]
    s_cmp_lg_u32 s66, s67
    s_addc_u32 s79, s79, 0
    s_waitcnt lgkmcnt(15)
    v_mfma_f32_16x16x32_bf16 v[176:179], a[128:131], a[80:83], v[176:179]
    ds_read_b64_tr_b16 a[248:249], v75 offset:0
    v_mfma_f32_16x16x32_bf16 v[184:187], a[128:131], a[84:87], v[184:187]
    ds_read_b64_tr_b16 a[250:251], v75 offset:1024
    v_mfma_f32_16x16x32_bf16 v[176:179], a[132:135], a[88:91], v[176:179]
    ds_read_b64_tr_b16 a[252:253], v75 offset:8192
    ds_read_b64_tr_b16 a[254:255], v75 offset:9216
    v_mfma_f32_16x16x32_bf16 v[184:187], a[132:135], a[92:95], v[184:187]
    s_cmp_lg_u32 s66, s67
    s_addc_u32 s79, s79, 0
    v_mfma_f32_16x16x32_bf16 v[180:183], a[136:139], a[80:83], v[180:183]
    ds_read_b64_tr_b16 a[112:113], v76 offset:0
    v_mfma_f32_16x16x32_bf16 v[188:191], a[136:139], a[84:87], v[188:191]
    ds_read_b64_tr_b16 a[114:115], v76 offset:1024
    v_mfma_f32_16x16x32_bf16 v[180:183], a[140:143], a[88:91], v[180:183]
    ds_read_b64_tr_b16 a[116:117], v76 offset:8192
    s_cmp_lg_u32 s4, 3
    s_cbranch_scc1 L_npr1_3
    s_mov_b64 s[66:67], -1
    s_load_dword s66, s[64:65], 64000
    s_load_dword s67, s[64:65], 55808
L_npr1_3:
    v_mfma_f32_16x16x32_bf16 v[188:191], a[140:143], a[92:95], v[188:191]
    ds_read_b64_tr_b16 a[118:119], v76 offset:9216
    s_cmp_lg_u32 s66, s67
    s_addc_u32 s79, s79, 0
    s_waitcnt lgkmcnt(12)
    v_mfma_f32_16x16x32_bf16 v[128:131], a[224:227], a[96:99], v[128:131]
    ds_read_b64_tr_b16 a[120:121], v77 offset:0
    v_mfma_f32_16x16x32_bf16 v[136:139], a[224:227], a[100:103], v[136:139]
    ds_read_b64_tr_b16 a[122:123], v77 offset:1024
    v_mfma_f32_16x16x32_bf16 v[128:131], a[228:231], a[104:107], v[128:131]
    ds_read_b64_tr_b16 a[124:125], v77 offset:8192
    ds_read_b64_tr_b16 a[126:127], v77 offset:9216
    v_mfma_f32_16x16x32_bf16 v[136:139], a[228:231], a[108:111], v[136:139]
    s_cmp_lg_u32 s66, s67
    s_addc_u32 s79, s79, 0
    v_mfma_f32_16x16x32_bf16 v[132:135], a[232:235], a[96:99], v[132:135]
    ds_read_b64_tr_b16 a[128:129], v78 offset:0
    ds_read_b64_tr_b16 a[130:131], v78 offset:1024
    v_mfma_f32_16x16x32_bf16 v[140:143], a[232:235], a[100:103], v[140:143]
    s_add_u32 m0, s48, 147456
    s_nop 0
    buffer_load_dwordx4 v96, s[16:19], s50 offen  lds
    v_mfma_f32_16x16x32_bf16 v[132:135], a[236:239], a[104:107], v[132:135]
    ds_read_b64_tr_b16 a[132:133], v78 offset:8192
    ds_read_b64_tr_b16 a[134:135], v78 offset:9216
    buffer_load_dwordx4 v97, s[16:19], s50 offen offset:1024  lds
    v_mfma_f32_16x16x32_bf16 v[140:143], a[236:239], a[108:111], v[140:143]
    s_cmp_lg_u32 s66, s67
    s_addc_u32 s79, s79, 0
    s_waitcnt lgkmcnt(12)
    v_mfma_f32_16x16x32_bf16 v[144:147], a[240:243], a[96:99], v[144:147]
    ds_read_b64_tr_b16 a[136:137], v79 offset:0
    ds_read_b64_tr_b16 a[138:139], v79 offset:1024
    v_mfma_f32_16x16x32_bf16 v[152:155], a[240:243], a[100:103], v[152:155]
    buffer_load_dwordx4 v98, s[16:19], s50 offen offset:2048  lds
    v_mfma_f32_16x16x32_bf16 v[144:147], a[244:247], a[104:107], v[144:147]
    ds_read_b64_tr_b16 a[140:141], v79 offset:8192
    ds_read_b64_tr_b16 a[142:143], v79 offset:9216
    v_mfma_f32_16x16x32_bf16 v[152:155], a[244:247], a[108:111], v[152:155]
    s_cmp_lg_u32 s66, s67
    s_addc_u32 s79, s79, 0
    buffer_load_dwordx4 v99, s[16:19], s50 offen offset:3072  lds
    v_mfma_f32_16x16x32_bf16 v[148:151], a[248:251], a[96:99], v[148:151]
    s_waitcnt vmcnt(24)
    s_barrier
    v_mfma_f32_16x16x32_bf16 v[156:159], a[248:251], a[100:103], v[156:159]
    ds_read_b64_tr_b16 a[224:225], v64 offset:32768
    ds_read_b64_tr_b16 a[226:227], v64 offset:33792
    v_mfma_f32_16x16x32_bf16 v[148:151], a[252:255], a[104:107], v[148:151]
    ds_read_b64_tr_b16 a[228:229], v64 offset:40960
    ds_read_b64_tr_b16 a[230:231], v64 offset:41984
    v_mfma_f32_16x16x32_bf16 v[156:159], a[252:255], a[108:111], v[156:159]
    s_cmp_lg_u32 s66, s67
    s_addc_u32 s79, s79, 0
    s_waitcnt lgkmcnt(12)
    v_mfma_f32_16x16x32_bf16 v[160:163], a[112:115], a[96:99], v[160:163]
    ds_read_b64_tr_b16 a[232:233], v65 offset:32768
    v_mfma_f32_16x16x32_bf16 v[168:171], a[112:115], a[100:103], v[168:171]
    ds_read_b64_tr_b16 a[234:235], v65 offset:33792
    v_mfma_f32_16x16x32_bf16 v[160:163], a[116:119], a[104:107], v[160:163]
    ds_read_b64_tr_b16 a[236:237], v65 offset:40960
    ds_read_b64_tr_b16 a[238:239], v65 offset:41984
    v_mfma_f32_16x16x32_bf16 v[168:171], a[116:119], a[108:111], v[168:171]
    s_cmp_lg_u32 s66, s67
    s_addc_u32 s79, s79, 0
    v_mfma_f32_16x16x32_bf16 v[164:167], a[120:123], a[96:99], v[164:167]
    ds_read_b64_tr_b16 a[240:241], v66 offset:32768
    v_mfma_f32_16x16x32_bf16 v[172:175], a[120:123], a[100:103], v[172:175]
    ds_read_b64_tr_b16 a[242:243], v66 offset:33792
    v_mfma_f32_16x16x32_bf16 v[164:167], a[124:127], a[104:107], v[164:167]
    ds_read_b64_tr_b16 a[244:245], v66 offset:40960
    ds_read_b64_tr_b16 a[246:247], v66 offset:41984
    v_mfma_f32_16x16x32_bf16 v[172:175], a[124:127], a[108:111], v[172:175]
    s_cmp_lg_u32 s66, s67
    s_addc_u32 s79, s79, 0
    s_waitcnt lgkmcnt(12)
    v_mfma_f32_16x16x32_bf16 v[176:179], a[128:131], a[96:99], v[176:179]
    ds_read_b64_tr_b16 a[248:249], v67 offset:32768
    v_mfma_f32_16x16x32_bf16 v[184:187], a[128:131], a[100:103], v[184:187]
    ds_read_b64_tr_b16 a[250:251], v67 offset:33792
    v_mfma_f32_16x16x32_bf16 v[176:179], a[132:135], a[104:107], v[176:179]
    ds_read_b64_tr_b16 a[252:253], v67 offset:40960
    ds_read_b64_tr_b16 a[254:255], v67 offset:41984
    v_mfma_f32_16x16x32_bf16 v[184:187], a[132:135], a[108:111], v[184:187]
    s_cmp_lg_u32 s66, s67
    s_addc_u32 s79, s79, 0
    v_mfma_f32_16x16x32_bf16 v[180:183], a[136:139], a[96:99], v[180:183]
    ds_read_b64_tr_b16 a[112:113], v68 offset:32768
    v_mfma_f32_16x16x32_bf16 v[188:191], a[136:139], a[100:103], v[188:191]
    ds_read_b64_tr_b16 a[114:115], v68 offset:33792
    v_mfma_f32_16x16x32_bf16 v[180:183], a[140:143], a[104:107], v[180:183]
    ds_read_b64_tr_b16 a[116:117], v68 offset:40960
    ds_read_b64_tr_b16 a[118:119], v68 offset:41984
    v_mfma_f32_16x16x32_bf16 v[188:191], a[140:143], a[108:111], v[188:191]
    s_cmp_lg_u32 s66, s67
    s_addc_u32 s79, s79, 0
    s_waitcnt lgkmcnt(12)
    v_mfma_f32_16x16x32_bf16 v[192:195], a[224:227], a[0:3], 0
    ds_read_b64_tr_b16 a[120:121], v69 offset:32768
    ds_read_b64_tr_b16 a[122:123], v69 offset:33792
    v_mfma_f32_16x16x32_bf16 v[200:203], a[224:227], a[4:7], 0
    s_add_u32 m0, s48, 0
    s_mov_b32 s61, 0
    buffer_load_dwordx4 v26, s[8:11], s61 offen nt lds
    v_mfma_f32_16x16x32_bf16 v[192:195], a[228:231], a[8:11], v[192:195]
    ds_read_b64_tr_b16 a[124:125], v69 offset:40960
    ds_read_b64_tr_b16 a[126:127], v69 offset:41984
    v_mfma_f32_16x16x32_bf16 v[200:203], a[228:231], a[12:15], v[200:203]
    s_cmp_lg_u32 s66, s67
    s_addc_u32 s79, s79, 0
    v_mfma_f32_16x16x32_bf16 v[196:199], a[232:235], a[0:3], 0
    ds_read_b64_tr_b16 a[128:129], v70 offset:32768
    ds_read_b64_tr_b16 a[130:131], v70 offset:33792
    v_mfma_f32_16x16x32_bf16 v[204:207], a[232:235], a[4:7], 0
    v_mul_f32 v128, s54, v128
    v_mul_f32 v129, s54, v129
    v_mfma_f32_16x16x32_bf16 v[196:199], a[236:239], a[8:11], v[196:199]
    ds_read_b64_tr_b16 a[132:133], v70 offset:40960
    ds_read_b64_tr_b16 a[134:135], v70 offset:41984
    v_mfma_f32_16x16x32_bf16 v[204:207], a[236:239], a[12:15], v[204:207]
    s_cmp_lg_u32 s66, s67
    s_addc_u32 s79, s79, 0
    s_waitcnt lgkmcnt(12)
    v_mfma_f32_16x16x32_bf16 v[208:211], a[240:243], a[0:3], 0
    ds_read_b64_tr_b16 a[136:137], v71 offset:32768
    ds_read_b64_tr_b16 a[138:139], v71 offset:33792
    v_mfma_f32_16x16x32_bf16 v[216:219], a[240:243], a[4:7], 0
    v_mul_f32 v130, s54, v130
    v_mul_f32 v131, s54, v131
    v_mul_f32 v132, s54, v132
    v_mfma_f32_16x16x32_bf16 v[208:211], a[244:247], a[8:11], v[208:211]
    ds_read_b64_tr_b16 a[140:141], v71 offset:40960
    ds_read_b64_tr_b16 a[142:143], v71 offset:41984
    v_mfma_f32_16x16x32_bf16 v[216:219], a[244:247], a[12:15], v[216:219]
    s_cmp_lg_u32 s66, s67
    s_addc_u32 s79, s79, 0
    v_mfma_f32_16x16x32_bf16 v[212:215], a[248:251], a[0:3], 0
L_pg2:
    s_cbranch_execz L_pgr1
    s_waitcnt vmcnt(21)
    s_barrier
    ds_read_b64_tr_b16 a[224:225], v72 offset:16384
    v_mfma_f32_16x16x32_bf16 v[220:223], a[248:251], a[4:7], 0
    ds_read_b64_tr_b16 a[226:227], v72 offset:17408
    s_add_u32 m0, s48, 0
    s_nop 0
    buffer_load_dwordx4 v27, s[8:11], s61 offen offset:1024 nt lds
    v_mfma_f32_16x16x32_bf16 v[212:215], a[252:255], a[8:11], v[212:215]
    ds_read_b64_tr_b16 a[228:229], v72 offset:24576
    ds_read_b64_tr_b16 a[230:231], v72 offset:25600
    v_mfma_f32_16x16x32_bf16 v[220:223], a[252:255], a[12:15], v[220:223]
    s_cmp_gt_i32 s79, 0
    s_cselect_b32 s99, 0x2000, 0
    s_waitcnt lgkmcnt(12)
    v_mfma_f32_16x16x32_bf16 v[224:227], a[112:115], a[0:3], 0
    ds_read_b64_tr_b16 a[232:233], v73 offset:16384
    ds_read_b64_tr_b16 a[234:235], v73 offset:17408
    v_mfma_f32_16x16x32_bf16 v[232:235], a[112:115], a[4:7], 0
    v_add_u32 v34, s99, v34
    v_mul_f32 v133, s54, v133
    v_mul_f32 v134, s54, v134
    v_mfma_f32_16x16x32_bf16 v[224:227], a[116:119], a[8:11], v[224:227]
    ds_read_b64_tr_b16 a[236:237], v73 offset:24576
    ds_read_b64_tr_b16 a[238:239], v73 offset:25600
    v_mfma_f32_16x16x32_bf16 v[232:235], a[116:119], a[12:15], v[232:235]
    s_lshr_b32 s44, s99, 6
    v_mov_b32 v51, s44
    v_mfma_f32_16x16x32_bf16 v[228:231], a[120:123], a[0:3], 0
    ds_read_b64_tr_b16 a[240:241], v74 offset:16384
    ds_read_b64_tr_b16 a[242:243], v74 offset:17408
    v_mfma_f32_16x16x32_bf16 v[236:239], a[120:123], a[4:7], 0
    v_mul_f32 v135, s54, v135
    v_mul_f32 v136, s54, v136
    v_mul_f32 v137, s54, v137
    v_mfma_f32_16x16x32_bf16 v[228:231], a[124:127], a[8:11], v[228:231]
    ds_read_b64_tr_b16 a[244:245], v74 offset:24576
    ds_read_b64_tr_b16 a[246:247], v74 offset:25600
    v_mfma_f32_16x16x32_bf16 v[236:239], a[124:127], a[12:15], v[236:239]
    s_add_u32 m0, s48, 0
    s_nop 0
    buffer_load_dwordx4 v26, s[8:11], s61 offen offset:2048 nt lds
    s_waitcnt lgkmcnt(12)
    v_mfma_f32_16x16x32_bf16 v[240:243], a[128:131], a[0:3], 0
    ds_read_b64_tr_b16 a[248:249], v75 offset:16384
    ds_read_b64_tr_b16 a[250:251], v75 offset:17408
    v_mfma_f32_16x16x32_bf16 v[248:251], a[128:131], a[4:7], 0
    v_mul_f32 v138, s54, v138
    v_mul_f32 v139, s54, v139
    v_mfma_f32_16x16x32_bf16 v[240:243], a[132:135], a[8:11], v[240:243]
    ds_read_b64_tr_b16 a[252:253], v75 offset:24576
    ds_read_b64_tr_b16 a[254:255], v75 offset:25600
    v_mfma_f32_16x16x32_bf16 v[248:251], a[132:135], a[12:15], v[248:251]
    v_mul_f32 v140, s54, v140
    v_mul_f32 v141, s54, v141
    v_mul_f32 v142, s54, v142
    v_mfma_f32_16x16x32_bf16 v[244:247], a[136:139], a[0:3], 0
    ds_read_b64_tr_b16 a[112:113], v76 offset:16384
    ds_read_b64_tr_b16 a[114:115], v76 offset:17408
    v_mfma_f32_16x16x32_bf16 v[252:255], a[136:139], a[4:7], 0
    v_mul_f32 v143, s54, v143
    v_cvt_pk_bf16_f32 v128, v128, v129
    v_mfma_f32_16x16x32_bf16 v[244:247], a[140:143], a[8:11], v[244:247]
    ds_read_b64_tr_b16 a[116:117], v76 offset:24576
    ds_read_b64_tr_b16 a[118:119], v76 offset:25600
    v_mfma_f32_16x16x32_bf16 v[252:255], a[140:143], a[12:15], v[252:255]
    v_cvt_pk_bf16_f32 v129, v130, v131
    v_cvt_pk_bf16_f32 v130, v132, v133
    s_waitcnt lgkmcnt(12)
    v_mfma_f32_16x16x32_bf16 v[192:195], a[224:227], a[16:19], v[192:195]
    ds_read_b64_tr_b16 a[120:121], v77 offset:16384
    ds_read_b64_tr_b16 a[122:123], v77 offset:17408
    v_mfma_f32_16x16x32_bf16 v[200:203], a[224:227], a[20:23], v[200:203]
    v_cvt_pk_bf16_f32 v131, v134, v135
    v_cvt_pk_bf16_f32 v136, v136, v137
    v_mfma_f32_16x16x32_bf16 v[192:195], a[228:231], a[24:27], v[192:195]
    ds_read_b64_tr_b16 a[124:125], v77 offset:24576
    ds_read_b64_tr_b16 a[126:127], v77 offset:25600
    v_mfma_f32_16x16x32_bf16 v[200:203], a[228:231], a[28:31], v[200:203]
    v_cvt_pk_bf16_f32 v137, v138, v139
    s_add_u32 m0, s48, 0
    s_nop 0
    buffer_load_dwordx4 v27, s[8:11], s61 offen offset:3072 nt lds
    v_mfma_f32_16x16x32_bf16 v[196:199], a[232:235], a[16:19], v[196:199]
    ds_read_b64_tr_b16 a[128:129], v78 offset:16384
    ds_read_b64_tr_b16 a[130:131], v78 offset:17408
    v_mfma_f32_16x16x32_bf16 v[204:207], a[232:235], a[20:23], v[204:207]
    v_cvt_pk_bf16_f32 v138, v140, v141
    v_cvt_pk_bf16_f32 v139, v142, v143
    v_mfma_f32_16x16x32_bf16 v[196:199], a[236:239], a[24:27], v[196:199]
    ds_read_b64_tr_b16 a[132:133], v78 offset:24576
    ds_read_b64_tr_b16 a[134:135], v78 offset:25600
    v_mfma_f32_16x16x32_bf16 v[204:207], a[236:239], a[28:31], v[204:207]
    v_permlane16_swap_b32 v128, v130
    v_permlane16_swap_b32 v129, v131
    s_waitcnt lgkmcnt(12)
    v_mfma_f32_16x16x32_bf16 v[208:211], a[240:243], a[16:19], v[208:211]
    ds_read_b64_tr_b16 a[136:137], v79 offset:16384
    ds_read_b64_tr_b16 a[138:139], v79 offset:17408
    v_mfma_f32_16x16x32_bf16 v[216:219], a[240:243], a[20:23], v[216:219]
    v_permlane16_swap_b32 v136, v138
    v_permlane16_swap_b32 v137, v139
    v_mfma_f32_16x16x32_bf16 v[208:211], a[244:247], a[24:27], v[208:211]
    ds_read_b64_tr_b16 a[140:141], v79 offset:24576
    ds_read_b64_tr_b16 a[142:143], v79 offset:25600
    v_mfma_f32_16x16x32_bf16 v[216:219], a[244:247], a[28:31], v[216:219]
    v_accvgpr_write_b32 a160, v128
    v_accvgpr_write_b32 a161, v129
    v_accvgpr_write_b32 a162, v130
    v_mfma_f32_16x16x32_bf16 v[212:215], a[248:251], a[16:19], v[212:215]
    s_waitcnt vmcnt(20)
    s_barrier
    ds_read_b64_tr_b16 a[224:225], v64 offset:49152
    ds_read_b64_tr_b16 a[226:227], v64 offset:50176
    v_mfma_f32_16x16x32_bf16 v[220:223], a[248:251], a[20:23], v[220:223]
    s_add_u32 m0, s48, 16384
    s_mov_b32 s61, 16384
    buffer_load_dwordx4 v26, s[8:11], s61 offen nt lds
    v_mfma_f32_16x16x32_bf16 v[212:215], a[252:255], a[24:27], v[212:215]
    ds_read_b64_tr_b16 a[228:229], v64 offset:57344
    ds_read_b64_tr_b16 a[230:231], v64 offset:58368
    v_mfma_f32_16x16x32_bf16 v[220:223], a[252:255], a[28:31], v[220:223]
    v_accvgpr_write_b32 a163, v131
    s_waitcnt lgkmcnt(12)
    v_mfma_f32_16x16x32_bf16 v[224:227], a[112:115], a[16:19], v[224:227]
    ds_read_b64_tr_b16 a[232:233], v65 offset:49152
    ds_read_b64_tr_b16 a[234:235], v65 offset:50176
    v_mfma_f32_16x16x32_bf16 v[232:235], a[112:115], a[20:23], v[232:235]
    v_accvgpr_write_b32 a164, v136
    v_accvgpr_write_b32 a165, v137
    v_accvgpr_write_b32 a166, v138
    v_mfma_f32_16x16x32_bf16 v[224:227], a[116:119], a[24:27], v[224:227]
    ds_read_b64_tr_b16 a[236:237], v65 offset:57344
    ds_read_b64_tr_b16 a[238:239], v65 offset:58368
    v_mfma_f32_16x16x32_bf16 v[232:235], a[116:119], a[28:31], v[232:235]
    v_accvgpr_write_b32 a167, v139
    v_mul_f32 v144, s54, v144
    v_mfma_f32_16x16x32_bf16 v[228:231], a[120:123], a[16:19], v[228:231]
    ds_read_b64_tr_b16 a[240:241], v66 offset:49152
    ds_read_b64_tr_b16 a[242:243], v66 offset:50176
    v_mfma_f32_16x16x32_bf16 v[236:239], a[120:123], a[20:23], v[236:239]
    v_mul_f32 v145, s54, v145
    v_mul_f32 v146, s54, v146
    v_mfma_f32_16x16x32_bf16 v[228:231], a[124:127], a[24:27], v[228:231]
    ds_read_b64_tr_b16 a[244:245], v66 offset:57344
    ds_read_b64_tr_b16 a[246:247], v66 offset:58368
    v_mfma_f32_16x16x32_bf16 v[236:239], a[124:127], a[28:31], v[236:239]
    v_mul_f32 v147, s54, v147
    v_mul_f32 v148, s54, v148
    s_waitcnt lgkmcnt(12)
    v_mfma_f32_16x16x32_bf16 v[240:243], a[128:131], a[16:19], v[240:243]
    ds_read_b64_tr_b16 a[248:249], v67 offset:49152
    ds_read_b64_tr_b16 a[250:251], v67 offset:50176
    v_mfma_f32_16x16x32_bf16 v[248:251], a[128:131], a[20:23], v[248:251]
    s_add_u32 m0, s48, 16384
    s_nop 0
    buffer_load_dwordx4 v27, s[8:11], s61 offen offset:1024 nt lds
    v_mfma_f32_16x16x32_bf16 v[240:243], a[132:135], a[24:27], v[240:243]
    ds_read_b64_tr_b16 a[252:253], v67 offset:57344
    ds_read_b64_tr_b16 a[254:255], v67 offset:58368
    v_mfma_f32_16x16x32_bf16 v[248:251], a[132:135], a[28:31], v[248:251]
    v_mul_f32 v149, s54, v149
    v_mul_f32 v150, s54, v150
    v_mul_f32 v151, s54, v151
    v_mfma_f32_16x16x32_bf16 v[244:247], a[136:139], a[16:19], v[244:247]
    ds_read_b64_tr_b16 a[112:113], v68 offset:49152
    ds_read_b64_tr_b16 a[114:115], v68 offset:50176
    v_mfma_f32_16x16x32_bf16 v[252:255], a[136:139], a[20:23], v[252:255]
    v_mul_f32 v152, s54, v152
    v_mul_f32 v153, s54, v153
    v_mfma_f32_16x16x32_bf16 v[244:247], a[140:143], a[24:27], v[244:247]
    ds_read_b64_tr_b16 a[116:117], v68 offset:57344
    ds_read_b64_tr_b16 a[118:119], v68 offset:58368
    v_mfma_f32_16x16x32_bf16 v[252:255], a[140:143], a[28:31], v[252:255]
    v_mul_f32 v154, s54, v154
    v_mul_f32 v155, s54, v155
    s_waitcnt lgkmcnt(12)
    v_mfma_f32_16x16x32_bf16 v[192:195], a[224:227], a[32:35], v[192:195]
    ds_read_b64_tr_b16 a[120:121], v69 offset:49152
    ds_read_b64_tr_b16 a[122:123], v69 offset:50176
    v_mfma_f32_16x16x32_bf16 v[200:203], a[224:227], a[36:39], v[200:203]
    v_mul_f32 v156, s54, v156
    v_mul_f32 v157, s54, v157
    v_mfma_f32_16x16x32_bf16 v[192:195], a[228:231], a[40:43], v[192:195]
    ds_read_b64_tr_b16 a[124:125], v69 offset:57344
    ds_read_b64_tr_b16 a[126:127], v69 offset:58368
    v_mfma_f32_16x16x32_bf16 v[200:203], a[228:231], a[44:47], v[200:203]
    v_mul_f32 v158, s54, v158
    v_mul_f32 v159, s54, v159
    v_cvt_pk_bf16_f32 v144, v144, v145
    v_mfma_f32_16x16x32_bf16 v[196:199], a[232:235], a[32:35], v[196:199]
    ds_read_b64_tr_b16 a[128:129], v70 offset:49152
    ds_read_b64_tr_b16 a[130:131], v70 offset:50176
    v_mfma_f32_16x16x32_bf16 v[204:207], a[232:235], a[36:39], v[204:207]
    s_add_u32 m0, s48, 16384
    s_nop 0
    buffer_load_dwordx4 v26, s[8:11], s61 offen offset:2048 nt lds
    v_mfma_f32_16x16x32_bf16 v[196:199], a[236:239], a[40:43], v[196:199]
    ds_read_b64_tr_b16 a[132:133], v70 offset:57344
    ds_read_b64_tr_b16 a[134:135], v70 offset:58368
    v_mfma_f32_16x16x32_bf16 v[204:207], a[236:239], a[44:47], v[204:207]
    v_cvt_pk_bf16_f32 v145, v146, v147
    v_cvt_pk_bf16_f32 v146, v148, v149
    s_waitcnt lgkmcnt(12)
    v_mfma_f32_16x16x32_bf16 v[208:211], a[240:243], a[32:35], v[208:211]
    ds_read_b64_tr_b16 a[136:137], v71 offset:49152
    ds_read_b64_tr_b16 a[138:139], v71 offset:50176
    v_mfma_f32_16x16x32_bf16 v[216:219], a[240:243], a[36:39], v[216:219]
    v_cvt_pk_bf16_f32 v147, v150, v151
    v_cvt_pk_bf16_f32 v152, v152, v153
    v_mfma_f32_16x16x32_bf16 v[208:211], a[244:247], a[40:43], v[208:211]
    ds_read_b64_tr_b16 a[140:141], v71 offset:57344
    ds_read_b64_tr_b16 a[142:143], v71 offset:58368
    v_mfma_f32_16x16x32_bf16 v[216:219], a[244:247], a[44:47], v[216:219]
    v_cvt_pk_bf16_f32 v153, v154, v155
    v_cvt_pk_bf16_f32 v154, v156, v157
    v_cvt_pk_bf16_f32 v155, v158, v159
    v_mfma_f32_16x16x32_bf16 v[212:215], a[248:251], a[32:35], v[212:215]
    s_waitcnt vmcnt(19)
    s_barrier
    v_mfma_f32_16x16x32_bf16 v[220:223], a[248:251], a[36:39], v[220:223]
    ds_read_b64_tr_b16 a[224:225], v72 offset:32768
    ds_read_b64_tr_b16 a[226:227], v72 offset:33792
    v_mfma_f32_16x16x32_bf16 v[212:215], a[252:255], a[40:43], v[212:215]
    ds_read_b64_tr_b16 a[228:229], v72 offset:40960
    ds_read_b64_tr_b16 a[230:231], v72 offset:41984
    v_mfma_f32_16x16x32_bf16 v[220:223], a[252:255], a[44:47], v[220:223]
    v_permlane16_swap_b32 v144, v146
    v_permlane16_swap_b32 v145, v147
    s_waitcnt lgkmcnt(12)
    v_mfma_f32_16x16x32_bf16 v[224:227], a[112:115], a[32:35], v[224:227]
    ds_read_b64_tr_b16 a[232:233], v73 offset:32768
    ds_read_b64_tr_b16 a[234:235], v73 offset:33792
    v_mfma_f32_16x16x32_bf16 v[232:235], a[112:115], a[36:39], v[232:235]
    s_add_u32 m0, s48, 16384
    s_nop 0
    buffer_load_dwordx4 v27, s[8:11], s61 offen offset:3072 nt lds
    v_mfma_f32_16x16x32_bf16 v[224:227], a[116:119], a[40:43], v[224:227]
    ds_read_b64_tr_b16 a[236:237], v73 offset:40960
    ds_read_b64_tr_b16 a[238:239], v73 offset:41984
    v_mfma_f32_16x16x32_bf16 v[232:235], a[116:119], a[44:47], v[232:235]
    v_permlane16_swap_b32 v152, v154
    v_permlane16_swap_b32 v153, v155
    v_accvgpr_write_b32 a168, v144
    v_mfma_f32_16x16x32_bf16 v[228:231], a[120:123], a[32:35], v[228:231]
    ds_read_b64_tr_b16 a[240:241], v74 offset:32768
    ds_read_b64_tr_b16 a[242:243], v74 offset:33792
    v_mfma_f32_16x16x32_bf16 v[236:239], a[120:123], a[36:39], v[236:239]
    v_accvgpr_write_b32 a169, v145
    v_accvgpr_write_b32 a170, v146
    v_mfma_f32_16x16x32_bf16 v[228:231], a[124:127], a[40:43], v[228:231]
    ds_read_b64_tr_b16 a[244:245], v74 offset:40960
    ds_read_b64_tr_b16 a[246:247], v74 offset:41984
    v_mfma_f32_16x16x32_bf16 v[236:239], a[124:127], a[44:47], v[236:239]
    v_accvgpr_write_b32 a171, v147
    v_accvgpr_write_b32 a172, v152
    s_waitcnt lgkmcnt(12)
    v_mfma_f32_16x16x32_bf16 v[240:243], a[128:131], a[32:35], v[240:243]
    ds_read_b64_tr_b16 a[248:249], v75 offset:32768
    ds_read_b64_tr_b16 a[250:251], v75 offset:33792
    v_mfma_f32_16x16x32_bf16 v[248:251], a[128:131], a[36:39], v[248:251]
    v_accvgpr_write_b32 a173, v153
    v_accvgpr_write_b32 a174, v154
    v_mfma_f32_16x16x32_bf16 v[240:243], a[132:135], a[40:43], v[240:243]
    ds_read_b64_tr_b16 a[252:253], v75 offset:40960
    ds_read_b64_tr_b16 a[254:255], v75 offset:41984
    v_mfma_f32_16x16x32_bf16 v[248:251], a[132:135], a[44:47], v[248:251]
    s_add_u32 m0, s48, 65536
    s_mov_b32 s61, 0
    buffer_load_dwordx4 v28, s[12:15], s61 offen nt lds
    v_mfma_f32_16x16x32_bf16 v[244:247], a[136:139], a[32:35], v[244:247]
    ds_read_b64_tr_b16 a[112:113], v76 offset:32768
    ds_read_b64_tr_b16 a[114:115], v76 offset:33792
    v_mfma_f32_16x16x32_bf16 v[252:255], a[136:139], a[36:39], v[252:255]
    v_accvgpr_write_b32 a175, v155
    v_mul_f32 v160, s54, v160
    v_mfma_f32_16x16x32_bf16 v[244:247], a[140:143], a[40:43], v[244:247]
    ds_read_b64_tr_b16 a[116:117], v76 offset:40960
    ds_read_b64_tr_b16 a[118:119], v76 offset:41984
    v_mfma_f32_16x16x32_bf16 v[252:255], a[140:143], a[44:47], v[252:255]
    v_mul_f32 v161, s54, v161
    v_mul_f32 v162, s54, v162
    s_waitcnt lgkmcnt(12)
    v_mfma_f32_16x16x32_bf16 v[192:195], a[224:227], a[48:51], v[192:195]
    ds_read_b64_tr_b16 a[120:121], v77 offset:32768
    ds_read_b64_tr_b16 a[122:123], v77 offset:33792
    v_mfma_f32_16x16x32_bf16 v[200:203], a[224:227], a[52:55], v[200:203]
    v_mul_f32 v163, s54, v163
    v_mul_f32 v164, s54, v164
    v_mfma_f32_16x16x32_bf16 v[192:195], a[228:231], a[56:59], v[192:195]
    ds_read_b64_tr_b16 a[124:125], v77 offset:40960
    ds_read_b64_tr_b16 a[126:127], v77 offset:41984
    v_mfma_f32_16x16x32_bf16 v[200:203], a[228:231], a[60:63], v[200:203]
    v_mul_f32 v165, s54, v165
    v_mul_f32 v166, s54, v166
    v_mul_f32 v167, s54, v167
    v_mfma_f32_16x16x32_bf16 v[196:199], a[232:235], a[48:51], v[196:199]
    ds_read_b64_tr_b16 a[128:129], v78 offset:32768
    ds_read_b64_tr_b16 a[130:131], v78 offset:33792
    v_mfma_f32_16x16x32_bf16 v[204:207], a[232:235], a[52:55], v[204:207]
    v_mul_f32 v168, s54, v168
    v_mul_f32 v169, s54, v169
    v_mfma_f32_16x16x32_bf16 v[196:199], a[236:239], a[56:59], v[196:199]
    ds_read_b64_tr_b16 a[132:133], v78 offset:40960
    ds_read_b64_tr_b16 a[134:135], v78 offset:41984
    v_mfma_f32_16x16x32_bf16 v[204:207], a[236:239], a[60:63], v[204:207]
    s_add_u32 m0, s48, 65536
    s_nop 0
    buffer_load_dwordx4 v29, s[12:15], s61 offen offset:1024 nt lds
    s_waitcnt lgkmcnt(12)
    v_mfma_f32_16x16x32_bf16 v[208:211], a[240:243], a[48:51], v[208:211]
    ds_read_b64_tr_b16 a[136:137], v79 offset:32768
    ds_read_b64_tr_b16 a[138:139], v79 offset:33792
    v_mfma_f32_16x16x32_bf16 v[216:219], a[240:243], a[52:55], v[216:219]
    v_mul_f32 v170, s54, v170
    v_mul_f32 v171, s54, v171
    v_mul_f32 v172, s54, v172
    v_mfma_f32_16x16x32_bf16 v[208:211], a[244:247], a[56:59], v[208:211]
    ds_read_b64_tr_b16 a[140:141], v79 offset:40960
    ds_read_b64_tr_b16 a[142:143], v79 offset:41984
    v_mfma_f32_16x16x32_bf16 v[216:219], a[244:247], a[60:63], v[216:219]
    v_mul_f32 v173, s54, v173
    v_mul_f32 v174, s54, v174
    v_mfma_f32_16x16x32_bf16 v[212:215], a[248:251], a[48:51], v[212:215]
    s_waitcnt vmcnt(18)
    s_barrier
    ds_read_b64_tr_b16 a[224:225], v72 offset:49152
    v_mfma_f32_16x16x32_bf16 v[220:223], a[248:251], a[52:55], v[220:223]
    ds_read_b64_tr_b16 a[226:227], v72 offset:50176
    v_mul_f32 v175, s54, v175
    v_mfma_f32_16x16x32_bf16 v[212:215], a[252:255], a[56:59], v[212:215]
    ds_read_b64_tr_b16 a[228:229], v72 offset:57344
    ds_read_b64_tr_b16 a[230:231], v72 offset:58368
    v_mfma_f32_16x16x32_bf16 v[220:223], a[252:255], a[60:63], v[220:223]
    v_cvt_pk_bf16_f32 v160, v160, v161
    s_waitcnt lgkmcnt(12)
    v_mfma_f32_16x16x32_bf16 v[224:227], a[112:115], a[48:51], v[224:227]
    ds_read_b64_tr_b16 a[232:233], v73 offset:49152
    ds_read_b64_tr_b16 a[234:235], v73 offset:50176
    v_mfma_f32_16x16x32_bf16 v[232:235], a[112:115], a[52:55], v[232:235]
    v_cvt_pk_bf16_f32 v161, v162, v163
    s_add_u32 m0, s48, 65536
    s_nop 0
    buffer_load_dwordx4 v28, s[12:15], s61 offen offset:2048 nt lds
    v_mfma_f32_16x16x32_bf16 v[224:227], a[116:119], a[56:59], v[224:227]
    ds_read_b64_tr_b16 a[236:237], v73 offset:57344
    ds_read_b64_tr_b16 a[238:239], v73 offset:58368
    v_mfma_f32_16x16x32_bf16 v[232:235], a[116:119], a[60:63], v[232:235]
    v_cvt_pk_bf16_f32 v162, v164, v165
    v_cvt_pk_bf16_f32 v163, v166, v167
    v_mfma_f32_16x16x32_bf16 v[228:231], a[120:123], a[48:51], v[228:231]
    ds_read_b64_tr_b16 a[240:241], v74 offset:49152
    ds_read_b64_tr_b16 a[242:243], v74 offset:50176
    v_mfma_f32_16x16x32_bf16 v[236:239], a[120:123], a[52:55], v[236:239]
    v_cvt_pk_bf16_f32 v168, v168, v169
    v_cvt_pk_bf16_f32 v169, v170, v171
    v_cvt_pk_bf16_f32 v170, v172, v173
    v_mfma_f32_16x16x32_bf16 v[228:231], a[124:127], a[56:59], v[228:231]
    ds_read_b64_tr_b16 a[244:245], v74 offset:57344
    ds_read_b64_tr_b16 a[246:247], v74 offset:58368
    v_mfma_f32_16x16x32_bf16 v[236:239], a[124:127], a[60:63], v[236:239]
    v_cvt_pk_bf16_f32 v171, v174, v175
    s_waitcnt lgkmcnt(12)
    v_mfma_f32_16x16x32_bf16 v[240:243], a[128:131], a[48:51], v[240:243]
    ds_read_b64_tr_b16 a[248:249], v75 offset:49152
    ds_read_b64_tr_b16 a[250:251], v75 offset:50176
    v_mfma_f32_16x16x32_bf16 v[248:251], a[128:131], a[52:55], v[248:251]
    v_permlane16_swap_b32 v160, v162
    v_permlane16_swap_b32 v161, v163
    v_permlane16_swap_b32 v168, v170
    v_mfma_f32_16x16x32_bf16 v[240:243], a[132:135], a[56:59], v[240:243]
    ds_read_b64_tr_b16 a[252:253], v75 offset:57344
    ds_read_b64_tr_b16 a[254:255], v75 offset:58368
    v_mfma_f32_16x16x32_bf16 v[248:251], a[132:135], a[60:63], v[248:251]
    v_permlane16_swap_b32 v169, v171
    v_accvgpr_write_b32 a176, v160
    v_mfma_f32_16x16x32_bf16 v[244:247], a[136:139], a[48:51], v[244:247]
    ds_read_b64_tr_b16 a[112:113], v76 offset:49152
    ds_read_b64_tr_b16 a[114:115], v76 offset:50176
    v_mfma_f32_16x16x32_bf16 v[252:255], a[136:139], a[52:55], v[252:255]
    v_accvgpr_write_b32 a177, v161
    s_add_u32 m0, s48, 65536
    s_nop 0
    buffer_load_dwordx4 v29, s[12:15], s61 offen offset:3072 nt lds
    v_mfma_f32_16x16x32_bf16 v[244:247], a[140:143], a[56:59], v[244:247]
    ds_read_b64_tr_b16 a[116:117], v76 offset:57344
    ds_read_b64_tr_b16 a[118:119], v76 offset:58368
    v_mfma_f32_16x16x32_bf16 v[252:255], a[140:143], a[60:63], v[252:255]
    v_accvgpr_write_b32 a178, v162
    s_waitcnt lgkmcnt(12)
    v_mfma_f32_16x16x32_bf16 v[192:195], a[224:227], a[64:67], v[192:195]
    ds_read_b64_tr_b16 a[120:121], v77 offset:49152
    ds_read_b64_tr_b16 a[122:123], v77 offset:50176
    v_mfma_f32_16x16x32_bf16 v[200:203], a[224:227], a[68:71], v[200:203]
    v_accvgpr_write_b32 a179, v163
    v_accvgpr_write_b32 a180, v168
    v_accvgpr_write_b32 a181, v169
    v_mfma_f32_16x16x32_bf16 v[192:195], a[228:231], a[72:75], v[192:195]
    ds_read_b64_tr_b16 a[124:125], v77 offset:57344
    ds_read_b64_tr_b16 a[126:127], v77 offset:58368
    v_mfma_f32_16x16x32_bf16 v[200:203], a[228:231], a[76:79], v[200:203]
    v_accvgpr_write_b32 a182, v170
    v_accvgpr_write_b32 a183, v171
    v_mfma_f32_16x16x32_bf16 v[196:199], a[232:235], a[64:67], v[196:199]
    ds_read_b64_tr_b16 a[128:129], v78 offset:49152
    ds_read_b64_tr_b16 a[130:131], v78 offset:50176
    v_mfma_f32_16x16x32_bf16 v[204:207], a[232:235], a[68:71], v[204:207]
    v_mul_f32 v176, s54, v176
    v_mul_f32 v177, s54, v177
    v_mfma_f32_16x16x32_bf16 v[196:199], a[236:239], a[72:75], v[196:199]
    s_add_u32 m0, s48, 32768
    s_mov_b32 s61, 32768
    buffer_load_dwordx4 v26, s[8:11], s61 offen nt lds
    v_mfma_f32_16x16x32_bf16 v[204:207], a[236:239], a[76:79], v[204:207]
    ds_read_b64_tr_b16 a[132:133], v78 offset:57344
    ds_read_b64_tr_b16 a[134:135], v78 offset:58368
    s_waitcnt lgkmcnt(12)
    v_mfma_f32_16x16x32_bf16 v[208:211], a[240:243], a[64:67], v[208:211]
    ds_read_b64_tr_b16 a[136:137], v79 offset:49152
    ds_read_b64_tr_b16 a[138:139], v79 offset:50176
    v_mfma_f32_16x16x32_bf16 v[216:219], a[240:243], a[68:71], v[216:219]
    v_mul_f32 v178, s54, v178
    v_mul_f32 v179, s54, v179
    v_mul_f32 v180, s54, v180
    v_mfma_f32_16x16x32_bf16 v[208:211], a[244:247], a[72:75], v[208:211]
    ds_read_b64_tr_b16 a[140:141], v79 offset:57344
    ds_read_b64_tr_b16 a[142:143], v79 offset:58368
    v_mfma_f32_16x16x32_bf16 v[216:219], a[244:247], a[76:79], v[216:219]
    v_mul_f32 v181, s54, v181
    v_mul_f32 v182, s54, v182
    v_mfma_f32_16x16x32_bf16 v[212:215], a[248:251], a[64:67], v[212:215]
    s_waitcnt vmcnt(13)
    s_barrier
    ds_read_b64_tr_b16 a[224:225], v80 offset:0
    v_mfma_f32_16x16x32_bf16 v[220:223], a[248:251], a[68:71], v[220:223]
    ds_read_b64_tr_b16 a[226:227], v80 offset:1024
    v_mul_f32 v183, s54, v183
    v_mfma_f32_16x16x32_bf16 v[212:215], a[252:255], a[72:75], v[212:215]
    ds_read_b64_tr_b16 a[228:229], v80 offset:8192
    ds_read_b64_tr_b16 a[230:231], v80 offset:9216
    v_mfma_f32_16x16x32_bf16 v[220:223], a[252:255], a[76:79], v[220:223]
    v_mul_f32 v184, s54, v184
    s_waitcnt lgkmcnt(12)
    v_mfma_f32_16x16x32_bf16 v[224:227], a[112:115], a[64:67], v[224:227]
    ds_read_b64_tr_b16 a[232:233], v80 offset:16384
    ds_read_b64_tr_b16 a[234:235], v80 offset:17408
    v_mfma_f32_16x16x32_bf16 v[232:235], a[112:115], a[68:71], v[232:235]
    v_mul_f32 v185, s54, v185
    v_mul_f32 v186, s54, v186
    v_mul_f32 v187, s54, v187
    v_mfma_f32_16x16x32_bf16 v[224:227], a[116:119], a[72:75], v[224:227]
    ds_read_b64_tr_b16 a[236:237], v80 offset:24576
    ds_read_b64_tr_b16 a[238:239], v80 offset:25600
    v_mfma_f32_16x16x32_bf16 v[232:235], a[116:119], a[76:79], v[232:235]
    s_add_u32 m0, s48, 32768
    s_nop 0
    buffer_load_dwordx4 v27, s[8:11], s61 offen offset:1024 nt lds
    v_mfma_f32_16x16x32_bf16 v[228:231], a[120:123], a[64:67], v[228:231]
    ds_read_b64_tr_b16 a[240:241], v81 offset:0
    ds_read_b64_tr_b16 a[242:243], v81 offset:1024
    v_mfma_f32_16x16x32_bf16 v[236:239], a[120:123], a[68:71], v[236:239]
    v_mul_f32 v188, s54, v188
    v_mul_f32 v189, s54, v189
    v_mul_f32 v190, s54, v190
    v_mfma_f32_16x16x32_bf16 v[228:231], a[124:127], a[72:75], v[228:231]
    ds_read_b64_tr_b16 a[244:245], v81 offset:8192
    ds_read_b64_tr_b16 a[246:247], v81 offset:9216
    v_mfma_f32_16x16x32_bf16 v[236:239], a[124:127], a[76:79], v[236:239]
    v_mul_f32 v191, s54, v191
    s_waitcnt lgkmcnt(12)
    v_mfma_f32_16x16x32_bf16 v[240:243], a[128:131], a[64:67], v[240:243]
    ds_read_b64_tr_b16 a[248:249], v81 offset:16384
    ds_read_b64_tr_b16 a[250:251], v81 offset:17408
    v_mfma_f32_16x16x32_bf16 v[248:251], a[128:131], a[68:71], v[248:251]
    v_cvt_pk_bf16_f32 v176, v176, v177
    v_cvt_pk_bf16_f32 v177, v178, v179
    v_cvt_pk_bf16_f32 v178, v180, v181
    v_mfma_f32_16x16x32_bf16 v[240:243], a[132:135], a[72:75], v[240:243]
    ds_read_b64_tr_b16 a[252:253], v81 offset:24576
    ds_read_b64_tr_b16 a[254:255], v81 offset:25600
    v_mfma_f32_16x16x32_bf16 v[248:251], a[132:135], a[76:79], v[248:251]
    v_cvt_pk_bf16_f32 v179, v182, v183
    v_cvt_pk_bf16_f32 v184, v184, v185
    v_mfma_f32_16x16x32_bf16 v[244:247], a[136:139], a[64:67], v[244:247]
    ds_read_b64_tr_b16 a[112:113], v82 offset:0
    ds_read_b64_tr_b16 a[114:115], v82 offset:1024
    v_mfma_f32_16x16x32_bf16 v[252:255], a[136:139], a[68:71], v[252:255]
    v_cvt_pk_bf16_f32 v185, v186, v187
    v_cvt_pk_bf16_f32 v186, v188, v189
    v_cvt_pk_bf16_f32 v187, v190, v191
    v_mfma_f32_16x16x32_bf16 v[244:247], a[140:143], a[72:75], v[244:247]
    ds_read_b64_tr_b16 a[116:117], v82 offset:8192
    ds_read_b64_tr_b16 a[118:119], v82 offset:9216
    v_mfma_f32_16x16x32_bf16 v[252:255], a[140:143], a[76:79], v[252:255]
    s_add_u32 m0, s48, 32768
    s_nop 0
    buffer_load_dwordx4 v26, s[8:11], s61 offen offset:2048 nt lds
    s_waitcnt lgkmcnt(12)
    v_mfma_f32_16x16x32_bf16 v[192:195], a[224:227], a[80:83], v[192:195]
    ds_read_b64_tr_b16 a[120:121], v82 offset:16384
    ds_read_b64_tr_b16 a[122:123], v82 offset:17408
    v_mfma_f32_16x16x32_bf16 v[200:203], a[224:227], a[84:87], v[200:203]
    v_permlane16_swap_b32 v176, v178
    v_permlane16_swap_b32 v177, v179
    v_mfma_f32_16x16x32_bf16 v[192:195], a[228:231], a[88:91], v[192:195]
    ds_read_b64_tr_b16 a[124:125], v82 offset:24576
    ds_read_b64_tr_b16 a[126:127], v82 offset:25600
    v_mfma_f32_16x16x32_bf16 v[200:203], a[228:231], a[92:95], v[200:203]
    v_permlane16_swap_b32 v184, v186
    v_permlane16_swap_b32 v185, v187
    v_accvgpr_write_b32 a184, v176
    v_mfma_f32_16x16x32_bf16 v[192:195], a[232:235], a[96:99], v[192:195]
    ds_read_b64_tr_b16 a[128:129], v83 offset:0
    ds_read_b64_tr_b16 a[130:131], v83 offset:1024
    v_mfma_f32_16x16x32_bf16 v[200:203], a[232:235], a[100:103], v[200:203]
    v_accvgpr_write_b32 a185, v177
    v_accvgpr_write_b32 a186, v178
    v_mfma_f32_16x16x32_bf16 v[192:195], a[236:239], a[104:107], v[192:195]
    ds_read_b64_tr_b16 a[132:133], v83 offset:8192
    ds_read_b64_tr_b16 a[134:135], v83 offset:9216
    v_mfma_f32_16x16x32_bf16 v[200:203], a[236:239], a[108:111], v[200:203]
    v_accvgpr_write_b32 a187, v179
    v_accvgpr_write_b32 a188, v184
    s_waitcnt lgkmcnt(12)
    v_mfma_f32_16x16x32_bf16 v[196:199], a[240:243], a[80:83], v[196:199]
    ds_read_b64_tr_b16 a[136:137], v83 offset:16384
    ds_read_b64_tr_b16 a[138:139], v83 offset:17408
    v_mfma_f32_16x16x32_bf16 v[204:207], a[240:243], a[84:87], v[204:207]
    v_accvgpr_write_b32 a189, v185
    v_accvgpr_write_b32 a190, v186
    v_mfma_f32_16x16x32_bf16 v[196:199], a[244:247], a[88:91], v[196:199]
    ds_read_b64_tr_b16 a[140:141], v83 offset:24576
    ds_read_b64_tr_b16 a[142:143], v83 offset:25600
    v_mfma_f32_16x16x32_bf16 v[204:207], a[244:247], a[92:95], v[204:207]
    v_accvgpr_write_b32 a191, v187
    s_add_u32 m0, s48, 32768
    s_nop 0
    buffer_load_dwordx4 v27, s[8:11], s61 offen offset:3072 nt lds
    v_mfma_f32_16x16x32_bf16 v[196:199], a[248:251], a[96:99], v[196:199]
    s_barrier
    v_mfma_f32_16x16x32_bf16 v[204:207], a[248:251], a[100:103], v[204:207]
    ds_read_b64_tr_b16 a[224:225], v84 offset:0
    ds_read_b64_tr_b16 a[226:227], v84 offset:1024
    v_mfma_f32_16x16x32_bf16 v[196:199], a[252:255], a[104:107], v[196:199]
    ds_read_b64_tr_b16 a[228:229], v84 offset:8192
    ds_read_b64_tr_b16 a[230:231], v84 offset:9216
    v_mfma_f32_16x16x32_bf16 v[204:207], a[252:255], a[108:111], v[204:207]
    s_waitcnt lgkmcnt(12)
    v_mfma_f32_16x16x32_bf16 v[208:211], a[112:115], a[80:83], v[208:211]
    ds_read_b64_tr_b16 a[232:233], v84 offset:16384
    v_mfma_f32_16x16x32_bf16 v[216:219], a[112:115], a[84:87], v[216:219]
    ds_read_b64_tr_b16 a[234:235], v84 offset:17408
    v_mfma_f32_16x16x32_bf16 v[208:211], a[116:119], a[88:91], v[208:211]
    ds_read_b64_tr_b16 a[236:237], v84 offset:24576
    ds_read_b64_tr_b16 a[238:239], v84 offset:25600
    v_mul_f32 v192, s54, v192
    v_mfma_f32_16x16x32_bf16 v[216:219], a[116:119], a[92:95], v[216:219]
    v_mul_f32 v193, s54, v193
    v_mul_f32 v194, s54, v194
    v_mul_f32 v195, s54, v195
    v_mfma_f32_16x16x32_bf16 v[208:211], a[120:123], a[96:99], v[208:211]
    ds_read_b64_tr_b16 a[240:241], v85 offset:0
    ds_read_b64_tr_b16 a[242:243], v85 offset:1024
    v_mul_f32 v196, s54, v196
    v_mfma_f32_16x16x32_bf16 v[216:219], a[120:123], a[100:103], v[216:219]
    s_add_u32 m0, s48, 81920
    s_mov_b32 s61, 16384
    buffer_load_dwordx4 v28, s[12:15], s61 offen nt lds
    v_mfma_f32_16x16x32_bf16 v[208:211], a[124:127], a[104:107], v[208:211]
    ds_read_b64_tr_b16 a[244:245], v85 offset:8192
    ds_read_b64_tr_b16 a[246:247], v85 offset:9216
    v_mul_f32 v197, s54, v197
    v_mfma_f32_16x16x32_bf16 v[216:219], a[124:127], a[108:111], v[216:219]
    v_mul_f32 v198, s54, v198
    v_mul_f32 v199, s54, v199
    s_waitcnt lgkmcnt(12)
    v_mfma_f32_16x16x32_bf16 v[212:215], a[128:131], a[80:83], v[212:215]
    ds_read_b64_tr_b16 a[248:249], v85 offset:16384
    ds_read_b64_tr_b16 a[250:251], v85 offset:17408
    v_mul_f32 v200, s54, v200
L_pg3:
    s_cbranch_execz L_pgr1
    v_mfma_f32_16x16x32_bf16 v[220:223], a[128:131], a[84:87], v[220:223]
    v_mul_f32 v201, s54, v201
    v_mul_f32 v202, s54, v202
    v_mul_f32 v203, s54, v203
    v_mfma_f32_16x16x32_bf16 v[212:215], a[132:135], a[88:91], v[212:215]
    ds_read_b64_tr_b16 a[252:253], v85 offset:24576
    ds_read_b64_tr_b16 a[254:255], v85 offset:25600
    v_mul_f32 v204, s54, v204
    v_mfma_f32_16x16x32_bf16 v[220:223], a[132:135], a[92:95], v[220:223]
    v_mul_f32 v205, s54, v205
    v_mul_f32 v206, s54, v206
    v_mul_f32 v207, s54, v207
    v_mfma_f32_16x16x32_bf16 v[212:215], a[136:139], a[96:99], v[212:215]
    ds_read_b64_tr_b16 a[112:113], v86 offset:0
    ds_read_b64_tr_b16 a[114:115], v86 offset:1024
    v_cvt_pk_bf16_f32 v192, v192, v193
    v_mfma_f32_16x16x32_bf16 v[220:223], a[136:139], a[100:103], v[220:223]
    v_cvt_pk_bf16_f32 v193, v194, v195
    v_cvt_pk_bf16_f32 v194, v196, v197
    v_cvt_pk_bf16_f32 v195, v198, v199
    v_mfma_f32_16x16x32_bf16 v[212:215], a[140:143], a[104:107], v[212:215]
    ds_read_b64_tr_b16 a[116:117], v86 offset:8192
    ds_read_b64_tr_b16 a[118:119], v86 offset:9216
    v_cvt_pk_bf16_f32 v200, v200, v201
    v_mfma_f32_16x16x32_bf16 v[220:223], a[140:143], a[108:111], v[220:223]
    v_cvt_pk_bf16_f32 v201, v202, v203
    v_cvt_pk_bf16_f32 v202, v204, v205
    s_waitcnt lgkmcnt(12)
    v_mfma_f32_16x16x32_bf16 v[224:227], a[224:227], a[80:83], v[224:227]
    ds_read_b64_tr_b16 a[120:121], v86 offset:16384
    ds_read_b64_tr_b16 a[122:123], v86 offset:17408
    v_cvt_pk_bf16_f32 v203, v206, v207
    v_mfma_f32_16x16x32_bf16 v[232:235], a[224:227], a[84:87], v[232:235]
    v_permlane16_swap_b32 v192, v194
    s_add_u32 m0, s48, 81920
    s_nop 0
    buffer_load_dwordx4 v29, s[12:15], s61 offen offset:1024 nt lds
    v_mfma_f32_16x16x32_bf16 v[224:227], a[228:231], a[88:91], v[224:227]
    ds_read_b64_tr_b16 a[124:125], v86 offset:24576
    ds_read_b64_tr_b16 a[126:127], v86 offset:25600
    v_permlane16_swap_b32 v193, v195
    v_mfma_f32_16x16x32_bf16 v[232:235], a[228:231], a[92:95], v[232:235]
    v_permlane16_swap_b32 v200, v202
    v_permlane16_swap_b32 v201, v203
    v_accvgpr_write_b32 a192, v192
    v_mfma_f32_16x16x32_bf16 v[224:227], a[232:235], a[96:99], v[224:227]
    ds_read_b64_tr_b16 a[128:129], v87 offset:0
    ds_read_b64_tr_b16 a[130:131], v87 offset:1024
    v_accvgpr_write_b32 a193, v193
    v_mfma_f32_16x16x32_bf16 v[232:235], a[232:235], a[100:103], v[232:235]
    v_accvgpr_write_b32 a194, v194
    v_accvgpr_write_b32 a195, v195
    v_accvgpr_write_b32 a196, v200
    v_mfma_f32_16x16x32_bf16 v[224:227], a[236:239], a[104:107], v[224:227]
    ds_read_b64_tr_b16 a[132:133], v87 offset:8192
    ds_read_b64_tr_b16 a[134:135], v87 offset:9216
    v_accvgpr_write_b32 a197, v201
    v_mfma_f32_16x16x32_bf16 v[232:235], a[236:239], a[108:111], v[232:235]
    v_accvgpr_write_b32 a198, v202
    v_accvgpr_write_b32 a199, v203
    s_waitcnt lgkmcnt(12)
    v_mfma_f32_16x16x32_bf16 v[228:231], a[240:243], a[80:83], v[228:231]
    ds_read_b64_tr_b16 a[136:137], v87 offset:16384
    ds_read_b64_tr_b16 a[138:139], v87 offset:17408
    v_mul_f32 v208, s54, v208
    v_mul_f32 v209, s54, v209
    v_mul_f32 v210, s54, v210
    v_mfma_f32_16x16x32_bf16 v[236:239], a[240:243], a[84:87], v[236:239]
    v_mul_f32 v211, s54, v211
    v_mul_f32 v212, s54, v212
    v_mul_f32 v213, s54, v213
    v_mul_f32 v214, s54, v214
    v_mul_f32 v215, s54, v215
    v_mfma_f32_16x16x32_bf16 v[228:231], a[244:247], a[88:91], v[228:231]
    ds_read_b64_tr_b16 a[140:141], v87 offset:24576
    ds_read_b64_tr_b16 a[142:143], v87 offset:25600
    v_mul_f32 v216, s54, v216
    s_add_u32 m0, s48, 81920
    s_nop 0
    buffer_load_dwordx4 v28, s[12:15], s61 offen offset:2048 nt lds
    v_mfma_f32_16x16x32_bf16 v[236:239], a[244:247], a[92:95], v[236:239]
    v_mul_f32 v217, s54, v217
    v_mul_f32 v218, s54, v218
    v_mul_f32 v219, s54, v219
    buffer_store_dword v50, v47, s[36:39], 0 offen sc1
    v_mfma_f32_16x16x32_bf16 v[228:231], a[248:251], a[96:99], v[228:231]
    s_waitcnt vmcnt(16)
    s_barrier
    ds_read_b128 a[224:227], v10 offset:0
    v_mul_f32 v220, s54, v220
    v_mul_f32 v221, s54, v221
    v_mfma_f32_16x16x32_bf16 v[236:239], a[248:251], a[100:103], v[236:239]
    v_mul_f32 v222, s54, v222
    v_mul_f32 v223, s54, v223
    v_cvt_pk_bf16_f32 v208, v208, v209
    v_cvt_pk_bf16_f32 v209, v210, v211
    v_cvt_pk_bf16_f32 v210, v212, v213
    v_mfma_f32_16x16x32_bf16 v[228:231], a[252:255], a[104:107], v[228:231]
    ds_read_b128 a[228:231], v10 offset:2048
    v_cvt_pk_bf16_f32 v211, v214, v215
    v_cvt_pk_bf16_f32 v216, v216, v217
    v_cvt_pk_bf16_f32 v217, v218, v219
    v_cvt_pk_bf16_f32 v218, v220, v221
    v_mfma_f32_16x16x32_bf16 v[236:239], a[252:255], a[108:111], v[236:239]
    v_cvt_pk_bf16_f32 v219, v222, v223
    v_permlane16_swap_b32 v208, v210
    v_permlane16_swap_b32 v209, v211
    v_permlane16_swap_b32 v216, v218
    s_waitcnt lgkmcnt(10)
    v_mfma_f32_16x16x32_bf16 v[240:243], a[112:115], a[80:83], v[240:243]
    ds_read_b128 a[232:235], v11 offset:0
    v_permlane16_swap_b32 v217, v219
    v_accvgpr_write_b32 a200, v208
    v_accvgpr_write_b32 a201, v209
    v_accvgpr_write_b32 a202, v210
    v_mfma_f32_16x16x32_bf16 v[248:251], a[112:115], a[84:87], v[248:251]
    v_accvgpr_write_b32 a203, v211
    v_accvgpr_write_b32 a204, v216
    v_accvgpr_write_b32 a205, v217
    v_accvgpr_write_b32 a206, v218
    v_accvgpr_write_b32 a207, v219
    v_mfma_f32_16x16x32_bf16 v[240:243], a[116:119], a[88:91], v[240:243]
    ds_read_b128 a[236:239], v11 offset:2048
    v_mul_f32 v224, s54, v224
    v_mfma_f32_16x16x32_bf16 v[248:251], a[116:119], a[92:95], v[248:251]
    v_mul_f32 v225, s54, v225
    v_mul_f32 v226, s54, v226
    v_mul_f32 v227, s54, v227
    v_mfma_f32_16x16x32_bf16 v[240:243], a[120:123], a[96:99], v[240:243]
    ds_read_b128 a[240:243], v12 offset:0
    v_mul_f32 v228, s54, v228
    v_mul_f32 v229, s54, v229
    v_mfma_f32_16x16x32_bf16 v[248:251], a[120:123], a[100:103], v[248:251]
    v_mul_f32 v230, s54, v230
    v_mul_f32 v231, s54, v231
    v_mul_f32 v232, s54, v232
    v_mfma_f32_16x16x32_bf16 v[240:243], a[124:127], a[104:107], v[240:243]
    ds_read_b128 a[244:247], v12 offset:2048
    s_add_u32 m0, s48, 81920
    s_nop 0
    buffer_load_dwordx4 v29, s[12:15], s61 offen offset:3072 nt lds
    v_mfma_f32_16x16x32_bf16 v[248:251], a[124:127], a[108:111], v[248:251]
    v_mul_f32 v233, s54, v233
    s_waitcnt lgkmcnt(6)
    v_mfma_f32_16x16x32_bf16 v[244:247], a[128:131], a[80:83], v[244:247]
    ds_read_b128 a[248:251], v13 offset:0
    v_mul_f32 v234, s54, v234
    v_mfma_f32_16x16x32_bf16 v[252:255], a[128:131], a[84:87], v[252:255]
    v_mul_f32 v235, s54, v235
    v_mul_f32 v236, s54, v236
    v_mul_f32 v237, s54, v237
    v_mfma_f32_16x16x32_bf16 v[244:247], a[132:135], a[88:91], v[244:247]
    ds_read_b128 a[252:255], v13 offset:2048
    v_mul_f32 v238, s54, v238
    v_mul_f32 v239, s54, v239
    v_mfma_f32_16x16x32_bf16 v[252:255], a[132:135], a[92:95], v[252:255]
    v_cvt_pk_bf16_f32 v224, v224, v225
    v_cvt_pk_bf16_f32 v225, v226, v227
    v_cvt_pk_bf16_f32 v226, v228, v229
    v_mfma_f32_16x16x32_bf16 v[244:247], a[136:139], a[96:99], v[244:247]
    ds_read_b128 a[112:115], v10 offset:256
    v_cvt_pk_bf16_f32 v227, v230, v231
    v_mfma_f32_16x16x32_bf16 v[252:255], a[136:139], a[100:103], v[252:255]
    v_cvt_pk_bf16_f32 v232, v232, v233
    v_cvt_pk_bf16_f32 v233, v234, v235
    v_cvt_pk_bf16_f32 v234, v236, v237
    v_mfma_f32_16x16x32_bf16 v[244:247], a[140:143], a[104:107], v[244:247]
    ds_read_b128 a[116:119], v10 offset:2304
    v_cvt_pk_bf16_f32 v235, v238, v239
    v_mfma_f32_16x16x32_bf16 v[252:255], a[140:143], a[108:111], v[252:255]
    v_permlane16_swap_b32 v224, v226
    v_permlane16_swap_b32 v225, v227
    s_waitcnt lgkmcnt(6)
    v_mfma_f32_16x16x32_bf16 v[64:67], a[224:227], a[160:163], v[112:115]
    ds_read_b128 a[120:123], v11 offset:256
    v_permlane16_swap_b32 v232, v234
    v_mfma_f32_16x16x32_bf16 v[72:75], a[224:227], a[164:167], v[116:119]
    s_add_u32 m0, s48, 49152
    s_mov_b32 s61, 49152
    buffer_load_dwordx4 v26, s[8:11], s61 offen nt lds
    v_mfma_f32_16x16x32_bf16 v[68:71], a[228:231], a[160:163], v[112:115]
    ds_read_b128 a[124:127], v11 offset:2304
    v_permlane16_swap_b32 v233, v235
    v_accvgpr_write_b32 a208, v224
    v_mfma_f32_16x16x32_bf16 v[76:79], a[228:231], a[164:167], v[116:119]
    v_accvgpr_write_b32 a209, v225
    v_accvgpr_write_b32 a210, v226
    v_accvgpr_write_b32 a211, v227
    v_mfma_f32_16x16x32_bf16 v[64:67], a[232:235], a[168:171], v[64:67]
    ds_read_b128 a[128:131], v12 offset:256
    v_accvgpr_write_b32 a212, v232
    v_mfma_f32_16x16x32_bf16 v[72:75], a[232:235], a[172:175], v[72:75]
    v_accvgpr_write_b32 a213, v233
    v_accvgpr_write_b32 a214, v234
    v_accvgpr_write_b32 a215, v235
    v_mfma_f32_16x16x32_bf16 v[68:71], a[236:239], a[168:171], v[68:71]
    ds_read_b128 a[132:135], v12 offset:2304
    v_mul_f32 v240, s54, v240
    v_mul_f32 v241, s54, v241
    v_mfma_f32_16x16x32_bf16 v[76:79], a[236:239], a[172:175], v[76:79]
    v_mul_f32 v242, s54, v242
    v_mul_f32 v243, s54, v243
    s_waitcnt lgkmcnt(6)
    v_mfma_f32_16x16x32_bf16 v[64:67], a[240:243], a[176:179], v[64:67]
    ds_read_b128 a[136:139], v13 offset:256
    s_add_u32 m0, s48, 49152
    s_nop 0
    buffer_load_dwordx4 v27, s[8:11], s61 offen offset:1024 nt lds
    v_mfma_f32_16x16x32_bf16 v[72:75], a[240:243], a[180:183], v[72:75]
    v_mul_f32 v244, s54, v244
    v_mul_f32 v245, s54, v245
    v_mfma_f32_16x16x32_bf16 v[68:71], a[244:247], a[176:179], v[68:71]
    ds_read_b128 a[140:143], v13 offset:2304
    v_mul_f32 v246, s54, v246
    v_mul_f32 v247, s54, v247
    v_mfma_f32_16x16x32_bf16 v[76:79], a[244:247], a[180:183], v[76:79]
    v_mul_f32 v248, s54, v248
    v_mul_f32 v249, s54, v249
    v_mul_f32 v250, s54, v250
    v_mfma_f32_16x16x32_bf16 v[64:67], a[248:251], a[184:187], v[64:67]
    s_waitcnt vmcnt(15)
    s_barrier
    ds_read_b128 a[224:227], v10 offset:16384
    v_mfma_f32_16x16x32_bf16 v[72:75], a[248:251], a[188:191], v[72:75]
    v_mul_f32 v251, s54, v251
    v_mul_f32 v252, s54, v252
    v_mul_f32 v253, s54, v253
    v_mfma_f32_16x16x32_bf16 v[68:71], a[252:255], a[184:187], v[68:71]
    ds_read_b128 a[228:231], v10 offset:18432
    v_mul_f32 v254, s54, v254
    v_mul_f32 v255, s54, v255
    v_mfma_f32_16x16x32_bf16 v[76:79], a[252:255], a[188:191], v[76:79]
    v_cvt_pk_bf16_f32 v240, v240, v241
    v_cvt_pk_bf16_f32 v241, v242, v243
    s_waitcnt lgkmcnt(6)
    v_mfma_f32_16x16x32_bf16 v[64:67], a[112:115], a[192:195], v[64:67]
    ds_read_b128 a[232:235], v11 offset:16384
    s_add_u32 m0, s48, 49152
    s_nop 0
    buffer_load_dwordx4 v26, s[8:11], s61 offen offset:2048 nt lds
    v_mfma_f32_16x16x32_bf16 v[72:75], a[112:115], a[196:199], v[72:75]
    v_cvt_pk_bf16_f32 v242, v244, v245
    v_cvt_pk_bf16_f32 v243, v246, v247
    v_mfma_f32_16x16x32_bf16 v[68:71], a[116:119], a[192:195], v[68:71]
    ds_read_b128 a[236:239], v11 offset:18432
    v_cvt_pk_bf16_f32 v248, v248, v249
    v_cvt_pk_bf16_f32 v249, v250, v251
    v_mfma_f32_16x16x32_bf16 v[76:79], a[116:119], a[196:199], v[76:79]
    v_cvt_pk_bf16_f32 v250, v252, v253
    v_cvt_pk_bf16_f32 v251, v254, v255
    v_permlane16_swap_b32 v240, v242
    v_mfma_f32_16x16x32_bf16 v[64:67], a[120:123], a[200:203], v[64:67]
    ds_read_b128 a[240:243], v12 offset:16384
    v_permlane16_swap_b32 v241, v243
    v_permlane16_swap_b32 v248, v250
    v_mfma_f32_16x16x32_bf16 v[72:75], a[120:123], a[204:207], v[72:75]
    v_permlane16_swap_b32 v249, v251
    v_accvgpr_write_b32 a216, v240
    v_accvgpr_write_b32 a217, v241
    v_mfma_f32_16x16x32_bf16 v[68:71], a[124:127], a[200:203], v[68:71]
    ds_read_b128 a[244:247], v12 offset:18432
    v_accvgpr_write_b32 a218, v242
    v_mfma_f32_16x16x32_bf16 v[76:79], a[124:127], a[204:207], v[76:79]
    v_accvgpr_write_b32 a219, v243
    v_accvgpr_write_b32 a220, v248
    s_waitcnt lgkmcnt(6)
    v_mfma_f32_16x16x32_bf16 v[64:67], a[128:131], a[208:211], v[64:67]
    ds_read_b128 a[248:251], v13 offset:16384
    s_add_u32 m0, s48, 49152
    s_nop 0
    buffer_load_dwordx4 v27, s[8:11], s61 offen offset:3072 nt lds
    v_mfma_f32_16x16x32_bf16 v[72:75], a[128:131], a[212:215], v[72:75]
    v_accvgpr_write_b32 a221, v249
    v_accvgpr_write_b32 a222, v250
    v_accvgpr_write_b32 a223, v251
    v_mfma_f32_16x16x32_bf16 v[68:71], a[132:135], a[208:211], v[68:71]
    ds_read_b128 a[252:255], v13 offset:18432
    v_mfma_f32_16x16x32_bf16 v[76:79], a[132:135], a[212:215], v[76:79]
    v_mfma_f32_16x16x32_bf16 v[64:67], a[136:139], a[216:219], v[64:67]
    ds_read_b128 a[112:115], v10 offset:16640
    v_mfma_f32_16x16x32_bf16 v[72:75], a[136:139], a[220:223], v[72:75]
    v_mfma_f32_16x16x32_bf16 v[68:71], a[140:143], a[216:219], v[68:71]
    s_add_u32 m0, s48, 98304
    s_mov_b32 s61, 32768
    s_waitcnt vmcnt(4)
    buffer_load_dwordx4 v28, s[12:15], s61 offen nt lds
    v_mfma_f32_16x16x32_bf16 v[76:79], a[140:143], a[220:223], v[76:79]
    ds_read_b128 a[116:119], v10 offset:18688
    s_waitcnt lgkmcnt(6)
    v_mfma_f32_16x16x32_bf16 v[80:83], a[224:227], a[160:163], v[112:115]
    ds_read_b128 a[120:123], v11 offset:16640
    v_mfma_f32_16x16x32_bf16 v[88:91], a[224:227], a[164:167], v[116:119]
    v_mfma_f32_16x16x32_bf16 v[84:87], a[228:231], a[160:163], v[112:115]
    ds_read_b128 a[124:127], v11 offset:18688
    v_exp_f32 v96, v64
    v_mfma_f32_16x16x32_bf16 v[92:95], a[228:231], a[164:167], v[116:119]
    v_exp_f32 v97, v65
    v_add_f32 v37, v35, v96
    v_mfma_f32_16x16x32_bf16 v[80:83], a[232:235], a[168:171], v[80:83]
    ds_read_b128 a[128:131], v12 offset:16640
    v_exp_f32 v98, v66
    v_add_f32 v37, v37, v97
    v_mfma_f32_16x16x32_bf16 v[88:91], a[232:235], a[172:175], v[88:91]
    v_cvt_pk_bf16_f32 v120, v96, v97
    v_exp_f32 v99, v67
    v_add_f32 v37, v37, v98
    v_mfma_f32_16x16x32_bf16 v[84:87], a[236:239], a[168:171], v[84:87]
    ds_read_b128 a[132:135], v12 offset:18688
    s_add_u32 m0, s48, 98304
    s_waitcnt vmcnt(4)
    buffer_load_dwordx4 v29, s[12:15], s61 offen offset:1024 nt lds
    v_mfma_f32_16x16x32_bf16 v[92:95], a[236:239], a[172:175], v[92:95]
    v_exp_f32 v100, v72
    s_waitcnt lgkmcnt(6)
    v_mfma_f32_16x16x32_bf16 v[80:83], a[240:243], a[176:179], v[80:83]
    ds_read_b128 a[136:139], v13 offset:16640
    v_add_f32 v37, v37, v99
    v_cvt_pk_bf16_f32 v121, v98, v99
    v_mfma_f32_16x16x32_bf16 v[88:91], a[240:243], a[180:183], v[88:91]
    v_exp_f32 v101, v73
    v_add_f32 v38, v36, v100
    v_mfma_f32_16x16x32_bf16 v[84:87], a[244:247], a[176:179], v[84:87]
    ds_read_b128 a[140:143], v13 offset:18688
    v_exp_f32 v102, v74
    v_add_f32 v38, v38, v101
    v_mfma_f32_16x16x32_bf16 v[92:95], a[244:247], a[180:183], v[92:95]
    v_cvt_pk_bf16_f32 v124, v100, v101
    v_exp_f32 v103, v75
    v_add_f32 v38, v38, v102
    v_mfma_f32_16x16x32_bf16 v[80:83], a[248:251], a[184:187], v[80:83]
    s_barrier
    ds_read_b64_tr_b16 a[224:225], v14 offset:0
    ds_read_b64_tr_b16 a[226:227], v14 offset:2048
    v_mfma_f32_16x16x32_bf16 v[88:91], a[248:251], a[188:191], v[88:91]
    s_add_u32 m0, s48, 98304
    s_waitcnt vmcnt(4)
    buffer_load_dwordx4 v28, s[12:15], s61 offen offset:2048 nt lds
    v_mfma_f32_16x16x32_bf16 v[84:87], a[252:255], a[184:187], v[84:87]
    ds_read_b64_tr_b16 a[228:229], v15 offset:0
    ds_read_b64_tr_b16 a[230:231], v15 offset:2048
    v_exp_f32 v96, v68
    v_mfma_f32_16x16x32_bf16 v[92:95], a[252:255], a[188:191], v[92:95]
    v_add_f32 v38, v38, v103
    v_cvt_pk_bf16_f32 v125, v102, v103
    s_waitcnt lgkmcnt(8)
    v_mfma_f32_16x16x32_bf16 v[80:83], a[112:115], a[192:195], v[80:83]
    ds_read_b64_tr_b16 a[232:233], v16 offset:0
    ds_read_b64_tr_b16 a[234:235], v16 offset:2048
    v_exp_f32 v97, v69
    v_mfma_f32_16x16x32_bf16 v[88:91], a[112:115], a[196:199], v[88:91]
    v_add_f32 v37, v37, v96
    v_exp_f32 v98, v70
    v_mfma_f32_16x16x32_bf16 v[84:87], a[116:119], a[192:195], v[84:87]
    ds_read_b64_tr_b16 a[236:237], v17 offset:0
    ds_read_b64_tr_b16 a[238:239], v17 offset:2048
    v_add_f32 v37, v37, v97
    v_mfma_f32_16x16x32_bf16 v[92:95], a[116:119], a[196:199], v[92:95]
    v_cvt_pk_bf16_f32 v122, v96, v97
    v_exp_f32 v99, v71
    v_mfma_f32_16x16x32_bf16 v[80:83], a[120:123], a[200:203], v[80:83]
    ds_read_b64_tr_b16 a[240:241], v18 offset:0
    s_add_u32 m0, s48, 98304
    s_waitcnt vmcnt(4)
    buffer_load_dwordx4 v29, s[12:15], s61 offen offset:3072 nt lds
    v_mfma_f32_16x16x32_bf16 v[88:91], a[120:123], a[204:207], v[88:91]
    ds_read_b64_tr_b16 a[242:243], v18 offset:2048
    v_add_f32 v37, v37, v98
    v_exp_f32 v100, v76
    v_mfma_f32_16x16x32_bf16 v[84:87], a[124:127], a[200:203], v[84:87]
    ds_read_b64_tr_b16 a[244:245], v19 offset:0
    ds_read_b64_tr_b16 a[246:247], v19 offset:2048
    v_add_f32 v37, v37, v99
    v_mfma_f32_16x16x32_bf16 v[92:95], a[124:127], a[204:207], v[92:95]
    v_cvt_pk_bf16_f32 v123, v98, v99
    v_exp_f32 v101, v77
    s_waitcnt lgkmcnt(12)
    v_mfma_f32_16x16x32_bf16 v[80:83], a[128:131], a[208:211], v[80:83]
    ds_read_b64_tr_b16 a[248:249], v20 offset:0
    ds_read_b64_tr_b16 a[250:251], v20 offset:2048
    v_add_f32 v38, v38, v100
    v_mfma_f32_16x16x32_bf16 v[88:91], a[128:131], a[212:215], v[88:91]
    v_exp_f32 v102, v78
    v_add_f32 v38, v38, v101
    v_mfma_f32_16x16x32_bf16 v[84:87], a[132:135], a[208:211], v[84:87]
    ds_read_b64_tr_b16 a[252:253], v21 offset:0
    ds_read_b64_tr_b16 a[254:255], v21 offset:2048
    v_cvt_pk_bf16_f32 v126, v100, v101
    v_mfma_f32_16x16x32_bf16 v[92:95], a[132:135], a[212:215], v[92:95]
    s_add_u32 m0, s48, 0
    s_mov_b32 s61, 65536
    s_waitcnt vmcnt(4)
    buffer_load_dwordx4 v26, s[8:11], s61 offen nt lds
    v_mfma_f32_16x16x32_bf16 v[80:83], a[136:139], a[216:219], v[80:83]
    ds_read_b64_tr_b16 a[112:113], v14 offset:256
    ds_read_b64_tr_b16 a[114:115], v14 offset:2304
    v_exp_f32 v103, v79
    v_mfma_f32_16x16x32_bf16 v[88:91], a[136:139], a[220:223], v[88:91]
    v_add_f32 v38, v38, v102
    v_add_f32 v38, v38, v103
    v_cvt_pk_bf16_f32 v127, v102, v103
    v_mfma_f32_16x16x32_bf16 v[84:87], a[140:143], a[216:219], v[84:87]
    v_max_f32 v39, v37, v38
    v_min_f32 v40, v37, v38
    v_cmp_lt_f32 vcc, s55, v39
    v_cmp_gt_f32 s[44:45], s98, v40
    s_nop 0
    s_or_b64 s[44:45], s[44:45], vcc
    s_cbranch_scc0 L_nm1
    s_call_b64 s[58:59], L_fix0
L_nm1:
    v_mfma_f32_16x16x32_bf16 v[92:95], a[140:143], a[220:223], v[92:95]
    ds_read_b64_tr_b16 a[116:117], v15 offset:256
    ds_read_b64_tr_b16 a[118:119], v15 offset:2304
    s_waitcnt lgkmcnt(12)
    v_mfma_f32_16x16x32_bf16 v[128:131], a[224:227], v[120:123], 0
    ds_read_b64_tr_b16 a[120:121], v16 offset:256
    v_mfma_f32_16x16x32_bf16 v[136:139], a[224:227], v[124:127], 0
    ds_read_b64_tr_b16 a[122:123], v16 offset:2304
    v_mfma_f32_16x16x32_bf16 v[132:135], a[228:231], v[120:123], 0
    ds_read_b64_tr_b16 a[124:125], v17 offset:256
    ds_read_b64_tr_b16 a[126:127], v17 offset:2304
    v_mfma_f32_16x16x32_bf16 v[140:143], a[228:231], v[124:127], 0
    s_add_u32 m0, s48, 0
    s_waitcnt vmcnt(4)
    buffer_load_dwordx4 v27, s[8:11], s61 offen offset:1024 nt lds
    v_mfma_f32_16x16x32_bf16 v[144:147], a[232:235], v[120:123], 0
    ds_read_b64_tr_b16 a[128:129], v18 offset:256
    ds_read_b64_tr_b16 a[130:131], v18 offset:2304
    v_mfma_f32_16x16x32_bf16 v[152:155], a[232:235], v[124:127], 0
    v_exp_f32 v96, v80
    v_mfma_f32_16x16x32_bf16 v[148:151], a[236:239], v[120:123], 0
    ds_read_b64_tr_b16 a[132:133], v19 offset:256
    ds_read_b64_tr_b16 a[134:135], v19 offset:2304
    v_mfma_f32_16x16x32_bf16 v[156:159], a[236:239], v[124:127], 0
    v_exp_f32 v97, v81
    s_waitcnt lgkmcnt(12)
    v_mfma_f32_16x16x32_bf16 v[160:163], a[240:243], v[120:123], 0
    ds_read_b64_tr_b16 a[136:137], v20 offset:256
    ds_read_b64_tr_b16 a[138:139], v20 offset:2304
    v_mfma_f32_16x16x32_bf16 v[168:171], a[240:243], v[124:127], 0
    v_add_f32 v35, v37, v96
    v_exp_f32 v98, v82
    v_mfma_f32_16x16x32_bf16 v[164:167], a[244:247], v[120:123], 0
    ds_read_b64_tr_b16 a[140:141], v21 offset:256
    ds_read_b64_tr_b16 a[142:143], v21 offset:2304
    v_mfma_f32_16x16x32_bf16 v[172:175], a[244:247], v[124:127], 0
    s_add_u32 m0, s48, 0
    s_waitcnt vmcnt(4)
    buffer_load_dwordx4 v26, s[8:11], s61 offen offset:2048 nt lds
    v_mfma_f32_16x16x32_bf16 v[176:179], a[248:251], v[120:123], 0
    s_barrier
    v_mfma_f32_16x16x32_bf16 v[184:187], a[248:251], v[124:127], 0
    ds_read_b128 a[224:227], v10 offset:32768
    v_add_f32 v35, v35, v97
    v_mfma_f32_16x16x32_bf16 v[180:183], a[252:255], v[120:123], 0
    ds_read_b128 a[228:231], v10 offset:34816
    v_cvt_pk_bf16_f32 v104, v96, v97
    v_mfma_f32_16x16x32_bf16 v[188:191], a[252:255], v[124:127], 0
    v_exp_f32 v99, v83
    s_waitcnt lgkmcnt(10)
    v_mfma_f32_16x16x32_bf16 v[192:195], a[112:115], v[120:123], 0
    ds_read_b128 a[232:235], v11 offset:32768
    v_add_f32 v35, v35, v98
    v_mfma_f32_16x16x32_bf16 v[200:203], a[112:115], v[124:127], 0
    v_exp_f32 v100, v88
    v_mfma_f32_16x16x32_bf16 v[196:199], a[116:119], v[120:123], 0
    ds_read_b128 a[236:239], v11 offset:34816
    v_mfma_f32_16x16x32_bf16 v[204:207], a[116:119], v[124:127], 0
    s_add_u32 m0, s48, 0
    s_waitcnt vmcnt(4)
    buffer_load_dwordx4 v27, s[8:11], s61 offen offset:3072 nt lds
    v_mfma_f32_16x16x32_bf16 v[208:211], a[120:123], v[120:123], 0
    ds_read_b128 a[240:243], v12 offset:32768
    v_add_f32 v35, v35, v99
    v_mfma_f32_16x16x32_bf16 v[216:219], a[120:123], v[124:127], 0
    v_cvt_pk_bf16_f32 v105, v98, v99
    v_exp_f32 v101, v89
    v_mfma_f32_16x16x32_bf16 v[212:215], a[124:127], v[120:123], 0
    ds_read_b128 a[244:247], v12 offset:34816
    v_mfma_f32_16x16x32_bf16 v[220:223], a[124:127], v[124:127], 0
    v_add_f32 v36, v38, v100
    s_waitcnt lgkmcnt(6)
    v_mfma_f32_16x16x32_bf16 v[224:227], a[128:131], v[120:123], 0
    ds_read_b128 a[248:251], v13 offset:32768
    v_mfma_f32_16x16x32_bf16 v[232:235], a[128:131], v[124:127], 0
    s_add_u32 m0, s48, 114688
    s_mov_b32 s61, 49152
    s_waitcnt vmcnt(4)
    buffer_load_dwordx4 v28, s[12:15], s61 offen nt lds
    v_mfma_f32_16x16x32_bf16 v[228:231], a[132:135], v[120:123], 0
    ds_read_b128 a[252:255], v13 offset:34816
    v_exp_f32 v102, v90
    v_mfma_f32_16x16x32_bf16 v[236:239], a[132:135], v[124:127], 0
    v_add_f32 v36, v36, v101
    v_cvt_pk_bf16_f32 v108, v100, v101
    v_mfma_f32_16x16x32_bf16 v[240:243], a[136:139], v[120:123], 0
    v_exp_f32 v103, v91
    v_mfma_f32_16x16x32_bf16 v[248:251], a[136:139], v[124:127], 0
    ds_read_b128 a[112:115], v10 offset:33024
    v_add_f32 v36, v36, v102
    v_mfma_f32_16x16x32_bf16 v[244:247], a[140:143], v[120:123], 0
    ds_read_b128 a[116:119], v10 offset:35072
    v_exp_f32 v96, v84
    v_mfma_f32_16x16x32_bf16 v[252:255], a[140:143], v[124:127], 0
    v_add_f32 v36, v36, v103
    s_waitcnt lgkmcnt(6)
    v_mfma_f32_16x16x32_bf16 v[64:67], a[224:227], a[160:163], v[112:115]
    ds_read_b128 a[120:123], v11 offset:33024
    v_mfma_f32_16x16x32_bf16 v[72:75], a[224:227], a[164:167], v[116:119]
    s_add_u32 m0, s48, 114688
    s_waitcnt vmcnt(4)
    buffer_load_dwordx4 v29, s[12:15], s61 offen offset:1024 nt lds
    v_mfma_f32_16x16x32_bf16 v[68:71], a[228:231], a[160:163], v[112:115]
    ds_read_b128 a[124:127], v11 offset:35072
    v_cvt_pk_bf16_f32 v109, v102, v103
    v_mfma_f32_16x16x32_bf16 v[76:79], a[228:231], a[164:167], v[116:119]
    v_exp_f32 v97, v85
    v_add_f32 v35, v35, v96
    v_mfma_f32_16x16x32_bf16 v[64:67], a[232:235], a[168:171], v[64:67]
    v_exp_f32 v98, v86
    v_mfma_f32_16x16x32_bf16 v[72:75], a[232:235], a[172:175], v[72:75]
    ds_read_b128 a[128:131], v12 offset:33024
    v_add_f32 v35, v35, v97
    v_mfma_f32_16x16x32_bf16 v[68:71], a[236:239], a[168:171], v[68:71]
    ds_read_b128 a[132:135], v12 offset:35072
    v_cvt_pk_bf16_f32 v106, v96, v97
    v_mfma_f32_16x16x32_bf16 v[76:79], a[236:239], a[172:175], v[76:79]
    v_exp_f32 v99, v87
    s_waitcnt lgkmcnt(6)
    v_mfma_f32_16x16x32_bf16 v[64:67], a[240:243], a[176:179], v[64:67]
    ds_read_b128 a[136:139], v13 offset:33024
    v_mfma_f32_16x16x32_bf16 v[72:75], a[240:243], a[180:183], v[72:75]
    s_add_u32 m0, s48, 114688
    s_waitcnt vmcnt(4)
    buffer_load_dwordx4 v28, s[12:15], s61 offen offset:2048 nt lds
    v_mfma_f32_16x16x32_bf16 v[68:71], a[244:247], a[176:179], v[68:71]
    ds_read_b128 a[140:143], v13 offset:35072
    v_add_f32 v35, v35, v98
    v_mfma_f32_16x16x32_bf16 v[76:79], a[244:247], a[180:183], v[76:79]
    v_exp_f32 v100, v92
    v_mfma_f32_16x16x32_bf16 v[64:67], a[248:251], a[184:187], v[64:67]
    s_barrier
    ds_read_b64_tr_b16 a[224:225], v14 offset:16384
    v_mfma_f32_16x16x32_bf16 v[72:75], a[248:251], a[188:191], v[72:75]
    ds_read_b64_tr_b16 a[226:227], v14 offset:18432
    v_add_f32 v35, v35, v99
    v_mfma_f32_16x16x32_bf16 v[68:71], a[252:255], a[184:187], v[68:71]
    ds_read_b64_tr_b16 a[228:229], v15 offset:16384
    ds_read_b64_tr_b16 a[230:231], v15 offset:18432
    v_mfma_f32_16x16x32_bf16 v[76:79], a[252:255], a[188:191], v[76:79]
    v_cvt_pk_bf16_f32 v107, v98, v99
    s_waitcnt lgkmcnt(8)
    v_mfma_f32_16x16x32_bf16 v[64:67], a[112:115], a[192:195], v[64:67]
    ds_read_b64_tr_b16 a[232:233], v16 offset:16384
    ds_read_b64_tr_b16 a[234:235], v16 offset:18432
    v_mfma_f32_16x16x32_bf16 v[72:75], a[112:115], a[196:199], v[72:75]
    s_add_u32 m0, s48, 114688
    s_waitcnt vmcnt(4)
    buffer_load_dwordx4 v29, s[12:15], s61 offen offset:3072 nt lds
    v_mfma_f32_16x16x32_bf16 v[68:71], a[116:119], a[192:195], v[68:71]
    ds_read_b64_tr_b16 a[236:237], v17 offset:16384
    ds_read_b64_tr_b16 a[238:239], v17 offset:18432
    v_mfma_f32_16x16x32_bf16 v[76:79], a[116:119], a[196:199], v[76:79]
    v_exp_f32 v101, v93
    v_mfma_f32_16x16x32_bf16 v[64:67], a[120:123], a[200:203], v[64:67]
    ds_read_b64_tr_b16 a[240:241], v18 offset:16384
    ds_read_b64_tr_b16 a[242:243], v18 offset:18432
    v_mfma_f32_16x16x32_bf16 v[72:75], a[120:123], a[204:207], v[72:75]
    v_add_f32 v36, v36, v100
    v_exp_f32 v102, v94
    v_mfma_f32_16x16x32_bf16 v[68:71], a[124:127], a[200:203], v[68:71]
    s_add_u32 m0, s48, 16384
    s_mov_b32 s61, 81920
    s_waitcnt vmcnt(4)
    buffer_load_dwordx4 v26, s[8:11], s61 offen nt lds
    v_mfma_f32_16x16x32_bf16 v[76:79], a[124:127], a[204:207], v[76:79]
    ds_read_b64_tr_b16 a[244:245], v19 offset:16384
    ds_read_b64_tr_b16 a[246:247], v19 offset:18432
    s_waitcnt lgkmcnt(12)
    v_mfma_f32_16x16x32_bf16 v[64:67], a[128:131], a[208:211], v[64:67]
    ds_read_b64_tr_b16 a[248:249], v20 offset:16384
    ds_read_b64_tr_b16 a[250:251], v20 offset:18432
    v_mfma_f32_16x16x32_bf16 v[72:75], a[128:131], a[212:215], v[72:75]
    v_add_f32 v36, v36, v101
    v_cvt_pk_bf16_f32 v110, v100, v101
    v_mfma_f32_16x16x32_bf16 v[68:71], a[132:135], a[208:211], v[68:71]
    ds_read_b64_tr_b16 a[252:253], v21 offset:16384
    ds_read_b64_tr_b16 a[254:255], v21 offset:18432
    v_mfma_f32_16x16x32_bf16 v[76:79], a[132:135], a[212:215], v[76:79]
    v_exp_f32 v103, v95
    v_add_f32 v36, v36, v102
    v_mfma_f32_16x16x32_bf16 v[64:67], a[136:139], a[216:219], v[64:67]
    ds_read_b64_tr_b16 a[112:113], v14 offset:16640
    ds_read_b64_tr_b16 a[114:115], v14 offset:18688
    v_mfma_f32_16x16x32_bf16 v[72:75], a[136:139], a[220:223], v[72:75]
    v_add_f32 v36, v36, v103
    v_cvt_pk_bf16_f32 v111, v102, v103
    v_mfma_f32_16x16x32_bf16 v[68:71], a[140:143], a[216:219], v[68:71]
    ds_read_b64_tr_b16 a[116:117], v15 offset:16640
    ds_read_b64_tr_b16 a[118:119], v15 offset:18688
    s_add_u32 m0, s48, 16384
    s_waitcnt vmcnt(4)
    buffer_load_dwordx4 v27, s[8:11], s61 offen offset:1024 nt lds
    v_mfma_f32_16x16x32_bf16 v[76:79], a[140:143], a[220:223], v[76:79]
    v_max_f32 v39, v35, v36
    v_cmp_lt_f32 vcc, s55, v39
    s_cbranch_vccz L_nm2
    s_call_b64 s[58:59], L_fixp1
L_nm2:
    s_waitcnt lgkmcnt(12)
    v_mfma_f32_16x16x32_bf16 v[128:131], a[224:227], v[104:107], v[128:131]
    ds_read_b64_tr_b16 a[120:121], v16 offset:16640
    v_mfma_f32_16x16x32_bf16 v[136:139], a[224:227], v[108:111], v[136:139]
L_pg4:
    s_cbranch_execz L_pgr1
    ds_read_b64_tr_b16 a[122:123], v16 offset:18688
    v_mfma_f32_16x16x32_bf16 v[132:135], a[228:231], v[104:107], v[132:135]
    ds_read_b64_tr_b16 a[124:125], v17 offset:16640
    ds_read_b64_tr_b16 a[126:127], v17 offset:18688
    v_mfma_f32_16x16x32_bf16 v[140:143], a[228:231], v[108:111], v[140:143]
    v_exp_f32 v96, v64
    v_mfma_f32_16x16x32_bf16 v[144:147], a[232:235], v[104:107], v[144:147]
    ds_read_b64_tr_b16 a[128:129], v18 offset:16640
    ds_read_b64_tr_b16 a[130:131], v18 offset:18688
    v_mfma_f32_16x16x32_bf16 v[152:155], a[232:235], v[108:111], v[152:155]
    v_exp_f32 v97, v65
    v_add_f32 v37, v35, v96
    v_mfma_f32_16x16x32_bf16 v[148:151], a[236:239], v[104:107], v[148:151]
    s_add_u32 m0, s48, 16384
    s_waitcnt vmcnt(4)
    buffer_load_dwordx4 v26, s[8:11], s61 offen offset:2048 nt lds
    v_mfma_f32_16x16x32_bf16 v[156:159], a[236:239], v[108:111], v[156:159]
    ds_read_b64_tr_b16 a[132:133], v19 offset:16640
    ds_read_b64_tr_b16 a[134:135], v19 offset:18688
    s_waitcnt lgkmcnt(12)
    v_mfma_f32_16x16x32_bf16 v[160:163], a[240:243], v[104:107], v[160:163]
    ds_read_b64_tr_b16 a[136:137], v20 offset:16640
    ds_read_b64_tr_b16 a[138:139], v20 offset:18688
    v_mfma_f32_16x16x32_bf16 v[168:171], a[240:243], v[108:111], v[168:171]
    v_exp_f32 v98, v66
    v_mfma_f32_16x16x32_bf16 v[164:167], a[244:247], v[104:107], v[164:167]
    ds_read_b64_tr_b16 a[140:141], v21 offset:16640
    ds_read_b64_tr_b16 a[142:143], v21 offset:18688
    v_mfma_f32_16x16x32_bf16 v[172:175], a[244:247], v[108:111], v[172:175]
    v_add_f32 v37, v37, v97
    v_cvt_pk_bf16_f32 v120, v96, v97
    v_mfma_f32_16x16x32_bf16 v[176:179], a[248:251], v[104:107], v[176:179]
    s_barrier
    ds_read_b128 a[224:227], v10 offset:49152
    v_mfma_f32_16x16x32_bf16 v[184:187], a[248:251], v[108:111], v[184:187]
    v_exp_f32 v99, v67
    v_mfma_f32_16x16x32_bf16 v[180:183], a[252:255], v[104:107], v[180:183]
    s_add_u32 m0, s48, 16384
    s_waitcnt vmcnt(4)
    buffer_load_dwordx4 v27, s[8:11], s61 offen offset:3072 nt lds
    v_mfma_f32_16x16x32_bf16 v[188:191], a[252:255], v[108:111], v[188:191]
    ds_read_b128 a[228:231], v10 offset:51200
    s_waitcnt lgkmcnt(10)
    v_mfma_f32_16x16x32_bf16 v[192:195], a[112:115], v[104:107], v[192:195]
    ds_read_b128 a[232:235], v11 offset:49152
    v_mfma_f32_16x16x32_bf16 v[200:203], a[112:115], v[108:111], v[200:203]
    s_mov_b64 exec, 0
    s_cmp_eq_u32 s4, 1
    s_cbranch_scc1 L_pg6
    s_cmp_eq_u32 s4, 2
    s_cbranch_scc1 L_pg7
    s_cmp_eq_u32 s4, 3
    s_cbranch_scc1 L_pg8
    s_branch L_pg5
L_pgr5:
    s_mov_b64 exec, -1
    s_nop 3
    v_mfma_f32_16x16x32_bf16 v[196:199], a[116:119], v[104:107], v[196:199]
    ds_read_b128 a[236:239], v11 offset:51200
    v_add_f32 v37, v37, v98
    v_mfma_f32_16x16x32_bf16 v[204:207], a[116:119], v[108:111], v[204:207]
    v_exp_f32 v100, v72
    v_mfma_f32_16x16x32_bf16 v[208:211], a[120:123], v[104:107], v[208:211]
    ds_read_b128 a[240:243], v12 offset:49152
    v_mfma_f32_16x16x32_bf16 v[216:219], a[120:123], v[108:111], v[216:219]
    s_add_u32 m0, s48, 65536
    s_mov_b32 s61, 65536
    s_waitcnt vmcnt(4)
    buffer_load_dwordx4 v28, s[12:15], s61 offen nt lds
    v_mfma_f32_16x16x32_bf16 v[212:215], a[124:127], v[104:107], v[212:215]
    ds_read_b128 a[244:247], v12 offset:51200
    v_add_f32 v37, v37, v99
    v_mfma_f32_16x16x32_bf16 v[220:223], a[124:127], v[108:111], v[220:223]
    v_cvt_pk_bf16_f32 v121, v98, v99
    s_waitcnt lgkmcnt(6)
    v_mfma_f32_16x16x32_bf16 v[224:227], a[128:131], v[104:107], v[224:227]
    v_exp_f32 v101, v73
    v_mfma_f32_16x16x32_bf16 v[232:235], a[128:131], v[108:111], v[232:235]
    ds_read_b128 a[248:251], v13 offset:49152
    v_add_f32 v38, v36, v100
    v_mfma_f32_16x16x32_bf16 v[228:231], a[132:135], v[104:107], v[228:231]
    v_exp_f32 v102, v74
    v_mfma_f32_16x16x32_bf16 v[236:239], a[132:135], v[108:111], v[236:239]
    ds_read_b128 a[252:255], v13 offset:51200
    v_add_f32 v38, v38, v101
    v_mfma_f32_16x16x32_bf16 v[240:243], a[136:139], v[104:107], v[240:243]
    ds_read_b128 a[112:115], v10 offset:49408
    v_cvt_pk_bf16_f32 v124, v100, v101
    v_mfma_f32_16x16x32_bf16 v[248:251], a[136:139], v[108:111], v[248:251]
    v_exp_f32 v103, v75
    v_add_f32 v38, v38, v102
    v_mfma_f32_16x16x32_bf16 v[244:247], a[140:143], v[104:107], v[244:247]
    s_add_u32 m0, s48, 65536
    s_waitcnt vmcnt(4)
    buffer_load_dwordx4 v29, s[12:15], s61 offen offset:1024 nt lds
    v_mfma_f32_16x16x32_bf16 v[252:255], a[140:143], v[108:111], v[252:255]
    ds_read_b128 a[116:119], v10 offset:51456
    s_waitcnt lgkmcnt(6)
    v_mfma_f32_16x16x32_bf16 v[80:83], a[224:227], a[160:163], v[112:115]
    v_exp_f32 v96, v68
    v_mfma_f32_16x16x32_bf16 v[88:91], a[224:227], a[164:167], v[116:119]
    ds_read_b128 a[120:123], v11 offset:49408
    v_add_f32 v38, v38, v103
    v_mfma_f32_16x16x32_bf16 v[84:87], a[228:231], a[160:163], v[112:115]
    ds_read_b128 a[124:127], v11 offset:51456
    v_cvt_pk_bf16_f32 v125, v102, v103
    v_mfma_f32_16x16x32_bf16 v[92:95], a[228:231], a[164:167], v[116:119]
    v_exp_f32 v97, v69
    v_mfma_f32_16x16x32_bf16 v[80:83], a[232:235], a[168:171], v[80:83]
    ds_read_b128 a[128:131], v12 offset:49408
    v_add_f32 v37, v37, v96
    v_mfma_f32_16x16x32_bf16 v[88:91], a[232:235], a[172:175], v[88:91]
    v_exp_f32 v98, v70
    v_add_f32 v37, v37, v97
    v_mfma_f32_16x16x32_bf16 v[84:87], a[236:239], a[168:171], v[84:87]
    s_add_u32 m0, s48, 65536
    s_waitcnt vmcnt(4)
    buffer_load_dwordx4 v28, s[12:15], s61 offen offset:2048 nt lds
    v_mfma_f32_16x16x32_bf16 v[92:95], a[236:239], a[172:175], v[92:95]
    ds_read_b128 a[132:135], v12 offset:51456
    s_waitcnt lgkmcnt(6)
    v_mfma_f32_16x16x32_bf16 v[80:83], a[240:243], a[176:179], v[80:83]
    ds_read_b128 a[136:139], v13 offset:49408
    v_cvt_pk_bf16_f32 v122, v96, v97
    v_mfma_f32_16x16x32_bf16 v[88:91], a[240:243], a[180:183], v[88:91]
    v_exp_f32 v99, v71
    v_mfma_f32_16x16x32_bf16 v[84:87], a[244:247], a[176:179], v[84:87]
    ds_read_b128 a[140:143], v13 offset:51456
    v_add_f32 v37, v37, v98
    v_mfma_f32_16x16x32_bf16 v[92:95], a[244:247], a[180:183], v[92:95]
    v_exp_f32 v100, v76
    v_mfma_f32_16x16x32_bf16 v[80:83], a[248:251], a[184:187], v[80:83]
    s_barrier
    v_mfma_f32_16x16x32_bf16 v[88:91], a[248:251], a[188:191], v[88:91]
    ds_read_b64_tr_b16 a[224:225], v14 offset:32768
    ds_read_b64_tr_b16 a[226:227], v14 offset:34816
    v_mfma_f32_16x16x32_bf16 v[84:87], a[252:255], a[184:187], v[84:87]
    s_add_u32 m0, s48, 65536
    s_waitcnt vmcnt(4)
    buffer_load_dwordx4 v29, s[12:15], s61 offen offset:3072 nt lds
    v_mfma_f32_16x16x32_bf16 v[92:95], a[252:255], a[188:191], v[92:95]
    ds_read_b64_tr_b16 a[228:229], v15 offset:32768
    ds_read_b64_tr_b16 a[230:231], v15 offset:34816
    s_waitcnt lgkmcnt(8)
    v_mfma_f32_16x16x32_bf16 v[80:83], a[112:115], a[192:195], v[80:83]
    ds_read_b64_tr_b16 a[232:233], v16 offset:32768
    ds_read_b64_tr_b16 a[234:235], v16 offset:34816
    v_mfma_f32_16x16x32_bf16 v[88:91], a[112:115], a[196:199], v[88:91]
    v_add_f32 v37, v37, v99
    v_cvt_pk_bf16_f32 v123, v98, v99
    v_mfma_f32_16x16x32_bf16 v[84:87], a[116:119], a[192:195], v[84:87]
    ds_read_b64_tr_b16 a[236:237], v17 offset:32768
    ds_read_b64_tr_b16 a[238:239], v17 offset:34816
    v_mfma_f32_16x16x32_bf16 v[92:95], a[116:119], a[196:199], v[92:95]
    v_exp_f32 v101, v77
    v_add_f32 v38, v38, v100
    v_mfma_f32_16x16x32_bf16 v[80:83], a[120:123], a[200:203], v[80:83]
    ds_read_b64_tr_b16 a[240:241], v18 offset:32768
    ds_read_b64_tr_b16 a[242:243], v18 offset:34816
    v_mfma_f32_16x16x32_bf16 v[88:91], a[120:123], a[204:207], v[88:91]
    v_exp_f32 v102, v78
    v_mfma_f32_16x16x32_bf16 v[84:87], a[124:127], a[200:203], v[84:87]
    s_add_u32 m0, s48, 32768
    s_mov_b32 s61, 98304
    s_waitcnt vmcnt(4)
    buffer_load_dwordx4 v26, s[8:11], s61 offen nt lds
    v_mfma_f32_16x16x32_bf16 v[92:95], a[124:127], a[204:207], v[92:95]
    ds_read_b64_tr_b16 a[244:245], v19 offset:32768
    ds_read_b64_tr_b16 a[246:247], v19 offset:34816
    s_waitcnt lgkmcnt(12)
    v_mfma_f32_16x16x32_bf16 v[80:83], a[128:131], a[208:211], v[80:83]
    ds_read_b64_tr_b16 a[248:249], v20 offset:32768
    ds_read_b64_tr_b16 a[250:251], v20 offset:34816
    v_mfma_f32_16x16x32_bf16 v[88:91], a[128:131], a[212:215], v[88:91]
    v_add_f32 v38, v38, v101
    v_cvt_pk_bf16_f32 v126, v100, v101
    v_mfma_f32_16x16x32_bf16 v[84:87], a[132:135], a[208:211], v[84:87]
    ds_read_b64_tr_b16 a[252:253], v21 offset:32768
    ds_read_b64_tr_b16 a[254:255], v21 offset:34816
    v_mfma_f32_16x16x32_bf16 v[92:95], a[132:135], a[212:215], v[92:95]
    v_exp_f32 v103, v79
    v_add_f32 v38, v38, v102
    v_mfma_f32_16x16x32_bf16 v[80:83], a[136:139], a[216:219], v[80:83]
    ds_read_b64_tr_b16 a[112:113], v14 offset:33024
    ds_read_b64_tr_b16 a[114:115], v14 offset:35072
    v_mfma_f32_16x16x32_bf16 v[88:91], a[136:139], a[220:223], v[88:91]
    v_add_f32 v38, v38, v103
    v_cvt_pk_bf16_f32 v127, v102, v103
    v_mfma_f32_16x16x32_bf16 v[84:87], a[140:143], a[216:219], v[84:87]
    v_max_f32 v39, v37, v38
    v_cmp_lt_f32 vcc, s55, v39
    s_cbranch_vccz L_nm3
    s_call_b64 s[58:59], L_fixp0
L_nm3:
    v_mfma_f32_16x16x32_bf16 v[92:95], a[140:143], a[220:223], v[92:95]
    ds_read_b64_tr_b16 a[116:117], v15 offset:33024
    ds_read_b64_tr_b16 a[118:119], v15 offset:35072
    s_waitcnt lgkmcnt(12)
    v_mfma_f32_16x16x32_bf16 v[128:131], a[224:227], v[120:123], v[128:131]
    ds_read_b64_tr_b16 a[120:121], v16 offset:33024
    ds_read_b64_tr_b16 a[122:123], v16 offset:35072
    v_mfma_f32_16x16x32_bf16 v[136:139], a[224:227], v[124:127], v[136:139]
    s_add_u32 m0, s48, 32768
    s_waitcnt vmcnt(4)
    buffer_load_dwordx4 v27, s[8:11], s61 offen offset:1024 nt lds
    v_mfma_f32_16x16x32_bf16 v[132:135], a[228:231], v[120:123], v[132:135]
    ds_read_b64_tr_b16 a[124:125], v17 offset:33024
    ds_read_b64_tr_b16 a[126:127], v17 offset:35072
    v_mfma_f32_16x16x32_bf16 v[140:143], a[228:231], v[124:127], v[140:143]
    v_exp_f32 v96, v80
    v_mfma_f32_16x16x32_bf16 v[144:147], a[232:235], v[120:123], v[144:147]
    ds_read_b64_tr_b16 a[128:129], v18 offset:33024
    ds_read_b64_tr_b16 a[130:131], v18 offset:35072
    v_mfma_f32_16x16x32_bf16 v[152:155], a[232:235], v[124:127], v[152:155]
    v_exp_f32 v97, v81
    v_mfma_f32_16x16x32_bf16 v[148:151], a[236:239], v[120:123], v[148:151]
    ds_read_b64_tr_b16 a[132:133], v19 offset:33024
    ds_read_b64_tr_b16 a[134:135], v19 offset:35072
    v_mfma_f32_16x16x32_bf16 v[156:159], a[236:239], v[124:127], v[156:159]
    v_add_f32 v35, v37, v96
    s_waitcnt lgkmcnt(12)
    v_mfma_f32_16x16x32_bf16 v[160:163], a[240:243], v[120:123], v[160:163]
    ds_read_b64_tr_b16 a[136:137], v20 offset:33024
    ds_read_b64_tr_b16 a[138:139], v20 offset:35072
    v_mfma_f32_16x16x32_bf16 v[168:171], a[240:243], v[124:127], v[168:171]
    s_add_u32 m0, s48, 32768
    s_waitcnt vmcnt(4)
    buffer_load_dwordx4 v26, s[8:11], s61 offen offset:2048 nt lds
    v_mfma_f32_16x16x32_bf16 v[164:167], a[244:247], v[120:123], v[164:167]
    ds_read_b64_tr_b16 a[140:141], v21 offset:33024
    ds_read_b64_tr_b16 a[142:143], v21 offset:35072
    v_mfma_f32_16x16x32_bf16 v[172:175], a[244:247], v[124:127], v[172:175]
    v_exp_f32 v98, v82
    v_mfma_f32_16x16x32_bf16 v[176:179], a[248:251], v[120:123], v[176:179]
    s_barrier
    ds_read_b128 a[224:227], v10 offset:0
    v_mfma_f32_16x16x32_bf16 v[184:187], a[248:251], v[124:127], v[184:187]
    v_add_f32 v35, v35, v97
    v_cvt_pk_bf16_f32 v104, v96, v97
    v_mfma_f32_16x16x32_bf16 v[180:183], a[252:255], v[120:123], v[180:183]
    v_exp_f32 v99, v83
    v_mfma_f32_16x16x32_bf16 v[188:191], a[252:255], v[124:127], v[188:191]
    ds_read_b128 a[228:231], v10 offset:2048
    s_waitcnt lgkmcnt(10)
    v_mfma_f32_16x16x32_bf16 v[192:195], a[112:115], v[120:123], v[192:195]
    ds_read_b128 a[232:235], v11 offset:0
    v_add_f32 v35, v35, v98
    v_mfma_f32_16x16x32_bf16 v[200:203], a[112:115], v[124:127], v[200:203]
    v_exp_f32 v100, v88
    v_mfma_f32_16x16x32_bf16 v[196:199], a[116:119], v[120:123], v[196:199]
    ds_read_b128 a[236:239], v11 offset:2048
    v_mfma_f32_16x16x32_bf16 v[204:207], a[116:119], v[124:127], v[204:207]
    s_add_u32 m0, s48, 32768
    s_waitcnt vmcnt(4)
    buffer_load_dwordx4 v27, s[8:11], s61 offen offset:3072 nt lds
    v_mfma_f32_16x16x32_bf16 v[208:211], a[120:123], v[120:123], v[208:211]
    ds_read_b128 a[240:243], v12 offset:0
    v_add_f32 v35, v35, v99
    v_mfma_f32_16x16x32_bf16 v[216:219], a[120:123], v[124:127], v[216:219]
    v_cvt_pk_bf16_f32 v105, v98, v99
    v_exp_f32 v101, v89
    v_mfma_f32_16x16x32_bf16 v[212:215], a[124:127], v[120:123], v[212:215]
    ds_read_b128 a[244:247], v12 offset:2048
    v_mfma_f32_16x16x32_bf16 v[220:223], a[124:127], v[124:127], v[220:223]
    v_add_f32 v36, v38, v100
    s_waitcnt lgkmcnt(6)
    v_mfma_f32_16x16x32_bf16 v[224:227], a[128:131], v[120:123], v[224:227]
    v_exp_f32 v102, v90
    v_mfma_f32_16x16x32_bf16 v[232:235], a[128:131], v[124:127], v[232:235]
    ds_read_b128 a[248:251], v13 offset:0
    v_add_f32 v36, v36, v101
    v_mfma_f32_16x16x32_bf16 v[228:231], a[132:135], v[120:123], v[228:231]
    ds_read_b128 a[252:255], v13 offset:2048
    v_mfma_f32_16x16x32_bf16 v[236:239], a[132:135], v[124:127], v[236:239]
    s_add_u32 m0, s48, 81920
    s_mov_b32 s61, 81920
    s_waitcnt vmcnt(4)
    buffer_load_dwordx4 v28, s[12:15], s61 offen nt lds
    v_mfma_f32_16x16x32_bf16 v[240:243], a[136:139], v[120:123], v[240:243]
    ds_read_b128 a[112:115], v10 offset:256
    v_cvt_pk_bf16_f32 v108, v100, v101
    v_mfma_f32_16x16x32_bf16 v[248:251], a[136:139], v[124:127], v[248:251]
    v_exp_f32 v103, v91
    v_mfma_f32_16x16x32_bf16 v[244:247], a[140:143], v[120:123], v[244:247]
    ds_read_b128 a[116:119], v10 offset:2304
    v_add_f32 v36, v36, v102
    v_mfma_f32_16x16x32_bf16 v[252:255], a[140:143], v[124:127], v[252:255]
    v_exp_f32 v96, v84
    s_waitcnt lgkmcnt(6)
    v_mfma_f32_16x16x32_bf16 v[64:67], a[224:227], a[160:163], v[112:115]
    ds_read_b128 a[120:123], v11 offset:256
    v_mfma_f32_16x16x32_bf16 v[72:75], a[224:227], a[164:167], v[116:119]
    v_add_f32 v36, v36, v103
    v_cvt_pk_bf16_f32 v109, v102, v103
    v_mfma_f32_16x16x32_bf16 v[68:71], a[228:231], a[160:163], v[112:115]
    v_exp_f32 v97, v85
    v_mfma_f32_16x16x32_bf16 v[76:79], a[228:231], a[164:167], v[116:119]
    ds_read_b128 a[124:127], v11 offset:2304
    v_add_f32 v35, v35, v96
    v_mfma_f32_16x16x32_bf16 v[64:67], a[232:235], a[168:171], v[64:67]
    ds_read_b128 a[128:131], v12 offset:256
    v_mfma_f32_16x16x32_bf16 v[72:75], a[232:235], a[172:175], v[72:75]
    s_add_u32 m0, s48, 81920
    s_waitcnt vmcnt(4)
    buffer_load_dwordx4 v29, s[12:15], s61 offen offset:1024 nt lds
    v_mfma_f32_16x16x32_bf16 v[68:71], a[236:239], a[168:171], v[68:71]
    ds_read_b128 a[132:135], v12 offset:2304
    v_exp_f32 v98, v86
    v_mfma_f32_16x16x32_bf16 v[76:79], a[236:239], a[172:175], v[76:79]
    v_add_f32 v35, v35, v97
    s_waitcnt lgkmcnt(6)
    v_mfma_f32_16x16x32_bf16 v[64:67], a[240:243], a[176:179], v[64:67]
    ds_read_b128 a[136:139], v13 offset:256
    v_cvt_pk_bf16_f32 v106, v96, v97
    v_mfma_f32_16x16x32_bf16 v[72:75], a[240:243], a[180:183], v[72:75]
    v_exp_f32 v99, v87
    v_mfma_f32_16x16x32_bf16 v[68:71], a[244:247], a[176:179], v[68:71]
    ds_read_b128 a[140:143], v13 offset:2304
    v_add_f32 v35, v35, v98
    v_mfma_f32_16x16x32_bf16 v[76:79], a[244:247], a[180:183], v[76:79]
    v_exp_f32 v100, v92
    v_mfma_f32_16x16x32_bf16 v[64:67], a[248:251], a[184:187], v[64:67]
    s_barrier
    ds_read_b64_tr_b16 a[224:225], v14 offset:49152
    ds_read_b64_tr_b16 a[226:227], v14 offset:51200
    v_mfma_f32_16x16x32_bf16 v[72:75], a[248:251], a[188:191], v[72:75]
    s_add_u32 m0, s48, 81920
    s_waitcnt vmcnt(4)
    buffer_load_dwordx4 v28, s[12:15], s61 offen offset:2048 nt lds
    v_mfma_f32_16x16x32_bf16 v[68:71], a[252:255], a[184:187], v[68:71]
    ds_read_b64_tr_b16 a[228:229], v15 offset:49152
    ds_read_b64_tr_b16 a[230:231], v15 offset:51200
    v_mfma_f32_16x16x32_bf16 v[76:79], a[252:255], a[188:191], v[76:79]
    v_add_f32 v35, v35, v99
    s_waitcnt lgkmcnt(8)
    v_mfma_f32_16x16x32_bf16 v[64:67], a[112:115], a[192:195], v[64:67]
    ds_read_b64_tr_b16 a[232:233], v16 offset:49152
    ds_read_b64_tr_b16 a[234:235], v16 offset:51200
    v_mfma_f32_16x16x32_bf16 v[72:75], a[112:115], a[196:199], v[72:75]
    v_cvt_pk_bf16_f32 v107, v98, v99
    v_exp_f32 v101, v93
    v_mfma_f32_16x16x32_bf16 v[68:71], a[116:119], a[192:195], v[68:71]
    ds_read_b64_tr_b16 a[236:237], v17 offset:49152
    ds_read_b64_tr_b16 a[238:239], v17 offset:51200
    v_mfma_f32_16x16x32_bf16 v[76:79], a[116:119], a[196:199], v[76:79]
    v_add_f32 v36, v36, v100
    v_mfma_f32_16x16x32_bf16 v[64:67], a[120:123], a[200:203], v[64:67]
    ds_read_b64_tr_b16 a[240:241], v18 offset:49152
    ds_read_b64_tr_b16 a[242:243], v18 offset:51200
    v_mfma_f32_16x16x32_bf16 v[72:75], a[120:123], a[204:207], v[72:75]
    v_exp_f32 v102, v94
    v_add_f32 v36, v36, v101
    v_mfma_f32_16x16x32_bf16 v[68:71], a[124:127], a[200:203], v[68:71]
    s_add_u32 m0, s48, 81920
    s_waitcnt vmcnt(4)
    buffer_load_dwordx4 v29, s[12:15], s61 offen offset:3072 nt lds
    v_mfma_f32_16x16x32_bf16 v[76:79], a[124:127], a[204:207], v[76:79]
    ds_read_b64_tr_b16 a[244:245], v19 offset:49152
    ds_read_b64_tr_b16 a[246:247], v19 offset:51200
    s_waitcnt lgkmcnt(12)
    v_mfma_f32_16x16x32_bf16 v[64:67], a[128:131], a[208:211], v[64:67]
    ds_read_b64_tr_b16 a[248:249], v20 offset:49152
    ds_read_b64_tr_b16 a[250:251], v20 offset:51200
    v_mfma_f32_16x16x32_bf16 v[72:75], a[128:131], a[212:215], v[72:75]
    v_cvt_pk_bf16_f32 v110, v100, v101
    v_mfma_f32_16x16x32_bf16 v[68:71], a[132:135], a[208:211], v[68:71]
    ds_read_b64_tr_b16 a[252:253], v21 offset:49152
    ds_read_b64_tr_b16 a[254:255], v21 offset:51200
    v_mfma_f32_16x16x32_bf16 v[76:79], a[132:135], a[212:215], v[76:79]
    v_exp_f32 v103, v95
    v_add_f32 v36, v36, v102
    v_mfma_f32_16x16x32_bf16 v[64:67], a[136:139], a[216:219], v[64:67]
    ds_read_b64_tr_b16 a[112:113], v14 offset:49408
    ds_read_b64_tr_b16 a[114:115], v14 offset:51456
    v_mfma_f32_16x16x32_bf16 v[72:75], a[136:139], a[220:223], v[72:75]
    v_add_f32 v36, v36, v103
    v_cvt_pk_bf16_f32 v111, v102, v103
    v_mfma_f32_16x16x32_bf16 v[68:71], a[140:143], a[216:219], v[68:71]
    ds_read_b64_tr_b16 a[116:117], v15 offset:49408
    ds_read_b64_tr_b16 a[118:119], v15 offset:51456
    v_max_f32 v39, v35, v36
    v_cmp_lt_f32 vcc, s55, v39
    s_cbranch_vccz L_nm4
    s_call_b64 s[58:59], L_fixp1
L_nm4:
    v_mfma_f32_16x16x32_bf16 v[76:79], a[140:143], a[220:223], v[76:79]
    s_add_u32 m0, s48, 49152
    s_mov_b32 s61, 114688
    s_waitcnt vmcnt(4)
    buffer_load_dwordx4 v26, s[8:11], s61 offen nt lds
    s_waitcnt lgkmcnt(12)
    v_mfma_f32_16x16x32_bf16 v[128:131], a[224:227], v[104:107], v[128:131]
    ds_read_b64_tr_b16 a[120:121], v16 offset:49408
    v_mfma_f32_16x16x32_bf16 v[136:139], a[224:227], v[108:111], v[136:139]
    ds_read_b64_tr_b16 a[122:123], v16 offset:51456
    v_mfma_f32_16x16x32_bf16 v[132:135], a[228:231], v[104:107], v[132:135]
    ds_read_b64_tr_b16 a[124:125], v17 offset:49408
    ds_read_b64_tr_b16 a[126:127], v17 offset:51456
    v_mfma_f32_16x16x32_bf16 v[140:143], a[228:231], v[108:111], v[140:143]
    v_exp_f32 v96, v64
    v_mfma_f32_16x16x32_bf16 v[144:147], a[232:235], v[104:107], v[144:147]
    ds_read_b64_tr_b16 a[128:129], v18 offset:49408
    ds_read_b64_tr_b16 a[130:131], v18 offset:51456
    v_mfma_f32_16x16x32_bf16 v[152:155], a[232:235], v[108:111], v[152:155]
    v_exp_f32 v97, v65
    v_mfma_f32_16x16x32_bf16 v[148:151], a[236:239], v[104:107], v[148:151]
    ds_read_b64_tr_b16 a[132:133], v19 offset:49408
    ds_read_b64_tr_b16 a[134:135], v19 offset:51456
    v_mfma_f32_16x16x32_bf16 v[156:159], a[236:239], v[108:111], v[156:159]
    v_add_f32 v37, v35, v96
    s_waitcnt lgkmcnt(12)
    v_mfma_f32_16x16x32_bf16 v[160:163], a[240:243], v[104:107], v[160:163]
    ds_read_b64_tr_b16 a[136:137], v20 offset:49408
    ds_read_b64_tr_b16 a[138:139], v20 offset:51456
    v_mfma_f32_16x16x32_bf16 v[168:171], a[240:243], v[108:111], v[168:171]
    s_add_u32 m0, s48, 49152
    s_waitcnt vmcnt(4)
    buffer_load_dwordx4 v27, s[8:11], s61 offen offset:1024 nt lds
    v_mfma_f32_16x16x32_bf16 v[164:167], a[244:247], v[104:107], v[164:167]
    ds_read_b64_tr_b16 a[140:141], v21 offset:49408
    ds_read_b64_tr_b16 a[142:143], v21 offset:51456
    v_mfma_f32_16x16x32_bf16 v[172:175], a[244:247], v[108:111], v[172:175]
    v_exp_f32 v98, v66
    v_add_f32 v37, v37, v97
    v_mfma_f32_16x16x32_bf16 v[176:179], a[248:251], v[104:107], v[176:179]
    s_barrier
    v_mfma_f32_16x16x32_bf16 v[184:187], a[248:251], v[108:111], v[184:187]
    ds_read_b128 a[224:227], v10 offset:16384
    v_cvt_pk_bf16_f32 v120, v96, v97
    v_mfma_f32_16x16x32_bf16 v[180:183], a[252:255], v[104:107], v[180:183]
    v_exp_f32 v99, v67
    v_mfma_f32_16x16x32_bf16 v[188:191], a[252:255], v[108:111], v[188:191]
    ds_read_b128 a[228:231], v10 offset:18432
    s_waitcnt lgkmcnt(10)
    v_mfma_f32_16x16x32_bf16 v[192:195], a[112:115], v[104:107], v[192:195]
    ds_read_b128 a[232:235], v11 offset:16384
    v_mfma_f32_16x16x32_bf16 v[200:203], a[112:115], v[108:111], v[200:203]
    s_add_u32 m0, s48, 49152
    s_waitcnt vmcnt(4)
    buffer_load_dwordx4 v26, s[8:11], s61 offen offset:2048 nt lds
    v_mfma_f32_16x16x32_bf16 v[196:199], a[116:119], v[104:107], v[196:199]
    ds_read_b128 a[236:239], v11 offset:18432
    v_add_f32 v37, v37, v98
    v_mfma_f32_16x16x32_bf16 v[204:207], a[116:119], v[108:111], v[204:207]
    v_exp_f32 v100, v72
    v_mfma_f32_16x16x32_bf16 v[208:211], a[120:123], v[104:107], v[208:211]
    ds_read_b128 a[240:243], v12 offset:16384
    v_add_f32 v37, v37, v99
    v_mfma_f32_16x16x32_bf16 v[216:219], a[120:123], v[108:111], v[216:219]
    v_cvt_pk_bf16_f32 v121, v98, v99
    v_exp_f32 v101, v73
    v_mfma_f32_16x16x32_bf16 v[212:215], a[124:127], v[104:107], v[212:215]
    ds_read_b128 a[244:247], v12 offset:18432
    v_mfma_f32_16x16x32_bf16 v[220:223], a[124:127], v[108:111], v[220:223]
    v_add_f32 v38, v36, v100
    s_waitcnt lgkmcnt(6)
    v_mfma_f32_16x16x32_bf16 v[224:227], a[128:131], v[104:107], v[224:227]
    ds_read_b128 a[248:251], v13 offset:16384
    v_exp_f32 v102, v74
    v_mfma_f32_16x16x32_bf16 v[232:235], a[128:131], v[108:111], v[232:235]
    v_add_f32 v38, v38, v101
    v_cvt_pk_bf16_f32 v124, v100, v101
    v_mfma_f32_16x16x32_bf16 v[228:231], a[132:135], v[104:107], v[228:231]
    ds_read_b128 a[252:255], v13 offset:18432
    v_mfma_f32_16x16x32_bf16 v[236:239], a[132:135], v[108:111], v[236:239]
    s_add_u32 m0, s48, 49152
    s_waitcnt vmcnt(4)
    buffer_load_dwordx4 v27, s[8:11], s61 offen offset:3072 nt lds
    v_mfma_f32_16x16x32_bf16 v[240:243], a[136:139], v[104:107], v[240:243]
    v_exp_f32 v103, v75
    v_mfma_f32_16x16x32_bf16 v[248:251], a[136:139], v[108:111], v[248:251]
    ds_read_b128 a[112:115], v10 offset:16640
    v_add_f32 v38, v38, v102
    v_mfma_f32_16x16x32_bf16 v[244:247], a[140:143], v[104:107], v[244:247]
    v_exp_f32 v96, v68
    v_mfma_f32_16x16x32_bf16 v[252:255], a[140:143], v[108:111], v[252:255]
    ds_read_b128 a[116:119], v10 offset:18688
    s_waitcnt lgkmcnt(6)
    v_mfma_f32_16x16x32_bf16 v[80:83], a[224:227], a[160:163], v[112:115]
    ds_read_b128 a[120:123], v11 offset:16640
    v_add_f32 v38, v38, v103
    v_mfma_f32_16x16x32_bf16 v[88:91], a[224:227], a[164:167], v[116:119]
    v_cvt_pk_bf16_f32 v125, v102, v103
    v_exp_f32 v97, v69
    v_mfma_f32_16x16x32_bf16 v[84:87], a[228:231], a[160:163], v[112:115]
    ds_read_b128 a[124:127], v11 offset:18688
    v_mfma_f32_16x16x32_bf16 v[92:95], a[228:231], a[164:167], v[116:119]
    s_add_u32 m0, s48, 98304
    s_mov_b32 s61, 98304
    s_waitcnt vmcnt(4)
    buffer_load_dwordx4 v28, s[12:15], s61 offen nt lds
    v_mfma_f32_16x16x32_bf16 v[80:83], a[232:235], a[168:171], v[80:83]
    ds_read_b128 a[128:131], v12 offset:16640
    v_add_f32 v37, v37, v96
    v_mfma_f32_16x16x32_bf16 v[88:91], a[232:235], a[172:175], v[88:91]
    v_exp_f32 v98, v70
    v_mfma_f32_16x16x32_bf16 v[84:87], a[236:239], a[168:171], v[84:87]
    ds_read_b128 a[132:135], v12 offset:18688
    v_add_f32 v37, v37, v97
    v_mfma_f32_16x16x32_bf16 v[92:95], a[236:239], a[172:175], v[92:95]
    v_cvt_pk_bf16_f32 v122, v96, v97
    s_waitcnt lgkmcnt(6)
    v_mfma_f32_16x16x32_bf16 v[80:83], a[240:243], a[176:179], v[80:83]
    v_exp_f32 v99, v71
    v_mfma_f32_16x16x32_bf16 v[88:91], a[240:243], a[180:183], v[88:91]
    ds_read_b128 a[136:139], v13 offset:16640
    v_add_f32 v37, v37, v98
    v_mfma_f32_16x16x32_bf16 v[84:87], a[244:247], a[176:179], v[84:87]
    v_exp_f32 v100, v76
    v_mfma_f32_16x16x32_bf16 v[92:95], a[244:247], a[180:183], v[92:95]
    ds_read_b128 a[140:143], v13 offset:18688
    v_add_f32 v37, v37, v99
    v_mfma_f32_16x16x32_bf16 v[80:83], a[248:251], a[184:187], v[80:83]
    s_barrier
    ds_read_b64_tr_b16 a[224:225], v14 offset:0
    ds_read_b64_tr_b16 a[226:227], v14 offset:2048
    v_mfma_f32_16x16x32_bf16 v[88:91], a[248:251], a[188:191], v[88:91]
    s_add_u32 m0, s48, 98304
    s_waitcnt vmcnt(4)
    buffer_load_dwordx4 v29, s[12:15], s61 offen offset:1024 nt lds
    v_mfma_f32_16x16x32_bf16 v[84:87], a[252:255], a[184:187], v[84:87]
    ds_read_b64_tr_b16 a[228:229], v15 offset:0
    ds_read_b64_tr_b16 a[230:231], v15 offset:2048
    v_mfma_f32_16x16x32_bf16 v[92:95], a[252:255], a[188:191], v[92:95]
    v_cvt_pk_bf16_f32 v123, v98, v99
    s_waitcnt lgkmcnt(8)
    v_mfma_f32_16x16x32_bf16 v[80:83], a[112:115], a[192:195], v[80:83]
    ds_read_b64_tr_b16 a[232:233], v16 offset:0
    ds_read_b64_tr_b16 a[234:235], v16 offset:2048
    v_mfma_f32_16x16x32_bf16 v[88:91], a[112:115], a[196:199], v[88:91]
    v_exp_f32 v101, v77
    v_mfma_f32_16x16x32_bf16 v[84:87], a[116:119], a[192:195], v[84:87]
    ds_read_b64_tr_b16 a[236:237], v17 offset:0
    ds_read_b64_tr_b16 a[238:239], v17 offset:2048
    v_mfma_f32_16x16x32_bf16 v[92:95], a[116:119], a[196:199], v[92:95]
    v_add_f32 v38, v38, v100
    v_exp_f32 v102, v78
    v_mfma_f32_16x16x32_bf16 v[80:83], a[120:123], a[200:203], v[80:83]
    ds_read_b64_tr_b16 a[240:241], v18 offset:0
    ds_read_b64_tr_b16 a[242:243], v18 offset:2048
    v_mfma_f32_16x16x32_bf16 v[88:91], a[120:123], a[204:207], v[88:91]
    s_add_u32 m0, s48, 98304
    s_waitcnt vmcnt(4)
    buffer_load_dwordx4 v28, s[12:15], s61 offen offset:2048 nt lds
    v_mfma_f32_16x16x32_bf16 v[84:87], a[124:127], a[200:203], v[84:87]
    ds_read_b64_tr_b16 a[244:245], v19 offset:0
    ds_read_b64_tr_b16 a[246:247], v19 offset:2048
    v_mfma_f32_16x16x32_bf16 v[92:95], a[124:127], a[204:207], v[92:95]
    v_add_f32 v38, v38, v101
    s_waitcnt lgkmcnt(12)
    v_mfma_f32_16x16x32_bf16 v[80:83], a[128:131], a[208:211], v[80:83]
    ds_read_b64_tr_b16 a[248:249], v20 offset:0
    ds_read_b64_tr_b16 a[250:251], v20 offset:2048
    v_mfma_f32_16x16x32_bf16 v[88:91], a[128:131], a[212:215], v[88:91]
    v_cvt_pk_bf16_f32 v126, v100, v101
    v_mfma_f32_16x16x32_bf16 v[84:87], a[132:135], a[208:211], v[84:87]
    ds_read_b64_tr_b16 a[252:253], v21 offset:0
    ds_read_b64_tr_b16 a[254:255], v21 offset:2048
    v_mfma_f32_16x16x32_bf16 v[92:95], a[132:135], a[212:215], v[92:95]
    v_exp_f32 v103, v79
    v_add_f32 v38, v38, v102
    v_mfma_f32_16x16x32_bf16 v[80:83], a[136:139], a[216:219], v[80:83]
    ds_read_b64_tr_b16 a[112:113], v14 offset:256
    ds_read_b64_tr_b16 a[114:115], v14 offset:2304
    v_mfma_f32_16x16x32_bf16 v[88:91], a[136:139], a[220:223], v[88:91]
    v_add_f32 v38, v38, v103
    v_cvt_pk_bf16_f32 v127, v102, v103
    v_mfma_f32_16x16x32_bf16 v[84:87], a[140:143], a[216:219], v[84:87]
    ds_read_b64_tr_b16 a[116:117], v15 offset:256
    ds_read_b64_tr_b16 a[118:119], v15 offset:2304
    s_add_u32 m0, s48, 98304
    s_waitcnt vmcnt(4)
    buffer_load_dwordx4 v29, s[12:15], s61 offen offset:3072 nt lds
    v_mfma_f32_16x16x32_bf16 v[92:95], a[140:143], a[220:223], v[92:95]
    v_max_f32 v39, v37, v38
    v_cmp_lt_f32 vcc, s55, v39
    s_cbranch_vccz L_nm5
    s_call_b64 s[58:59], L_fixp0
L_nm5:
    s_waitcnt lgkmcnt(12)
    v_mfma_f32_16x16x32_bf16 v[128:131], a[224:227], v[120:123], v[128:131]
    ds_read_b64_tr_b16 a[120:121], v16 offset:256
    v_mfma_f32_16x16x32_bf16 v[136:139], a[224:227], v[124:127], v[136:139]
    ds_read_b64_tr_b16 a[122:123], v16 offset:2304
    v_mfma_f32_16x16x32_bf16 v[132:135], a[228:231], v[120:123], v[132:135]
    ds_read_b64_tr_b16 a[124:125], v17 offset:256
    ds_read_b64_tr_b16 a[126:127], v17 offset:2304
    v_mfma_f32_16x16x32_bf16 v[140:143], a[228:231], v[124:127], v[140:143]
    v_exp_f32 v96, v80
    v_mfma_f32_16x16x32_bf16 v[144:147], a[232:235], v[120:123], v[144:147]
    ds_read_b64_tr_b16 a[128:129], v18 offset:256
    ds_read_b64_tr_b16 a[130:131], v18 offset:2304
    v_mfma_f32_16x16x32_bf16 v[152:155], a[232:235], v[124:127], v[152:155]
    v_exp_f32 v97, v81
    v_add_f32 v35, v37, v96
    v_mfma_f32_16x16x32_bf16 v[148:151], a[236:239], v[120:123], v[148:151]
    s_add_u32 m0, s48, 0
    s_mov_b32 s61, 131072
    s_waitcnt vmcnt(4)
    buffer_load_dwordx4 v26, s[8:11], s61 offen nt lds
    v_mfma_f32_16x16x32_bf16 v[156:159], a[236:239], v[124:127], v[156:159]
    ds_read_b64_tr_b16 a[132:133], v19 offset:256
    ds_read_b64_tr_b16 a[134:135], v19 offset:2304
L_pg5:
    s_cbranch_execz L_pgr5
    s_waitcnt lgkmcnt(12)
    v_mfma_f32_16x16x32_bf16 v[160:163], a[240:243], v[120:123], v[160:163]
    ds_read_b64_tr_b16 a[136:137], v20 offset:256
    ds_read_b64_tr_b16 a[138:139], v20 offset:2304
    v_mfma_f32_16x16x32_bf16 v[168:171], a[240:243], v[124:127], v[168:171]
    v_exp_f32 v98, v82
    v_mfma_f32_16x16x32_bf16 v[164:167], a[244:247], v[120:123], v[164:167]
    ds_read_b64_tr_b16 a[140:141], v21 offset:256
    ds_read_b64_tr_b16 a[142:143], v21 offset:2304
    v_mfma_f32_16x16x32_bf16 v[172:175], a[244:247], v[124:127], v[172:175]
    v_add_f32 v35, v35, v97
    v_cvt_pk_bf16_f32 v104, v96, v97
    v_mfma_f32_16x16x32_bf16 v[176:179], a[248:251], v[120:123], v[176:179]
    s_barrier
    ds_read_b128 a[224:227], v10 offset:32768
    v_mfma_f32_16x16x32_bf16 v[184:187], a[248:251], v[124:127], v[184:187]
    v_exp_f32 v99, v83
    v_mfma_f32_16x16x32_bf16 v[180:183], a[252:255], v[120:123], v[180:183]
    ds_read_b128 a[228:231], v10 offset:34816
    v_mfma_f32_16x16x32_bf16 v[188:191], a[252:255], v[124:127], v[188:191]
    v_add_f32 v35, v35, v98
    s_waitcnt lgkmcnt(10)
    v_mfma_f32_16x16x32_bf16 v[192:195], a[112:115], v[120:123], v[192:195]
    ds_read_b128 a[232:235], v11 offset:32768
    v_exp_f32 v100, v88
    v_mfma_f32_16x16x32_bf16 v[200:203], a[112:115], v[124:127], v[200:203]
    s_add_u32 m0, s48, 0
    s_waitcnt vmcnt(4)
    buffer_load_dwordx4 v27, s[8:11], s61 offen offset:1024 nt lds
    v_mfma_f32_16x16x32_bf16 v[196:199], a[116:119], v[120:123], v[196:199]
    ds_read_b128 a[236:239], v11 offset:34816
    v_mfma_f32_16x16x32_bf16 v[204:207], a[116:119], v[124:127], v[204:207]
    v_add_f32 v35, v35, v99
    v_cvt_pk_bf16_f32 v105, v98, v99
    v_mfma_f32_16x16x32_bf16 v[208:211], a[120:123], v[120:123], v[208:211]
    v_exp_f32 v101, v89
    v_mfma_f32_16x16x32_bf16 v[216:219], a[120:123], v[124:127], v[216:219]
    ds_read_b128 a[240:243], v12 offset:32768
    v_add_f32 v36, v38, v100
    v_mfma_f32_16x16x32_bf16 v[212:215], a[124:127], v[120:123], v[212:215]
    ds_read_b128 a[244:247], v12 offset:34816
    v_exp_f32 v102, v90
    v_mfma_f32_16x16x32_bf16 v[220:223], a[124:127], v[124:127], v[220:223]
    v_add_f32 v36, v36, v101
    s_waitcnt lgkmcnt(6)
    v_mfma_f32_16x16x32_bf16 v[224:227], a[128:131], v[120:123], v[224:227]
    ds_read_b128 a[248:251], v13 offset:32768
    v_mfma_f32_16x16x32_bf16 v[232:235], a[128:131], v[124:127], v[232:235]
    s_add_u32 m0, s48, 0
    s_waitcnt vmcnt(4)
    buffer_load_dwordx4 v26, s[8:11], s61 offen offset:2048 nt lds
    v_mfma_f32_16x16x32_bf16 v[228:231], a[132:135], v[120:123], v[228:231]
    ds_read_b128 a[252:255], v13 offset:34816
    v_cvt_pk_bf16_f32 v108, v100, v101
    v_mfma_f32_16x16x32_bf16 v[236:239], a[132:135], v[124:127], v[236:239]
    v_exp_f32 v103, v91
    v_add_f32 v36, v36, v102
    v_mfma_f32_16x16x32_bf16 v[240:243], a[136:139], v[120:123], v[240:243]
    v_exp_f32 v96, v84
    v_mfma_f32_16x16x32_bf16 v[248:251], a[136:139], v[124:127], v[248:251]
    ds_read_b128 a[112:115], v10 offset:33024
    v_add_f32 v36, v36, v103
    v_mfma_f32_16x16x32_bf16 v[244:247], a[140:143], v[120:123], v[244:247]
    ds_read_b128 a[116:119], v10 offset:35072
    v_cvt_pk_bf16_f32 v109, v102, v103
    v_mfma_f32_16x16x32_bf16 v[252:255], a[140:143], v[124:127], v[252:255]
    v_exp_f32 v97, v85
    s_waitcnt lgkmcnt(6)
    v_mfma_f32_16x16x32_bf16 v[64:67], a[224:227], a[160:163], v[112:115]
    ds_read_b128 a[120:123], v11 offset:33024
    v_add_f32 v35, v35, v96
    v_mfma_f32_16x16x32_bf16 v[72:75], a[224:227], a[164:167], v[116:119]
    v_exp_f32 v98, v86
    v_mfma_f32_16x16x32_bf16 v[68:71], a[228:231], a[160:163], v[112:115]
    ds_read_b128 a[124:127], v11 offset:35072
    v_mfma_f32_16x16x32_bf16 v[76:79], a[228:231], a[164:167], v[116:119]
    s_add_u32 m0, s48, 0
    s_waitcnt vmcnt(4)
    buffer_load_dwordx4 v27, s[8:11], s61 offen offset:3072 nt lds
    v_mfma_f32_16x16x32_bf16 v[64:67], a[232:235], a[168:171], v[64:67]
    ds_read_b128 a[128:131], v12 offset:33024
    v_add_f32 v35, v35, v97
    v_mfma_f32_16x16x32_bf16 v[72:75], a[232:235], a[172:175], v[72:75]
    v_cvt_pk_bf16_f32 v106, v96, v97
    v_exp_f32 v99, v87
    v_mfma_f32_16x16x32_bf16 v[68:71], a[236:239], a[168:171], v[68:71]
    ds_read_b128 a[132:135], v12 offset:35072
    v_mfma_f32_16x16x32_bf16 v[76:79], a[236:239], a[172:175], v[76:79]
    v_add_f32 v35, v35, v98
    s_waitcnt lgkmcnt(6)
    v_mfma_f32_16x16x32_bf16 v[64:67], a[240:243], a[176:179], v[64:67]
    ds_read_b128 a[136:139], v13 offset:33024
    v_exp_f32 v100, v92
    v_mfma_f32_16x16x32_bf16 v[72:75], a[240:243], a[180:183], v[72:75]
    v_add_f32 v35, v35, v99
    v_cvt_pk_bf16_f32 v107, v98, v99
    v_mfma_f32_16x16x32_bf16 v[68:71], a[244:247], a[176:179], v[68:71]
    ds_read_b128 a[140:143], v13 offset:35072
    v_mfma_f32_16x16x32_bf16 v[76:79], a[244:247], a[180:183], v[76:79]
    s_add_u32 m0, s48, 114688
    s_mov_b32 s61, 114688
    s_waitcnt vmcnt(4)
    buffer_load_dwordx4 v28, s[12:15], s61 offen nt lds
    v_mfma_f32_16x16x32_bf16 v[64:67], a[248:251], a[184:187], v[64:67]
    s_barrier
    v_mfma_f32_16x16x32_bf16 v[72:75], a[248:251], a[188:191], v[72:75]
    ds_read_b64_tr_b16 a[224:225], v14 offset:16384
    ds_read_b64_tr_b16 a[226:227], v14 offset:18432
    v_mfma_f32_16x16x32_bf16 v[68:71], a[252:255], a[184:187], v[68:71]
    ds_read_b64_tr_b16 a[228:229], v15 offset:16384
    ds_read_b64_tr_b16 a[230:231], v15 offset:18432
    v_mfma_f32_16x16x32_bf16 v[76:79], a[252:255], a[188:191], v[76:79]
    v_exp_f32 v101, v93
    s_waitcnt lgkmcnt(8)
    v_mfma_f32_16x16x32_bf16 v[64:67], a[112:115], a[192:195], v[64:67]
    ds_read_b64_tr_b16 a[232:233], v16 offset:16384
    ds_read_b64_tr_b16 a[234:235], v16 offset:18432
    v_mfma_f32_16x16x32_bf16 v[72:75], a[112:115], a[196:199], v[72:75]
    v_add_f32 v36, v36, v100
    v_mfma_f32_16x16x32_bf16 v[68:71], a[116:119], a[192:195], v[68:71]
    ds_read_b64_tr_b16 a[236:237], v17 offset:16384
    ds_read_b64_tr_b16 a[238:239], v17 offset:18432
    v_mfma_f32_16x16x32_bf16 v[76:79], a[116:119], a[196:199], v[76:79]
    v_exp_f32 v102, v94
    v_add_f32 v36, v36, v101
    v_mfma_f32_16x16x32_bf16 v[64:67], a[120:123], a[200:203], v[64:67]
    ds_read_b64_tr_b16 a[240:241], v18 offset:16384
    ds_read_b64_tr_b16 a[242:243], v18 offset:18432
    v_mfma_f32_16x16x32_bf16 v[72:75], a[120:123], a[204:207], v[72:75]
    s_add_u32 m0, s48, 114688
    s_waitcnt vmcnt(4)
    buffer_load_dwordx4 v29, s[12:15], s61 offen offset:1024 nt lds
    v_mfma_f32_16x16x32_bf16 v[68:71], a[124:127], a[200:203], v[68:71]
    ds_read_b64_tr_b16 a[244:245], v19 offset:16384
    ds_read_b64_tr_b16 a[246:247], v19 offset:18432
    v_mfma_f32_16x16x32_bf16 v[76:79], a[124:127], a[204:207], v[76:79]
    v_cvt_pk_bf16_f32 v110, v100, v101
    s_waitcnt lgkmcnt(12)
    v_mfma_f32_16x16x32_bf16 v[64:67], a[128:131], a[208:211], v[64:67]
    ds_read_b64_tr_b16 a[248:249], v20 offset:16384
    ds_read_b64_tr_b16 a[250:251], v20 offset:18432
    v_mfma_f32_16x16x32_bf16 v[72:75], a[128:131], a[212:215], v[72:75]
    v_exp_f32 v103, v95
    v_add_f32 v36, v36, v102
    v_mfma_f32_16x16x32_bf16 v[68:71], a[132:135], a[208:211], v[68:71]
    ds_read_b64_tr_b16 a[252:253], v21 offset:16384
    ds_read_b64_tr_b16 a[254:255], v21 offset:18432
    v_mfma_f32_16x16x32_bf16 v[76:79], a[132:135], a[212:215], v[76:79]
    v_add_f32 v36, v36, v103
    v_cvt_pk_bf16_f32 v111, v102, v103
    v_mfma_f32_16x16x32_bf16 v[64:67], a[136:139], a[216:219], v[64:67]
    ds_read_b64_tr_b16 a[112:113], v14 offset:16640
    ds_read_b64_tr_b16 a[114:115], v14 offset:18688
    v_mfma_f32_16x16x32_bf16 v[72:75], a[136:139], a[220:223], v[72:75]
    s_add_u32 m0, s48, 114688
    s_waitcnt vmcnt(4)
    buffer_load_dwordx4 v28, s[12:15], s61 offen offset:2048 nt lds
    v_mfma_f32_16x16x32_bf16 v[68:71], a[140:143], a[216:219], v[68:71]
    v_max_f32 v39, v35, v36
    v_cmp_lt_f32 vcc, s55, v39
    s_cbranch_vccz L_nm6
    s_call_b64 s[58:59], L_fixp1
L_nm6:
    v_mfma_f32_16x16x32_bf16 v[76:79], a[140:143], a[220:223], v[76:79]
    ds_read_b64_tr_b16 a[116:117], v15 offset:16640
    ds_read_b64_tr_b16 a[118:119], v15 offset:18688
    s_waitcnt lgkmcnt(12)
    v_mfma_f32_16x16x32_bf16 v[128:131], a[224:227], v[104:107], v[128:131]
    ds_read_b64_tr_b16 a[120:121], v16 offset:16640
    v_mfma_f32_16x16x32_bf16 v[136:139], a[224:227], v[108:111], v[136:139]
    ds_read_b64_tr_b16 a[122:123], v16 offset:18688
    v_mfma_f32_16x16x32_bf16 v[132:135], a[228:231], v[104:107], v[132:135]
    ds_read_b64_tr_b16 a[124:125], v17 offset:16640
    ds_read_b64_tr_b16 a[126:127], v17 offset:18688
    v_mfma_f32_16x16x32_bf16 v[140:143], a[228:231], v[108:111], v[140:143]
    v_exp_f32 v96, v64
    v_mfma_f32_16x16x32_bf16 v[144:147], a[232:235], v[104:107], v[144:147]
    ds_read_b64_tr_b16 a[128:129], v18 offset:16640
    ds_read_b64_tr_b16 a[130:131], v18 offset:18688
    v_mfma_f32_16x16x32_bf16 v[152:155], a[232:235], v[108:111], v[152:155]
    s_add_u32 m0, s48, 114688
    s_waitcnt vmcnt(4)
    buffer_load_dwordx4 v29, s[12:15], s61 offen offset:3072 nt lds
    v_mfma_f32_16x16x32_bf16 v[148:151], a[236:239], v[104:107], v[148:151]
    ds_read_b64_tr_b16 a[132:133], v19 offset:16640
    ds_read_b64_tr_b16 a[134:135], v19 offset:18688
    v_mfma_f32_16x16x32_bf16 v[156:159], a[236:239], v[108:111], v[156:159]
    v_exp_f32 v97, v65
    s_waitcnt lgkmcnt(12)
    v_mfma_f32_16x16x32_bf16 v[160:163], a[240:243], v[104:107], v[160:163]
    ds_read_b64_tr_b16 a[136:137], v20 offset:16640
    ds_read_b64_tr_b16 a[138:139], v20 offset:18688
    v_mfma_f32_16x16x32_bf16 v[168:171], a[240:243], v[108:111], v[168:171]
    v_add_f32 v37, v35, v96
    v_exp_f32 v98, v66
    v_mfma_f32_16x16x32_bf16 v[164:167], a[244:247], v[104:107], v[164:167]
    ds_read_b64_tr_b16 a[140:141], v21 offset:16640
    ds_read_b64_tr_b16 a[142:143], v21 offset:18688
    v_mfma_f32_16x16x32_bf16 v[172:175], a[244:247], v[108:111], v[172:175]
    v_add_f32 v37, v37, v97
    v_mfma_f32_16x16x32_bf16 v[176:179], a[248:251], v[104:107], v[176:179]
    s_barrier
    ds_read_b128 a[224:227], v10 offset:49152
    v_mfma_f32_16x16x32_bf16 v[184:187], a[248:251], v[108:111], v[184:187]
    s_add_u32 m0, s48, 16384
    s_mov_b32 s61, 147456
    s_waitcnt vmcnt(4)
    buffer_load_dwordx4 v26, s[8:11], s61 offen nt lds
    v_mfma_f32_16x16x32_bf16 v[180:183], a[252:255], v[104:107], v[180:183]
    ds_read_b128 a[228:231], v10 offset:51200
    v_cvt_pk_bf16_f32 v120, v96, v97
    v_mfma_f32_16x16x32_bf16 v[188:191], a[252:255], v[108:111], v[188:191]
    v_exp_f32 v99, v67
    s_waitcnt lgkmcnt(10)
    v_mfma_f32_16x16x32_bf16 v[192:195], a[112:115], v[104:107], v[192:195]
    ds_read_b128 a[232:235], v11 offset:49152
    v_mfma_f32_16x16x32_bf16 v[200:203], a[112:115], v[108:111], v[200:203]
    s_mov_b64 exec, 0
    s_cmp_eq_u32 s4, 1
    s_cbranch_scc1 L_pg10
    s_cmp_eq_u32 s4, 2
    s_cbranch_scc1 L_pg11
    s_branch L_pg9
L_pgr9:
    s_mov_b64 exec, -1
    s_nop 3
    v_mfma_f32_16x16x32_bf16 v[196:199], a[116:119], v[104:107], v[196:199]
    ds_read_b128 a[236:239], v11 offset:51200
    v_add_f32 v37, v37, v98
    v_mfma_f32_16x16x32_bf16 v[204:207], a[116:119], v[108:111], v[204:207]
    v_exp_f32 v100, v72
    v_mfma_f32_16x16x32_bf16 v[208:211], a[120:123], v[104:107], v[208:211]
    ds_read_b128 a[240:243], v12 offset:49152
    v_add_f32 v37, v37, v99
    v_mfma_f32_16x16x32_bf16 v[216:219], a[120:123], v[108:111], v[216:219]
    v_cvt_pk_bf16_f32 v121, v98, v99
    v_exp_f32 v101, v73
    v_mfma_f32_16x16x32_bf16 v[212:215], a[124:127], v[104:107], v[212:215]
    s_add_u32 m0, s48, 16384
    s_waitcnt vmcnt(4)
    buffer_load_dwordx4 v27, s[8:11], s61 offen offset:1024 nt lds
    v_mfma_f32_16x16x32_bf16 v[220:223], a[124:127], v[108:111], v[220:223]
    ds_read_b128 a[244:247], v12 offset:51200
    s_waitcnt lgkmcnt(6)
    v_mfma_f32_16x16x32_bf16 v[224:227], a[128:131], v[104:107], v[224:227]
    ds_read_b128 a[248:251], v13 offset:49152
    v_add_f32 v38, v36, v100
    v_mfma_f32_16x16x32_bf16 v[232:235], a[128:131], v[108:111], v[232:235]
    v_exp_f32 v102, v74
    v_mfma_f32_16x16x32_bf16 v[228:231], a[132:135], v[104:107], v[228:231]
    ds_read_b128 a[252:255], v13 offset:51200
    v_add_f32 v38, v38, v101
    v_mfma_f32_16x16x32_bf16 v[236:239], a[132:135], v[108:111], v[236:239]
    v_cvt_pk_bf16_f32 v124, v100, v101
    v_exp_f32 v103, v75
    v_mfma_f32_16x16x32_bf16 v[240:243], a[136:139], v[104:107], v[240:243]
    ds_read_b128 a[112:115], v10 offset:49408
    v_add_f32 v38, v38, v102
    v_mfma_f32_16x16x32_bf16 v[248:251], a[136:139], v[108:111], v[248:251]
    v_exp_f32 v96, v68
    v_mfma_f32_16x16x32_bf16 v[244:247], a[140:143], v[104:107], v[244:247]
    s_add_u32 m0, s48, 16384
    s_waitcnt vmcnt(4)
    buffer_load_dwordx4 v26, s[8:11], s61 offen offset:2048 nt lds
    v_mfma_f32_16x16x32_bf16 v[252:255], a[140:143], v[108:111], v[252:255]
    ds_read_b128 a[116:119], v10 offset:51456
    s_waitcnt lgkmcnt(6)
    v_mfma_f32_16x16x32_bf16 v[80:83], a[224:227], a[160:163], v[112:115]
    ds_read_b128 a[120:123], v11 offset:49408
    v_mfma_f32_16x16x32_bf16 v[88:91], a[224:227], a[164:167], v[116:119]
    v_add_f32 v38, v38, v103
    v_cvt_pk_bf16_f32 v125, v102, v103
    v_mfma_f32_16x16x32_bf16 v[84:87], a[228:231], a[160:163], v[112:115]
    ds_read_b128 a[124:127], v11 offset:51456
    v_exp_f32 v97, v69
    v_mfma_f32_16x16x32_bf16 v[92:95], a[228:231], a[164:167], v[116:119]
    v_add_f32 v37, v37, v96
    v_exp_f32 v98, v70
    v_mfma_f32_16x16x32_bf16 v[80:83], a[232:235], a[168:171], v[80:83]
    ds_read_b128 a[128:131], v12 offset:49408
    v_mfma_f32_16x16x32_bf16 v[88:91], a[232:235], a[172:175], v[88:91]
    v_add_f32 v37, v37, v97
    v_cvt_pk_bf16_f32 v122, v96, v97
    v_mfma_f32_16x16x32_bf16 v[84:87], a[236:239], a[168:171], v[84:87]
    ds_read_b128 a[132:135], v12 offset:51456
    v_exp_f32 v99, v71
    v_mfma_f32_16x16x32_bf16 v[92:95], a[236:239], a[172:175], v[92:95]
    v_add_f32 v37, v37, v98
    s_waitcnt lgkmcnt(6)
    v_mfma_f32_16x16x32_bf16 v[80:83], a[240:243], a[176:179], v[80:83]
    ds_read_b128 a[136:139], v13 offset:49408
    v_mfma_f32_16x16x32_bf16 v[88:91], a[240:243], a[180:183], v[88:91]
    s_add_u32 m0, s48, 16384
    s_waitcnt vmcnt(4)
    buffer_load_dwordx4 v27, s[8:11], s61 offen offset:3072 nt lds
    v_mfma_f32_16x16x32_bf16 v[84:87], a[244:247], a[176:179], v[84:87]
    ds_read_b128 a[140:143], v13 offset:51456
    v_exp_f32 v100, v76
    v_mfma_f32_16x16x32_bf16 v[92:95], a[244:247], a[180:183], v[92:95]
    v_add_f32 v37, v37, v99
    v_cvt_pk_bf16_f32 v123, v98, v99
    v_mfma_f32_16x16x32_bf16 v[80:83], a[248:251], a[184:187], v[80:83]
    s_barrier
    v_mfma_f32_16x16x32_bf16 v[88:91], a[248:251], a[188:191], v[88:91]
    ds_read_b64_tr_b16 a[224:225], v14 offset:32768
    ds_read_b64_tr_b16 a[226:227], v14 offset:34816
    v_mfma_f32_16x16x32_bf16 v[84:87], a[252:255], a[184:187], v[84:87]
    ds_read_b64_tr_b16 a[228:229], v15 offset:32768
    ds_read_b64_tr_b16 a[230:231], v15 offset:34816
    v_mfma_f32_16x16x32_bf16 v[92:95], a[252:255], a[188:191], v[92:95]
    v_exp_f32 v101, v77
    s_waitcnt lgkmcnt(8)
    v_mfma_f32_16x16x32_bf16 v[80:83], a[112:115], a[192:195], v[80:83]
    ds_read_b64_tr_b16 a[232:233], v16 offset:32768
    ds_read_b64_tr_b16 a[234:235], v16 offset:34816
    v_mfma_f32_16x16x32_bf16 v[88:91], a[112:115], a[196:199], v[88:91]
    s_add_u32 m0, s48, 65536
    s_mov_b32 s61, 131072
    s_waitcnt vmcnt(4)
    buffer_load_dwordx4 v28, s[12:15], s61 offen nt lds
    v_mfma_f32_16x16x32_bf16 v[84:87], a[116:119], a[192:195], v[84:87]
    ds_read_b64_tr_b16 a[236:237], v17 offset:32768
    ds_read_b64_tr_b16 a[238:239], v17 offset:34816
    v_mfma_f32_16x16x32_bf16 v[92:95], a[116:119], a[196:199], v[92:95]
    v_add_f32 v38, v38, v100
    v_mfma_f32_16x16x32_bf16 v[80:83], a[120:123], a[200:203], v[80:83]
    ds_read_b64_tr_b16 a[240:241], v18 offset:32768
    ds_read_b64_tr_b16 a[242:243], v18 offset:34816
    v_mfma_f32_16x16x32_bf16 v[88:91], a[120:123], a[204:207], v[88:91]
    v_exp_f32 v102, v78
    v_add_f32 v38, v38, v101
    v_mfma_f32_16x16x32_bf16 v[84:87], a[124:127], a[200:203], v[84:87]
    ds_read_b64_tr_b16 a[244:245], v19 offset:32768
    ds_read_b64_tr_b16 a[246:247], v19 offset:34816
    v_mfma_f32_16x16x32_bf16 v[92:95], a[124:127], a[204:207], v[92:95]
    v_cvt_pk_bf16_f32 v126, v100, v101
    s_waitcnt lgkmcnt(12)
    v_mfma_f32_16x16x32_bf16 v[80:83], a[128:131], a[208:211], v[80:83]
    ds_read_b64_tr_b16 a[248:249], v20 offset:32768
    ds_read_b64_tr_b16 a[250:251], v20 offset:34816
    v_mfma_f32_16x16x32_bf16 v[88:91], a[128:131], a[212:215], v[88:91]
    v_exp_f32 v103, v79
    v_add_f32 v38, v38, v102
    v_mfma_f32_16x16x32_bf16 v[84:87], a[132:135], a[208:211], v[84:87]
    ds_read_b64_tr_b16 a[252:253], v21 offset:32768
    ds_read_b64_tr_b16 a[254:255], v21 offset:34816
    v_mfma_f32_16x16x32_bf16 v[92:95], a[132:135], a[212:215], v[92:95]
    s_add_u32 m0, s48, 65536
    s_waitcnt vmcnt(4)
    buffer_load_dwordx4 v29, s[12:15], s61 offen offset:1024 nt lds
    v_mfma_f32_16x16x32_bf16 v[80:83], a[136:139], a[216:219], v[80:83]
    ds_read_b64_tr_b16 a[112:113], v14 offset:33024
    ds_read_b64_tr_b16 a[114:115], v14 offset:35072
    v_mfma_f32_16x16x32_bf16 v[88:91], a[136:139], a[220:223], v[88:91]
    v_add_f32 v38, v38, v103
    v_cvt_pk_bf16_f32 v127, v102, v103
    v_mfma_f32_16x16x32_bf16 v[84:87], a[140:143], a[216:219], v[84:87]
    v_max_f32 v39, v37, v38
    v_cmp_lt_f32 vcc, s55, v39
    s_cbranch_vccz L_nm7
    s_call_b64 s[58:59], L_fixp0
L_nm7:
    v_mfma_f32_16x16x32_bf16 v[92:95], a[140:143], a[220:223], v[92:95]
    ds_read_b64_tr_b16 a[116:117], v15 offset:33024
    ds_read_b64_tr_b16 a[118:119], v15 offset:35072
    s_waitcnt lgkmcnt(12)
    v_mfma_f32_16x16x32_bf16 v[128:131], a[224:227], v[120:123], v[128:131]
    ds_read_b64_tr_b16 a[120:121], v16 offset:33024
    v_mfma_f32_16x16x32_bf16 v[136:139], a[224:227], v[124:127], v[136:139]
    ds_read_b64_tr_b16 a[122:123], v16 offset:35072
    v_mfma_f32_16x16x32_bf16 v[132:135], a[228:231], v[120:123], v[132:135]
    ds_read_b64_tr_b16 a[124:125], v17 offset:33024
    ds_read_b64_tr_b16 a[126:127], v17 offset:35072
    v_mfma_f32_16x16x32_bf16 v[140:143], a[228:231], v[124:127], v[140:143]
    s_add_u32 m0, s48, 65536
    s_waitcnt vmcnt(4)
    buffer_load_dwordx4 v28, s[12:15], s61 offen offset:2048 nt lds
    v_mfma_f32_16x16x32_bf16 v[144:147], a[232:235], v[120:123], v[144:147]
    ds_read_b64_tr_b16 a[128:129], v18 offset:33024
    ds_read_b64_tr_b16 a[130:131], v18 offset:35072
    v_mfma_f32_16x16x32_bf16 v[152:155], a[232:235], v[124:127], v[152:155]
    v_exp_f32 v96, v80
    v_mfma_f32_16x16x32_bf16 v[148:151], a[236:239], v[120:123], v[148:151]
    ds_read_b64_tr_b16 a[132:133], v19 offset:33024
    ds_read_b64_tr_b16 a[134:135], v19 offset:35072
    v_mfma_f32_16x16x32_bf16 v[156:159], a[236:239], v[124:127], v[156:159]
    v_exp_f32 v97, v81
    s_waitcnt lgkmcnt(12)
    v_mfma_f32_16x16x32_bf16 v[160:163], a[240:243], v[120:123], v[160:163]
    ds_read_b64_tr_b16 a[136:137], v20 offset:33024
    ds_read_b64_tr_b16 a[138:139], v20 offset:35072
    v_mfma_f32_16x16x32_bf16 v[168:171], a[240:243], v[124:127], v[168:171]
    v_add_f32 v35, v37, v96
    v_mfma_f32_16x16x32_bf16 v[164:167], a[244:247], v[120:123], v[164:167]
    ds_read_b64_tr_b16 a[140:141], v21 offset:33024
    ds_read_b64_tr_b16 a[142:143], v21 offset:35072
    v_mfma_f32_16x16x32_bf16 v[172:175], a[244:247], v[124:127], v[172:175]
    v_exp_f32 v98, v82
    v_add_f32 v35, v35, v97
    v_mfma_f32_16x16x32_bf16 v[176:179], a[248:251], v[120:123], v[176:179]
    s_barrier
    ds_read_b128 a[224:227], v10 offset:0
    v_mfma_f32_16x16x32_bf16 v[184:187], a[248:251], v[124:127], v[184:187]
    s_add_u32 m0, s48, 65536
    s_waitcnt vmcnt(4)
    buffer_load_dwordx4 v29, s[12:15], s61 offen offset:3072 nt lds
    v_mfma_f32_16x16x32_bf16 v[180:183], a[252:255], v[120:123], v[180:183]
    ds_read_b128 a[228:231], v10 offset:2048
    v_cvt_pk_bf16_f32 v104, v96, v97
    v_mfma_f32_16x16x32_bf16 v[188:191], a[252:255], v[124:127], v[188:191]
    v_exp_f32 v99, v83
    s_waitcnt lgkmcnt(10)
    v_mfma_f32_16x16x32_bf16 v[192:195], a[112:115], v[120:123], v[192:195]
    ds_read_b128 a[232:235], v11 offset:0
    v_add_f32 v35, v35, v98
    v_mfma_f32_16x16x32_bf16 v[200:203], a[112:115], v[124:127], v[200:203]
    v_exp_f32 v100, v88
    v_mfma_f32_16x16x32_bf16 v[196:199], a[116:119], v[120:123], v[196:199]
    ds_read_b128 a[236:239], v11 offset:2048
    v_mfma_f32_16x16x32_bf16 v[204:207], a[116:119], v[124:127], v[204:207]
    v_add_f32 v35, v35, v99
    v_cvt_pk_bf16_f32 v105, v98, v99
    v_mfma_f32_16x16x32_bf16 v[208:211], a[120:123], v[120:123], v[208:211]
    ds_read_b128 a[240:243], v12 offset:0
    v_mfma_f32_16x16x32_bf16 v[216:219], a[120:123], v[124:127], v[216:219]
    s_add_u32 m0, s48, 32768
    s_mov_b32 s61, 163840
    s_waitcnt vmcnt(4)
    buffer_load_dwordx4 v26, s[8:11], s61 offen nt lds
    v_mfma_f32_16x16x32_bf16 v[212:215], a[124:127], v[120:123], v[212:215]
    ds_read_b128 a[244:247], v12 offset:2048
    v_exp_f32 v101, v89
    v_mfma_f32_16x16x32_bf16 v[220:223], a[124:127], v[124:127], v[220:223]
    v_add_f32 v36, v38, v100
    s_waitcnt lgkmcnt(6)
    v_mfma_f32_16x16x32_bf16 v[224:227], a[128:131], v[120:123], v[224:227]
    v_exp_f32 v102, v90
    v_mfma_f32_16x16x32_bf16 v[232:235], a[128:131], v[124:127], v[232:235]
    ds_read_b128 a[248:251], v13 offset:0
    v_add_f32 v36, v36, v101
    v_mfma_f32_16x16x32_bf16 v[228:231], a[132:135], v[120:123], v[228:231]
    ds_read_b128 a[252:255], v13 offset:2048
    v_cvt_pk_bf16_f32 v108, v100, v101
    v_mfma_f32_16x16x32_bf16 v[236:239], a[132:135], v[124:127], v[236:239]
    v_exp_f32 v103, v91
    v_mfma_f32_16x16x32_bf16 v[240:243], a[136:139], v[120:123], v[240:243]
    ds_read_b128 a[112:115], v10 offset:256
    v_add_f32 v36, v36, v102
    v_mfma_f32_16x16x32_bf16 v[248:251], a[136:139], v[124:127], v[248:251]
    v_exp_f32 v96, v84
    v_mfma_f32_16x16x32_bf16 v[244:247], a[140:143], v[120:123], v[244:247]
    s_add_u32 m0, s48, 32768
    s_waitcnt vmcnt(4)
    buffer_load_dwordx4 v27, s[8:11], s61 offen offset:1024 nt lds
    v_mfma_f32_16x16x32_bf16 v[252:255], a[140:143], v[124:127], v[252:255]
    ds_read_b128 a[116:119], v10 offset:2304
    s_waitcnt lgkmcnt(6)
    v_mfma_f32_16x16x32_bf16 v[64:67], a[224:227], a[160:163], v[112:115]
    ds_read_b128 a[120:123], v11 offset:256
    v_add_f32 v36, v36, v103
    v_mfma_f32_16x16x32_bf16 v[72:75], a[224:227], a[164:167], v[116:119]
    v_cvt_pk_bf16_f32 v109, v102, v103
    v_exp_f32 v97, v85
    v_mfma_f32_16x16x32_bf16 v[68:71], a[228:231], a[160:163], v[112:115]
    ds_read_b128 a[124:127], v11 offset:2304
    v_add_f32 v35, v35, v96
    v_mfma_f32_16x16x32_bf16 v[76:79], a[228:231], a[164:167], v[116:119]
    v_exp_f32 v98, v86
    v_mfma_f32_16x16x32_bf16 v[64:67], a[232:235], a[168:171], v[64:67]
    ds_read_b128 a[128:131], v12 offset:256
    v_add_f32 v35, v35, v97
    v_mfma_f32_16x16x32_bf16 v[72:75], a[232:235], a[172:175], v[72:75]
    v_cvt_pk_bf16_f32 v106, v96, v97
    v_exp_f32 v99, v87
    v_mfma_f32_16x16x32_bf16 v[68:71], a[236:239], a[168:171], v[68:71]
    s_add_u32 m0, s48, 32768
    s_waitcnt vmcnt(4)
    buffer_load_dwordx4 v26, s[8:11], s61 offen offset:2048 nt lds
    v_mfma_f32_16x16x32_bf16 v[76:79], a[236:239], a[172:175], v[76:79]
    ds_read_b128 a[132:135], v12 offset:2304
    s_waitcnt lgkmcnt(6)
    v_mfma_f32_16x16x32_bf16 v[64:67], a[240:243], a[176:179], v[64:67]
    ds_read_b128 a[136:139], v13 offset:256
    v_add_f32 v35, v35, v98
    v_mfma_f32_16x16x32_bf16 v[72:75], a[240:243], a[180:183], v[72:75]
    v_exp_f32 v100, v92
    v_mfma_f32_16x16x32_bf16 v[68:71], a[244:247], a[176:179], v[68:71]
    ds_read_b128 a[140:143], v13 offset:2304
    v_mfma_f32_16x16x32_bf16 v[76:79], a[244:247], a[180:183], v[76:79]
    v_add_f32 v35, v35, v99
    v_cvt_pk_bf16_f32 v107, v98, v99
    v_mfma_f32_16x16x32_bf16 v[64:67], a[248:251], a[184:187], v[64:67]
    s_barrier
    v_mfma_f32_16x16x32_bf16 v[72:75], a[248:251], a[188:191], v[72:75]
    ds_read_b64_tr_b16 a[224:225], v14 offset:49152
    ds_read_b64_tr_b16 a[226:227], v14 offset:51200
    v_mfma_f32_16x16x32_bf16 v[68:71], a[252:255], a[184:187], v[68:71]
    ds_read_b64_tr_b16 a[228:229], v15 offset:49152
    ds_read_b64_tr_b16 a[230:231], v15 offset:51200
    v_mfma_f32_16x16x32_bf16 v[76:79], a[252:255], a[188:191], v[76:79]
    v_exp_f32 v101, v93
    s_waitcnt lgkmcnt(8)
    v_mfma_f32_16x16x32_bf16 v[64:67], a[112:115], a[192:195], v[64:67]
    ds_read_b64_tr_b16 a[232:233], v16 offset:49152
    ds_read_b64_tr_b16 a[234:235], v16 offset:51200
    v_mfma_f32_16x16x32_bf16 v[72:75], a[112:115], a[196:199], v[72:75]
    s_add_u32 m0, s48, 32768
    s_waitcnt vmcnt(4)
    buffer_load_dwordx4 v27, s[8:11], s61 offen offset:3072 nt lds
    v_mfma_f32_16x16x32_bf16 v[68:71], a[116:119], a[192:195], v[68:71]
    ds_read_b64_tr_b16 a[236:237], v17 offset:49152
    ds_read_b64_tr_b16 a[238:239], v17 offset:51200
    v_mfma_f32_16x16x32_bf16 v[76:79], a[116:119], a[196:199], v[76:79]
    v_add_f32 v36, v36, v100
    v_exp_f32 v102, v94
    v_mfma_f32_16x16x32_bf16 v[64:67], a[120:123], a[200:203], v[64:67]
    ds_read_b64_tr_b16 a[240:241], v18 offset:49152
    ds_read_b64_tr_b16 a[242:243], v18 offset:51200
    v_mfma_f32_16x16x32_bf16 v[72:75], a[120:123], a[204:207], v[72:75]
    v_add_f32 v36, v36, v101
    v_mfma_f32_16x16x32_bf16 v[68:71], a[124:127], a[200:203], v[68:71]
    ds_read_b64_tr_b16 a[244:245], v19 offset:49152
    ds_read_b64_tr_b16 a[246:247], v19 offset:51200
    v_mfma_f32_16x16x32_bf16 v[76:79], a[124:127], a[204:207], v[76:79]
    v_cvt_pk_bf16_f32 v110, v100, v101
    s_waitcnt lgkmcnt(12)
    v_mfma_f32_16x16x32_bf16 v[64:67], a[128:131], a[208:211], v[64:67]
    ds_read_b64_tr_b16 a[248:249], v20 offset:49152
    ds_read_b64_tr_b16 a[250:251], v20 offset:51200
    v_mfma_f32_16x16x32_bf16 v[72:75], a[128:131], a[212:215], v[72:75]
    s_add_u32 m0, s48, 81920
    s_mov_b32 s61, 147456
    s_waitcnt vmcnt(4)
    buffer_load_dwordx4 v28, s[12:15], s61 offen nt lds
    v_mfma_f32_16x16x32_bf16 v[68:71], a[132:135], a[208:211], v[68:71]
    ds_read_b64_tr_b16 a[252:253], v21 offset:49152
    ds_read_b64_tr_b16 a[254:255], v21 offset:51200
    v_mfma_f32_16x16x32_bf16 v[76:79], a[132:135], a[212:215], v[76:79]
    v_exp_f32 v103, v95
    v_add_f32 v36, v36, v102
    v_mfma_f32_16x16x32_bf16 v[64:67], a[136:139], a[216:219], v[64:67]
    ds_read_b64_tr_b16 a[112:113], v14 offset:49408
    ds_read_b64_tr_b16 a[114:115], v14 offset:51456
    v_mfma_f32_16x16x32_bf16 v[72:75], a[136:139], a[220:223], v[72:75]
    v_add_f32 v36, v36, v103
    v_cvt_pk_bf16_f32 v111, v102, v103
    v_mfma_f32_16x16x32_bf16 v[68:71], a[140:143], a[216:219], v[68:71]
    v_max_f32 v39, v35, v36
    v_cmp_lt_f32 vcc, s55, v39
    s_cbranch_vccz L_nm8
    s_call_b64 s[58:59], L_fixp1
L_nm8:
    v_mfma_f32_16x16x32_bf16 v[76:79], a[140:143], a[220:223], v[76:79]
    ds_read_b64_tr_b16 a[116:117], v15 offset:49408
    ds_read_b64_tr_b16 a[118:119], v15 offset:51456
    s_waitcnt lgkmcnt(12)
    v_mfma_f32_16x16x32_bf16 v[128:131], a[224:227], v[104:107], v[128:131]
    ds_read_b64_tr_b16 a[120:121], v16 offset:49408
    v_mfma_f32_16x16x32_bf16 v[136:139], a[224:227], v[108:111], v[136:139]
    ds_read_b64_tr_b16 a[122:123], v16 offset:51456
    v_mfma_f32_16x16x32_bf16 v[132:135], a[228:231], v[104:107], v[132:135]
    ds_read_b64_tr_b16 a[124:125], v17 offset:49408
    ds_read_b64_tr_b16 a[126:127], v17 offset:51456
    v_mfma_f32_16x16x32_bf16 v[140:143], a[228:231], v[108:111], v[140:143]
    s_add_u32 m0, s48, 81920
    s_waitcnt vmcnt(4)
    buffer_load_dwordx4 v29, s[12:15], s61 offen offset:1024 nt lds
    v_mfma_f32_16x16x32_bf16 v[144:147], a[232:235], v[104:107], v[144:147]
    ds_read_b64_tr_b16 a[128:129], v18 offset:49408
    ds_read_b64_tr_b16 a[130:131], v18 offset:51456
    v_mfma_f32_16x16x32_bf16 v[152:155], a[232:235], v[108:111], v[152:155]
    v_exp_f32 v96, v64
    v_mfma_f32_16x16x32_bf16 v[148:151], a[236:239], v[104:107], v[148:151]
    ds_read_b64_tr_b16 a[132:133], v19 offset:49408
    ds_read_b64_tr_b16 a[134:135], v19 offset:51456
    v_mfma_f32_16x16x32_bf16 v[156:159], a[236:239], v[108:111], v[156:159]
    v_exp_f32 v97, v65
    s_waitcnt lgkmcnt(12)
    v_mfma_f32_16x16x32_bf16 v[160:163], a[240:243], v[104:107], v[160:163]
    ds_read_b64_tr_b16 a[136:137], v20 offset:49408
    ds_read_b64_tr_b16 a[138:139], v20 offset:51456
    v_mfma_f32_16x16x32_bf16 v[168:171], a[240:243], v[108:111], v[168:171]
    v_add_f32 v37, v35, v96
    v_mfma_f32_16x16x32_bf16 v[164:167], a[244:247], v[104:107], v[164:167]
    ds_read_b64_tr_b16 a[140:141], v21 offset:49408
    ds_read_b64_tr_b16 a[142:143], v21 offset:51456
    v_mfma_f32_16x16x32_bf16 v[172:175], a[244:247], v[108:111], v[172:175]
    s_add_u32 m0, s48, 81920
    s_waitcnt vmcnt(4)
    buffer_load_dwordx4 v28, s[12:15], s61 offen offset:2048 nt lds
    v_mfma_f32_16x16x32_bf16 v[176:179], a[248:251], v[104:107], v[176:179]
    s_barrier
    ds_read_b128 a[224:227], v10 offset:16384
    v_mfma_f32_16x16x32_bf16 v[184:187], a[248:251], v[108:111], v[184:187]
    v_exp_f32 v98, v66
    v_mfma_f32_16x16x32_bf16 v[180:183], a[252:255], v[104:107], v[180:183]
    ds_read_b128 a[228:231], v10 offset:18432
    v_add_f32 v37, v37, v97
    v_mfma_f32_16x16x32_bf16 v[188:191], a[252:255], v[108:111], v[188:191]
    v_cvt_pk_bf16_f32 v120, v96, v97
    s_waitcnt lgkmcnt(10)
    v_mfma_f32_16x16x32_bf16 v[192:195], a[112:115], v[104:107], v[192:195]
    v_exp_f32 v99, v67
    v_mfma_f32_16x16x32_bf16 v[200:203], a[112:115], v[108:111], v[200:203]
L_pg6:
    s_cbranch_execz L_pgr5
    ds_read_b128 a[232:235], v11 offset:16384
    v_add_f32 v37, v37, v98
    v_mfma_f32_16x16x32_bf16 v[196:199], a[116:119], v[104:107], v[196:199]
    ds_read_b128 a[236:239], v11 offset:18432
    v_exp_f32 v100, v72
    v_mfma_f32_16x16x32_bf16 v[204:207], a[116:119], v[108:111], v[204:207]
    v_add_f32 v37, v37, v99
    v_cvt_pk_bf16_f32 v121, v98, v99
    v_mfma_f32_16x16x32_bf16 v[208:211], a[120:123], v[104:107], v[208:211]
    ds_read_b128 a[240:243], v12 offset:16384
    v_mfma_f32_16x16x32_bf16 v[216:219], a[120:123], v[108:111], v[216:219]
    s_add_u32 m0, s48, 81920
    s_waitcnt vmcnt(4)
    buffer_load_dwordx4 v29, s[12:15], s61 offen offset:3072 nt lds
    v_mfma_f32_16x16x32_bf16 v[212:215], a[124:127], v[104:107], v[212:215]
    v_exp_f32 v101, v73
    v_mfma_f32_16x16x32_bf16 v[220:223], a[124:127], v[108:111], v[220:223]
    ds_read_b128 a[244:247], v12 offset:18432
    s_waitcnt lgkmcnt(6)
    v_mfma_f32_16x16x32_bf16 v[224:227], a[128:131], v[104:107], v[224:227]
    ds_read_b128 a[248:251], v13 offset:16384
    v_add_f32 v38, v36, v100
    v_mfma_f32_16x16x32_bf16 v[232:235], a[128:131], v[108:111], v[232:235]
    v_exp_f32 v102, v74
    v_add_f32 v38, v38, v101
    v_mfma_f32_16x16x32_bf16 v[228:231], a[132:135], v[104:107], v[228:231]
    ds_read_b128 a[252:255], v13 offset:18432
    v_cvt_pk_bf16_f32 v124, v100, v101
    v_mfma_f32_16x16x32_bf16 v[236:239], a[132:135], v[108:111], v[236:239]
    v_exp_f32 v103, v75
    v_mfma_f32_16x16x32_bf16 v[240:243], a[136:139], v[104:107], v[240:243]
    ds_read_b128 a[112:115], v10 offset:16640
    v_mfma_f32_16x16x32_bf16 v[248:251], a[136:139], v[108:111], v[248:251]
    s_add_u32 m0, s48, 49152
    s_mov_b32 s61, 180224
    s_waitcnt vmcnt(4)
    buffer_load_dwordx4 v26, s[8:11], s61 offen nt lds
    v_mfma_f32_16x16x32_bf16 v[244:247], a[140:143], v[104:107], v[244:247]
    ds_read_b128 a[116:119], v10 offset:18688
    v_add_f32 v38, v38, v102
    v_mfma_f32_16x16x32_bf16 v[252:255], a[140:143], v[108:111], v[252:255]
    v_exp_f32 v96, v68
    s_waitcnt lgkmcnt(6)
    v_mfma_f32_16x16x32_bf16 v[80:83], a[224:227], a[160:163], v[112:115]
    ds_read_b128 a[120:123], v11 offset:16640
    v_mfma_f32_16x16x32_bf16 v[88:91], a[224:227], a[164:167], v[116:119]
    v_add_f32 v38, v38, v103
    v_cvt_pk_bf16_f32 v125, v102, v103
    v_mfma_f32_16x16x32_bf16 v[84:87], a[228:231], a[160:163], v[112:115]
    v_exp_f32 v97, v69
    v_mfma_f32_16x16x32_bf16 v[92:95], a[228:231], a[164:167], v[116:119]
    ds_read_b128 a[124:127], v11 offset:18688
    v_add_f32 v37, v37, v96
    v_mfma_f32_16x16x32_bf16 v[80:83], a[232:235], a[168:171], v[80:83]
    ds_read_b128 a[128:131], v12 offset:16640
    v_exp_f32 v98, v70
    v_mfma_f32_16x16x32_bf16 v[88:91], a[232:235], a[172:175], v[88:91]
    v_add_f32 v37, v37, v97
    v_cvt_pk_bf16_f32 v122, v96, v97
    v_mfma_f32_16x16x32_bf16 v[84:87], a[236:239], a[168:171], v[84:87]
    s_add_u32 m0, s48, 49152
    s_waitcnt vmcnt(4)
    buffer_load_dwordx4 v27, s[8:11], s61 offen offset:1024 nt lds
    v_mfma_f32_16x16x32_bf16 v[92:95], a[236:239], a[172:175], v[92:95]
    ds_read_b128 a[132:135], v12 offset:18688
    s_waitcnt lgkmcnt(6)
    v_mfma_f32_16x16x32_bf16 v[80:83], a[240:243], a[176:179], v[80:83]
    v_exp_f32 v99, v71
    v_mfma_f32_16x16x32_bf16 v[88:91], a[240:243], a[180:183], v[88:91]
    ds_read_b128 a[136:139], v13 offset:16640
    v_add_f32 v37, v37, v98
    v_mfma_f32_16x16x32_bf16 v[84:87], a[244:247], a[176:179], v[84:87]
    v_exp_f32 v100, v76
    v_mfma_f32_16x16x32_bf16 v[92:95], a[244:247], a[180:183], v[92:95]
    ds_read_b128 a[140:143], v13 offset:18688
    v_add_f32 v37, v37, v99
    v_mfma_f32_16x16x32_bf16 v[80:83], a[248:251], a[184:187], v[80:83]
    s_barrier
    ds_read_b64_tr_b16 a[224:225], v14 offset:0
    v_mfma_f32_16x16x32_bf16 v[88:91], a[248:251], a[188:191], v[88:91]
    ds_read_b64_tr_b16 a[226:227], v14 offset:2048
    v_cvt_pk_bf16_f32 v123, v98, v99
    v_mfma_f32_16x16x32_bf16 v[84:87], a[252:255], a[184:187], v[84:87]
    s_add_u32 m0, s48, 49152
    s_waitcnt vmcnt(4)
    buffer_load_dwordx4 v26, s[8:11], s61 offen offset:2048 nt lds
    v_mfma_f32_16x16x32_bf16 v[92:95], a[252:255], a[188:191], v[92:95]
    ds_read_b64_tr_b16 a[228:229], v15 offset:0
    ds_read_b64_tr_b16 a[230:231], v15 offset:2048
    s_waitcnt lgkmcnt(8)
    v_mfma_f32_16x16x32_bf16 v[80:83], a[112:115], a[192:195], v[80:83]
    ds_read_b64_tr_b16 a[232:233], v16 offset:0
    ds_read_b64_tr_b16 a[234:235], v16 offset:2048
    v_mfma_f32_16x16x32_bf16 v[88:91], a[112:115], a[196:199], v[88:91]
    v_exp_f32 v101, v77
    v_mfma_f32_16x16x32_bf16 v[84:87], a[116:119], a[192:195], v[84:87]
    ds_read_b64_tr_b16 a[236:237], v17 offset:0
    ds_read_b64_tr_b16 a[238:239], v17 offset:2048
    v_mfma_f32_16x16x32_bf16 v[92:95], a[116:119], a[196:199], v[92:95]
    v_add_f32 v38, v38, v100
    v_exp_f32 v102, v78
    v_mfma_f32_16x16x32_bf16 v[80:83], a[120:123], a[200:203], v[80:83]
    ds_read_b64_tr_b16 a[240:241], v18 offset:0
    ds_read_b64_tr_b16 a[242:243], v18 offset:2048
    v_mfma_f32_16x16x32_bf16 v[88:91], a[120:123], a[204:207], v[88:91]
    v_add_f32 v38, v38, v101
    v_mfma_f32_16x16x32_bf16 v[84:87], a[124:127], a[200:203], v[84:87]
    ds_read_b64_tr_b16 a[244:245], v19 offset:0
    ds_read_b64_tr_b16 a[246:247], v19 offset:2048
    v_mfma_f32_16x16x32_bf16 v[92:95], a[124:127], a[204:207], v[92:95]
    v_cvt_pk_bf16_f32 v126, v100, v101
    s_waitcnt lgkmcnt(12)
    v_mfma_f32_16x16x32_bf16 v[80:83], a[128:131], a[208:211], v[80:83]
    ds_read_b64_tr_b16 a[248:249], v20 offset:0
    ds_read_b64_tr_b16 a[250:251], v20 offset:2048
    v_mfma_f32_16x16x32_bf16 v[88:91], a[128:131], a[212:215], v[88:91]
    s_add_u32 m0, s48, 49152
    s_waitcnt vmcnt(4)
    buffer_load_dwordx4 v27, s[8:11], s61 offen offset:3072 nt lds
    v_mfma_f32_16x16x32_bf16 v[84:87], a[132:135], a[208:211], v[84:87]
    ds_read_b64_tr_b16 a[252:253], v21 offset:0
    ds_read_b64_tr_b16 a[254:255], v21 offset:2048
    v_mfma_f32_16x16x32_bf16 v[92:95], a[132:135], a[212:215], v[92:95]
    v_exp_f32 v103, v79
    v_add_f32 v38, v38, v102
    v_mfma_f32_16x16x32_bf16 v[80:83], a[136:139], a[216:219], v[80:83]
    ds_read_b64_tr_b16 a[112:113], v14 offset:256
    ds_read_b64_tr_b16 a[114:115], v14 offset:2304
    v_mfma_f32_16x16x32_bf16 v[88:91], a[136:139], a[220:223], v[88:91]
    v_add_f32 v38, v38, v103
    v_cvt_pk_bf16_f32 v127, v102, v103
    v_mfma_f32_16x16x32_bf16 v[84:87], a[140:143], a[216:219], v[84:87]
    v_max_f32 v39, v37, v38
    v_cmp_lt_f32 vcc, s55, v39
    s_cbranch_vccz L_nm9
    s_call_b64 s[58:59], L_fixp0
L_nm9:
    v_mfma_f32_16x16x32_bf16 v[92:95], a[140:143], a[220:223], v[92:95]
    ds_read_b64_tr_b16 a[116:117], v15 offset:256
    ds_read_b64_tr_b16 a[118:119], v15 offset:2304
    s_waitcnt lgkmcnt(12)
    v_mfma_f32_16x16x32_bf16 v[128:131], a[224:227], v[120:123], v[128:131]
    ds_read_b64_tr_b16 a[120:121], v16 offset:256
    ds_read_b64_tr_b16 a[122:123], v16 offset:2304
    v_mfma_f32_16x16x32_bf16 v[136:139], a[224:227], v[124:127], v[136:139]
    s_add_u32 m0, s48, 98304
    s_mov_b32 s61, 163840
    s_waitcnt vmcnt(4)
    buffer_load_dwordx4 v28, s[12:15], s61 offen nt lds
    v_mfma_f32_16x16x32_bf16 v[132:135], a[228:231], v[120:123], v[132:135]
    ds_read_b64_tr_b16 a[124:125], v17 offset:256
    ds_read_b64_tr_b16 a[126:127], v17 offset:2304
    v_mfma_f32_16x16x32_bf16 v[140:143], a[228:231], v[124:127], v[140:143]
    v_exp_f32 v96, v80
    v_mfma_f32_16x16x32_bf16 v[144:147], a[232:235], v[120:123], v[144:147]
    ds_read_b64_tr_b16 a[128:129], v18 offset:256
    ds_read_b64_tr_b16 a[130:131], v18 offset:2304
    v_mfma_f32_16x16x32_bf16 v[152:155], a[232:235], v[124:127], v[152:155]
    v_exp_f32 v97, v81
    v_mfma_f32_16x16x32_bf16 v[148:151], a[236:239], v[120:123], v[148:151]
    ds_read_b64_tr_b16 a[132:133], v19 offset:256
    ds_read_b64_tr_b16 a[134:135], v19 offset:2304
    v_mfma_f32_16x16x32_bf16 v[156:159], a[236:239], v[124:127], v[156:159]
    v_add_f32 v35, v37, v96
    s_waitcnt lgkmcnt(12)
    v_mfma_f32_16x16x32_bf16 v[160:163], a[240:243], v[120:123], v[160:163]
    ds_read_b64_tr_b16 a[136:137], v20 offset:256
    ds_read_b64_tr_b16 a[138:139], v20 offset:2304
    v_mfma_f32_16x16x32_bf16 v[168:171], a[240:243], v[124:127], v[168:171]
    v_exp_f32 v98, v82
    v_add_f32 v35, v35, v97
    v_mfma_f32_16x16x32_bf16 v[164:167], a[244:247], v[120:123], v[164:167]
    ds_read_b64_tr_b16 a[140:141], v21 offset:256
    ds_read_b64_tr_b16 a[142:143], v21 offset:2304
    v_mfma_f32_16x16x32_bf16 v[172:175], a[244:247], v[124:127], v[172:175]
    s_add_u32 m0, s48, 98304
    s_waitcnt vmcnt(4)
    buffer_load_dwordx4 v29, s[12:15], s61 offen offset:1024 nt lds
    v_mfma_f32_16x16x32_bf16 v[176:179], a[248:251], v[120:123], v[176:179]
    s_barrier
    v_mfma_f32_16x16x32_bf16 v[184:187], a[248:251], v[124:127], v[184:187]
    ds_read_b128 a[224:227], v10 offset:32768
    v_cvt_pk_bf16_f32 v104, v96, v97
    v_mfma_f32_16x16x32_bf16 v[180:183], a[252:255], v[120:123], v[180:183]
    v_exp_f32 v99, v83
    v_mfma_f32_16x16x32_bf16 v[188:191], a[252:255], v[124:127], v[188:191]
    ds_read_b128 a[228:231], v10 offset:34816
    s_waitcnt lgkmcnt(10)
    v_mfma_f32_16x16x32_bf16 v[192:195], a[112:115], v[120:123], v[192:195]
    ds_read_b128 a[232:235], v11 offset:32768
    v_add_f32 v35, v35, v98
    v_mfma_f32_16x16x32_bf16 v[200:203], a[112:115], v[124:127], v[200:203]
    v_exp_f32 v100, v88
    v_mfma_f32_16x16x32_bf16 v[196:199], a[116:119], v[120:123], v[196:199]
    ds_read_b128 a[236:239], v11 offset:34816
    v_mfma_f32_16x16x32_bf16 v[204:207], a[116:119], v[124:127], v[204:207]
    s_add_u32 m0, s48, 98304
    s_waitcnt vmcnt(4)
    buffer_load_dwordx4 v28, s[12:15], s61 offen offset:2048 nt lds
    v_mfma_f32_16x16x32_bf16 v[208:211], a[120:123], v[120:123], v[208:211]
    ds_read_b128 a[240:243], v12 offset:32768
    v_add_f32 v35, v35, v99
    v_mfma_f32_16x16x32_bf16 v[216:219], a[120:123], v[124:127], v[216:219]
    v_cvt_pk_bf16_f32 v105, v98, v99
    v_exp_f32 v101, v89
    v_mfma_f32_16x16x32_bf16 v[212:215], a[124:127], v[120:123], v[212:215]
    ds_read_b128 a[244:247], v12 offset:34816
    v_mfma_f32_16x16x32_bf16 v[220:223], a[124:127], v[124:127], v[220:223]
    v_add_f32 v36, v38, v100
    s_waitcnt lgkmcnt(6)
    v_mfma_f32_16x16x32_bf16 v[224:227], a[128:131], v[120:123], v[224:227]
    ds_read_b128 a[248:251], v13 offset:32768
    v_exp_f32 v102, v90
    v_mfma_f32_16x16x32_bf16 v[232:235], a[128:131], v[124:127], v[232:235]
    v_add_f32 v36, v36, v101
    v_cvt_pk_bf16_f32 v108, v100, v101
    v_mfma_f32_16x16x32_bf16 v[228:231], a[132:135], v[120:123], v[228:231]
    ds_read_b128 a[252:255], v13 offset:34816
    v_mfma_f32_16x16x32_bf16 v[236:239], a[132:135], v[124:127], v[236:239]
    s_add_u32 m0, s48, 98304
    s_waitcnt vmcnt(4)
    buffer_load_dwordx4 v29, s[12:15], s61 offen offset:3072 nt lds
    v_mfma_f32_16x16x32_bf16 v[240:243], a[136:139], v[120:123], v[240:243]
    v_exp_f32 v103, v91
    v_mfma_f32_16x16x32_bf16 v[248:251], a[136:139], v[124:127], v[248:251]
    ds_read_b128 a[112:115], v10 offset:33024
    v_add_f32 v36, v36, v102
    v_mfma_f32_16x16x32_bf16 v[244:247], a[140:143], v[120:123], v[244:247]
    v_exp_f32 v96, v84
    v_mfma_f32_16x16x32_bf16 v[252:255], a[140:143], v[124:127], v[252:255]
    ds_read_b128 a[116:119], v10 offset:35072
    s_waitcnt lgkmcnt(6)
    v_mfma_f32_16x16x32_bf16 v[64:67], a[224:227], a[160:163], v[112:115]
    ds_read_b128 a[120:123], v11 offset:33024
    v_add_f32 v36, v36, v103
    v_mfma_f32_16x16x32_bf16 v[72:75], a[224:227], a[164:167], v[116:119]
    v_cvt_pk_bf16_f32 v109, v102, v103
    v_exp_f32 v97, v85
    v_mfma_f32_16x16x32_bf16 v[68:71], a[228:231], a[160:163], v[112:115]
    ds_read_b128 a[124:127], v11 offset:35072
    v_mfma_f32_16x16x32_bf16 v[76:79], a[228:231], a[164:167], v[116:119]
    s_add_u32 m0, s48, 0
    s_mov_b32 s61, 196608
    s_waitcnt vmcnt(4)
    buffer_load_dwordx4 v26, s[8:11], s61 offen nt lds
    v_mfma_f32_16x16x32_bf16 v[64:67], a[232:235], a[168:171], v[64:67]
    ds_read_b128 a[128:131], v12 offset:33024
    v_add_f32 v35, v35, v96
    v_mfma_f32_16x16x32_bf16 v[72:75], a[232:235], a[172:175], v[72:75]
    v_exp_f32 v98, v86
    v_mfma_f32_16x16x32_bf16 v[68:71], a[236:239], a[168:171], v[68:71]
    ds_read_b128 a[132:135], v12 offset:35072
    v_add_f32 v35, v35, v97
    v_mfma_f32_16x16x32_bf16 v[76:79], a[236:239], a[172:175], v[76:79]
    v_cvt_pk_bf16_f32 v106, v96, v97
    s_waitcnt lgkmcnt(6)
    v_mfma_f32_16x16x32_bf16 v[64:67], a[240:243], a[176:179], v[64:67]
    v_exp_f32 v99, v87
    v_mfma_f32_16x16x32_bf16 v[72:75], a[240:243], a[180:183], v[72:75]
    ds_read_b128 a[136:139], v13 offset:33024
    v_add_f32 v35, v35, v98
    v_mfma_f32_16x16x32_bf16 v[68:71], a[244:247], a[176:179], v[68:71]
    v_exp_f32 v100, v92
    v_mfma_f32_16x16x32_bf16 v[76:79], a[244:247], a[180:183], v[76:79]
    ds_read_b128 a[140:143], v13 offset:35072
    v_add_f32 v35, v35, v99
    v_mfma_f32_16x16x32_bf16 v[64:67], a[248:251], a[184:187], v[64:67]
    s_barrier
    ds_read_b64_tr_b16 a[224:225], v14 offset:16384
    ds_read_b64_tr_b16 a[226:227], v14 offset:18432
    v_mfma_f32_16x16x32_bf16 v[72:75], a[248:251], a[188:191], v[72:75]
    s_add_u32 m0, s48, 0
    s_waitcnt vmcnt(4)
    buffer_load_dwordx4 v27, s[8:11], s61 offen offset:1024 nt lds
    v_mfma_f32_16x16x32_bf16 v[68:71], a[252:255], a[184:187], v[68:71]
    ds_read_b64_tr_b16 a[228:229], v15 offset:16384
    ds_read_b64_tr_b16 a[230:231], v15 offset:18432
    v_mfma_f32_16x16x32_bf16 v[76:79], a[252:255], a[188:191], v[76:79]
    v_cvt_pk_bf16_f32 v107, v98, v99
    s_waitcnt lgkmcnt(8)
    v_mfma_f32_16x16x32_bf16 v[64:67], a[112:115], a[192:195], v[64:67]
    ds_read_b64_tr_b16 a[232:233], v16 offset:16384
    ds_read_b64_tr_b16 a[234:235], v16 offset:18432
    v_mfma_f32_16x16x32_bf16 v[72:75], a[112:115], a[196:199], v[72:75]
    v_exp_f32 v101, v93
    v_mfma_f32_16x16x32_bf16 v[68:71], a[116:119], a[192:195], v[68:71]
    ds_read_b64_tr_b16 a[236:237], v17 offset:16384
    ds_read_b64_tr_b16 a[238:239], v17 offset:18432
    v_mfma_f32_16x16x32_bf16 v[76:79], a[116:119], a[196:199], v[76:79]
    v_add_f32 v36, v36, v100
    v_exp_f32 v102, v94
    v_mfma_f32_16x16x32_bf16 v[64:67], a[120:123], a[200:203], v[64:67]
    ds_read_b64_tr_b16 a[240:241], v18 offset:16384
    ds_read_b64_tr_b16 a[242:243], v18 offset:18432
    v_mfma_f32_16x16x32_bf16 v[72:75], a[120:123], a[204:207], v[72:75]
    s_add_u32 m0, s48, 0
    s_waitcnt vmcnt(4)
    buffer_load_dwordx4 v26, s[8:11], s61 offen offset:2048 nt lds
    v_mfma_f32_16x16x32_bf16 v[68:71], a[124:127], a[200:203], v[68:71]
    ds_read_b64_tr_b16 a[244:245], v19 offset:16384
    ds_read_b64_tr_b16 a[246:247], v19 offset:18432
    v_mfma_f32_16x16x32_bf16 v[76:79], a[124:127], a[204:207], v[76:79]
    v_add_f32 v36, v36, v101
    s_waitcnt lgkmcnt(12)
    v_mfma_f32_16x16x32_bf16 v[64:67], a[128:131], a[208:211], v[64:67]
    ds_read_b64_tr_b16 a[248:249], v20 offset:16384
    ds_read_b64_tr_b16 a[250:251], v20 offset:18432
    v_mfma_f32_16x16x32_bf16 v[72:75], a[128:131], a[212:215], v[72:75]
    v_cvt_pk_bf16_f32 v110, v100, v101
    v_mfma_f32_16x16x32_bf16 v[68:71], a[132:135], a[208:211], v[68:71]
    ds_read_b64_tr_b16 a[252:253], v21 offset:16384
    ds_read_b64_tr_b16 a[254:255], v21 offset:18432
    v_mfma_f32_16x16x32_bf16 v[76:79], a[132:135], a[212:215], v[76:79]
    v_exp_f32 v103, v95
    v_add_f32 v36, v36, v102
    v_mfma_f32_16x16x32_bf16 v[64:67], a[136:139], a[216:219], v[64:67]
    ds_read_b64_tr_b16 a[112:113], v14 offset:16640
    ds_read_b64_tr_b16 a[114:115], v14 offset:18688
    v_mfma_f32_16x16x32_bf16 v[72:75], a[136:139], a[220:223], v[72:75]
    v_add_f32 v36, v36, v103
    v_cvt_pk_bf16_f32 v111, v102, v103
    v_mfma_f32_16x16x32_bf16 v[68:71], a[140:143], a[216:219], v[68:71]
    ds_read_b64_tr_b16 a[116:117], v15 offset:16640
    ds_read_b64_tr_b16 a[118:119], v15 offset:18688
    s_add_u32 m0, s48, 0
    s_waitcnt vmcnt(4)
    buffer_load_dwordx4 v27, s[8:11], s61 offen offset:3072 nt lds
    v_mfma_f32_16x16x32_bf16 v[76:79], a[140:143], a[220:223], v[76:79]
    v_max_f32 v39, v35, v36
    v_cmp_lt_f32 vcc, s55, v39
    s_cbranch_vccz L_nm10
    s_call_b64 s[58:59], L_fixp1
L_nm10:
    s_waitcnt lgkmcnt(12)
    v_mfma_f32_16x16x32_bf16 v[128:131], a[224:227], v[104:107], v[128:131]
    ds_read_b64_tr_b16 a[120:121], v16 offset:16640
    v_mfma_f32_16x16x32_bf16 v[136:139], a[224:227], v[108:111], v[136:139]
    ds_read_b64_tr_b16 a[122:123], v16 offset:18688
    v_mfma_f32_16x16x32_bf16 v[132:135], a[228:231], v[104:107], v[132:135]
    ds_read_b64_tr_b16 a[124:125], v17 offset:16640
    ds_read_b64_tr_b16 a[126:127], v17 offset:18688
    v_mfma_f32_16x16x32_bf16 v[140:143], a[228:231], v[108:111], v[140:143]
    v_exp_f32 v96, v64
    v_mfma_f32_16x16x32_bf16 v[144:147], a[232:235], v[104:107], v[144:147]
    ds_read_b64_tr_b16 a[128:129], v18 offset:16640
    ds_read_b64_tr_b16 a[130:131], v18 offset:18688
    v_mfma_f32_16x16x32_bf16 v[152:155], a[232:235], v[108:111], v[152:155]
    v_exp_f32 v97, v65
    v_add_f32 v37, v35, v96
    v_mfma_f32_16x16x32_bf16 v[148:151], a[236:239], v[104:107], v[148:151]
    s_add_u32 m0, s48, 114688
    s_mov_b32 s61, 180224
    s_waitcnt vmcnt(4)
    buffer_load_dwordx4 v28, s[12:15], s61 offen nt lds
    v_mfma_f32_16x16x32_bf16 v[156:159], a[236:239], v[108:111], v[156:159]
    ds_read_b64_tr_b16 a[132:133], v19 offset:16640
    ds_read_b64_tr_b16 a[134:135], v19 offset:18688
    s_waitcnt lgkmcnt(12)
    v_mfma_f32_16x16x32_bf16 v[160:163], a[240:243], v[104:107], v[160:163]
    ds_read_b64_tr_b16 a[136:137], v20 offset:16640
    ds_read_b64_tr_b16 a[138:139], v20 offset:18688
    v_mfma_f32_16x16x32_bf16 v[168:171], a[240:243], v[108:111], v[168:171]
    v_exp_f32 v98, v66
    v_mfma_f32_16x16x32_bf16 v[164:167], a[244:247], v[104:107], v[164:167]
    ds_read_b64_tr_b16 a[140:141], v21 offset:16640
    ds_read_b64_tr_b16 a[142:143], v21 offset:18688
    v_mfma_f32_16x16x32_bf16 v[172:175], a[244:247], v[108:111], v[172:175]
    v_add_f32 v37, v37, v97
    v_cvt_pk_bf16_f32 v120, v96, v97
    v_mfma_f32_16x16x32_bf16 v[176:179], a[248:251], v[104:107], v[176:179]
    s_barrier
    ds_read_b128 a[224:227], v10 offset:49152
    v_mfma_f32_16x16x32_bf16 v[184:187], a[248:251], v[108:111], v[184:187]
    v_exp_f32 v99, v67
    v_mfma_f32_16x16x32_bf16 v[180:183], a[252:255], v[104:107], v[180:183]
    ds_read_b128 a[228:231], v10 offset:51200
    v_mfma_f32_16x16x32_bf16 v[188:191], a[252:255], v[108:111], v[188:191]
    v_add_f32 v37, v37, v98
    s_waitcnt lgkmcnt(10)
    v_mfma_f32_16x16x32_bf16 v[192:195], a[112:115], v[104:107], v[192:195]
    ds_read_b128 a[232:235], v11 offset:49152
    v_exp_f32 v100, v72
    v_mfma_f32_16x16x32_bf16 v[200:203], a[112:115], v[108:111], v[200:203]
    s_add_u32 m0, s48, 114688
    s_waitcnt vmcnt(4)
    buffer_load_dwordx4 v29, s[12:15], s61 offen offset:1024 nt lds
    v_mfma_f32_16x16x32_bf16 v[196:199], a[116:119], v[104:107], v[196:199]
    ds_read_b128 a[236:239], v11 offset:51200
    v_mfma_f32_16x16x32_bf16 v[204:207], a[116:119], v[108:111], v[204:207]
    v_add_f32 v37, v37, v99
    v_cvt_pk_bf16_f32 v121, v98, v99
    v_mfma_f32_16x16x32_bf16 v[208:211], a[120:123], v[104:107], v[208:211]
    v_exp_f32 v101, v73
    v_mfma_f32_16x16x32_bf16 v[216:219], a[120:123], v[108:111], v[216:219]
    ds_read_b128 a[240:243], v12 offset:49152
    v_add_f32 v38, v36, v100
    v_mfma_f32_16x16x32_bf16 v[212:215], a[124:127], v[104:107], v[212:215]
    ds_read_b128 a[244:247], v12 offset:51200
    v_exp_f32 v102, v74
    v_mfma_f32_16x16x32_bf16 v[220:223], a[124:127], v[108:111], v[220:223]
    v_add_f32 v38, v38, v101
    s_waitcnt lgkmcnt(6)
    v_mfma_f32_16x16x32_bf16 v[224:227], a[128:131], v[104:107], v[224:227]
    ds_read_b128 a[248:251], v13 offset:49152
    v_mfma_f32_16x16x32_bf16 v[232:235], a[128:131], v[108:111], v[232:235]
    s_add_u32 m0, s48, 114688
    s_waitcnt vmcnt(4)
    buffer_load_dwordx4 v28, s[12:15], s61 offen offset:2048 nt lds
    v_mfma_f32_16x16x32_bf16 v[228:231], a[132:135], v[104:107], v[228:231]
    ds_read_b128 a[252:255], v13 offset:51200
    v_cvt_pk_bf16_f32 v124, v100, v101
    v_mfma_f32_16x16x32_bf16 v[236:239], a[132:135], v[108:111], v[236:239]
    v_exp_f32 v103, v75
    v_add_f32 v38, v38, v102
    v_mfma_f32_16x16x32_bf16 v[240:243], a[136:139], v[104:107], v[240:243]
    v_exp_f32 v96, v68
    v_mfma_f32_16x16x32_bf16 v[248:251], a[136:139], v[108:111], v[248:251]
    ds_read_b128 a[112:115], v10 offset:49408
    v_add_f32 v38, v38, v103
    v_mfma_f32_16x16x32_bf16 v[244:247], a[140:143], v[104:107], v[244:247]
    ds_read_b128 a[116:119], v10 offset:51456
    v_cvt_pk_bf16_f32 v125, v102, v103
    v_mfma_f32_16x16x32_bf16 v[252:255], a[140:143], v[108:111], v[252:255]
    v_exp_f32 v97, v69
    s_waitcnt lgkmcnt(6)
    v_mfma_f32_16x16x32_bf16 v[80:83], a[224:227], a[160:163], v[112:115]
    ds_read_b128 a[120:123], v11 offset:49408
    v_add_f32 v37, v37, v96
    v_mfma_f32_16x16x32_bf16 v[88:91], a[224:227], a[164:167], v[116:119]
    v_exp_f32 v98, v70
    v_mfma_f32_16x16x32_bf16 v[84:87], a[228:231], a[160:163], v[112:115]
    ds_read_b128 a[124:127], v11 offset:51456
    v_mfma_f32_16x16x32_bf16 v[92:95], a[228:231], a[164:167], v[116:119]
    s_add_u32 m0, s48, 114688
    s_waitcnt vmcnt(4)
    buffer_load_dwordx4 v29, s[12:15], s61 offen offset:3072 nt lds
    v_mfma_f32_16x16x32_bf16 v[80:83], a[232:235], a[168:171], v[80:83]
    ds_read_b128 a[128:131], v12 offset:49408
    v_add_f32 v37, v37, v97
    v_mfma_f32_16x16x32_bf16 v[88:91], a[232:235], a[172:175], v[88:91]
    v_cvt_pk_bf16_f32 v122, v96, v97
    v_exp_f32 v99, v71
    v_mfma_f32_16x16x32_bf16 v[84:87], a[236:239], a[168:171], v[84:87]
    ds_read_b128 a[132:135], v12 offset:51456
    v_mfma_f32_16x16x32_bf16 v[92:95], a[236:239], a[172:175], v[92:95]
    v_add_f32 v37, v37, v98
    s_waitcnt lgkmcnt(6)
    v_mfma_f32_16x16x32_bf16 v[80:83], a[240:243], a[176:179], v[80:83]
    ds_read_b128 a[136:139], v13 offset:49408
    v_exp_f32 v100, v76
    v_mfma_f32_16x16x32_bf16 v[88:91], a[240:243], a[180:183], v[88:91]
    v_add_f32 v37, v37, v99
    v_cvt_pk_bf16_f32 v123, v98, v99
    v_mfma_f32_16x16x32_bf16 v[84:87], a[244:247], a[176:179], v[84:87]
    ds_read_b128 a[140:143], v13 offset:51456
    v_mfma_f32_16x16x32_bf16 v[92:95], a[244:247], a[180:183], v[92:95]
    s_add_u32 m0, s48, 16384
    s_mov_b32 s61, 212992
    s_waitcnt vmcnt(4)
    buffer_load_dwordx4 v26, s[8:11], s61 offen nt lds
    v_mfma_f32_16x16x32_bf16 v[80:83], a[248:251], a[184:187], v[80:83]
    s_barrier
    v_mfma_f32_16x16x32_bf16 v[88:91], a[248:251], a[188:191], v[88:91]
    ds_read_b64_tr_b16 a[224:225], v14 offset:32768
    ds_read_b64_tr_b16 a[226:227], v14 offset:34816
    v_mfma_f32_16x16x32_bf16 v[84:87], a[252:255], a[184:187], v[84:87]
    ds_read_b64_tr_b16 a[228:229], v15 offset:32768
    ds_read_b64_tr_b16 a[230:231], v15 offset:34816
    v_mfma_f32_16x16x32_bf16 v[92:95], a[252:255], a[188:191], v[92:95]
    v_exp_f32 v101, v77
    s_waitcnt lgkmcnt(8)
    v_mfma_f32_16x16x32_bf16 v[80:83], a[112:115], a[192:195], v[80:83]
    ds_read_b64_tr_b16 a[232:233], v16 offset:32768
    ds_read_b64_tr_b16 a[234:235], v16 offset:34816
    v_mfma_f32_16x16x32_bf16 v[88:91], a[112:115], a[196:199], v[88:91]
    v_add_f32 v38, v38, v100
    v_mfma_f32_16x16x32_bf16 v[84:87], a[116:119], a[192:195], v[84:87]
    ds_read_b64_tr_b16 a[236:237], v17 offset:32768
    ds_read_b64_tr_b16 a[238:239], v17 offset:34816
    v_mfma_f32_16x16x32_bf16 v[92:95], a[116:119], a[196:199], v[92:95]
    v_exp_f32 v102, v78
    v_add_f32 v38, v38, v101
    v_mfma_f32_16x16x32_bf16 v[80:83], a[120:123], a[200:203], v[80:83]
    ds_read_b64_tr_b16 a[240:241], v18 offset:32768
    ds_read_b64_tr_b16 a[242:243], v18 offset:34816
    v_mfma_f32_16x16x32_bf16 v[88:91], a[120:123], a[204:207], v[88:91]
    s_add_u32 m0, s48, 16384
    s_waitcnt vmcnt(4)
    buffer_load_dwordx4 v27, s[8:11], s61 offen offset:1024 nt lds
    v_mfma_f32_16x16x32_bf16 v[84:87], a[124:127], a[200:203], v[84:87]
    ds_read_b64_tr_b16 a[244:245], v19 offset:32768
    ds_read_b64_tr_b16 a[246:247], v19 offset:34816
    v_mfma_f32_16x16x32_bf16 v[92:95], a[124:127], a[204:207], v[92:95]
    v_cvt_pk_bf16_f32 v126, v100, v101
    s_waitcnt lgkmcnt(12)
    v_mfma_f32_16x16x32_bf16 v[80:83], a[128:131], a[208:211], v[80:83]
    ds_read_b64_tr_b16 a[248:249], v20 offset:32768
    ds_read_b64_tr_b16 a[250:251], v20 offset:34816
    v_mfma_f32_16x16x32_bf16 v[88:91], a[128:131], a[212:215], v[88:91]
    v_exp_f32 v103, v79
    v_add_f32 v38, v38, v102
    v_mfma_f32_16x16x32_bf16 v[84:87], a[132:135], a[208:211], v[84:87]
    ds_read_b64_tr_b16 a[252:253], v21 offset:32768
    ds_read_b64_tr_b16 a[254:255], v21 offset:34816
    v_mfma_f32_16x16x32_bf16 v[92:95], a[132:135], a[212:215], v[92:95]
    v_add_f32 v38, v38, v103
    v_cvt_pk_bf16_f32 v127, v102, v103
    v_mfma_f32_16x16x32_bf16 v[80:83], a[136:139], a[216:219], v[80:83]
    ds_read_b64_tr_b16 a[112:113], v14 offset:33024
    ds_read_b64_tr_b16 a[114:115], v14 offset:35072
    v_mfma_f32_16x16x32_bf16 v[88:91], a[136:139], a[220:223], v[88:91]
    s_add_u32 m0, s48, 16384
    s_waitcnt vmcnt(4)
    buffer_load_dwordx4 v26, s[8:11], s61 offen offset:2048 nt lds
    v_mfma_f32_16x16x32_bf16 v[84:87], a[140:143], a[216:219], v[84:87]
    v_max_f32 v39, v37, v38
    v_cmp_lt_f32 vcc, s55, v39
    s_cbranch_vccz L_nm11
    s_call_b64 s[58:59], L_fixp0
L_nm11:
    v_mfma_f32_16x16x32_bf16 v[92:95], a[140:143], a[220:223], v[92:95]
    ds_read_b64_tr_b16 a[116:117], v15 offset:33024
    ds_read_b64_tr_b16 a[118:119], v15 offset:35072
    s_waitcnt lgkmcnt(12)
    v_mfma_f32_16x16x32_bf16 v[128:131], a[224:227], v[120:123], v[128:131]
    ds_read_b64_tr_b16 a[120:121], v16 offset:33024
    v_mfma_f32_16x16x32_bf16 v[136:139], a[224:227], v[124:127], v[136:139]
    ds_read_b64_tr_b16 a[122:123], v16 offset:35072
    v_mfma_f32_16x16x32_bf16 v[132:135], a[228:231], v[120:123], v[132:135]
    ds_read_b64_tr_b16 a[124:125], v17 offset:33024
    ds_read_b64_tr_b16 a[126:127], v17 offset:35072
    v_mfma_f32_16x16x32_bf16 v[140:143], a[228:231], v[124:127], v[140:143]
    v_exp_f32 v96, v80
    v_mfma_f32_16x16x32_bf16 v[144:147], a[232:235], v[120:123], v[144:147]
    ds_read_b64_tr_b16 a[128:129], v18 offset:33024
    ds_read_b64_tr_b16 a[130:131], v18 offset:35072
    v_mfma_f32_16x16x32_bf16 v[152:155], a[232:235], v[124:127], v[152:155]
    v_exp_f32 v97, v81
    v_add_f32 v35, v37, v96
    v_mfma_f32_16x16x32_bf16 v[148:151], a[236:239], v[120:123], v[148:151]
    s_add_u32 m0, s48, 16384
    s_waitcnt vmcnt(4)
    buffer_load_dwordx4 v27, s[8:11], s61 offen offset:3072 nt lds
    v_mfma_f32_16x16x32_bf16 v[156:159], a[236:239], v[124:127], v[156:159]
    ds_read_b64_tr_b16 a[132:133], v19 offset:33024
    ds_read_b64_tr_b16 a[134:135], v19 offset:35072
    s_waitcnt lgkmcnt(12)
    v_mfma_f32_16x16x32_bf16 v[160:163], a[240:243], v[120:123], v[160:163]
    ds_read_b64_tr_b16 a[136:137], v20 offset:33024
    ds_read_b64_tr_b16 a[138:139], v20 offset:35072
    v_mfma_f32_16x16x32_bf16 v[168:171], a[240:243], v[124:127], v[168:171]
    v_exp_f32 v98, v82
    v_mfma_f32_16x16x32_bf16 v[164:167], a[244:247], v[120:123], v[164:167]
    ds_read_b64_tr_b16 a[140:141], v21 offset:33024
    ds_read_b64_tr_b16 a[142:143], v21 offset:35072
    v_mfma_f32_16x16x32_bf16 v[172:175], a[244:247], v[124:127], v[172:175]
    v_add_f32 v35, v35, v97
    v_cvt_pk_bf16_f32 v104, v96, v97
    v_mfma_f32_16x16x32_bf16 v[176:179], a[248:251], v[120:123], v[176:179]
    s_barrier
    ds_read_b128 a[224:227], v10 offset:0
    v_mfma_f32_16x16x32_bf16 v[184:187], a[248:251], v[124:127], v[184:187]
    v_exp_f32 v99, v83
    v_mfma_f32_16x16x32_bf16 v[180:183], a[252:255], v[120:123], v[180:183]
    s_add_u32 m0, s48, 65536
    s_mov_b32 s61, 196608
    s_waitcnt vmcnt(4)
    buffer_load_dwordx4 v28, s[12:15], s61 offen nt lds
    v_mfma_f32_16x16x32_bf16 v[188:191], a[252:255], v[124:127], v[188:191]
    ds_read_b128 a[228:231], v10 offset:2048
    s_waitcnt lgkmcnt(10)
    v_mfma_f32_16x16x32_bf16 v[192:195], a[112:115], v[120:123], v[192:195]
    ds_read_b128 a[232:235], v11 offset:0
    v_add_f32 v35, v35, v98
    v_mfma_f32_16x16x32_bf16 v[200:203], a[112:115], v[124:127], v[200:203]
    v_exp_f32 v100, v88
    v_mfma_f32_16x16x32_bf16 v[196:199], a[116:119], v[120:123], v[196:199]
    ds_read_b128 a[236:239], v11 offset:2048
    v_mfma_f32_16x16x32_bf16 v[204:207], a[116:119], v[124:127], v[204:207]
    v_add_f32 v35, v35, v99
    v_cvt_pk_bf16_f32 v105, v98, v99
    v_mfma_f32_16x16x32_bf16 v[208:211], a[120:123], v[120:123], v[208:211]
    ds_read_b128 a[240:243], v12 offset:0
    v_exp_f32 v101, v89
    v_mfma_f32_16x16x32_bf16 v[216:219], a[120:123], v[124:127], v[216:219]
    v_add_f32 v36, v38, v100
    v_exp_f32 v102, v90
    v_mfma_f32_16x16x32_bf16 v[212:215], a[124:127], v[120:123], v[212:215]
    ds_read_b128 a[244:247], v12 offset:2048
    v_mfma_f32_16x16x32_bf16 v[220:223], a[124:127], v[124:127], v[220:223]
    v_add_f32 v36, v36, v101
    s_waitcnt lgkmcnt(6)
    v_mfma_f32_16x16x32_bf16 v[224:227], a[128:131], v[120:123], v[224:227]
    ds_read_b128 a[248:251], v13 offset:0
    v_cvt_pk_bf16_f32 v108, v100, v101
    v_mfma_f32_16x16x32_bf16 v[232:235], a[128:131], v[124:127], v[232:235]
    s_add_u32 m0, s48, 65536
    s_waitcnt vmcnt(4)
    buffer_load_dwordx4 v29, s[12:15], s61 offen offset:1024 nt lds
    v_mfma_f32_16x16x32_bf16 v[228:231], a[132:135], v[120:123], v[228:231]
    v_exp_f32 v103, v91
L_pg7:
    s_cbranch_execz L_pgr5
    v_mfma_f32_16x16x32_bf16 v[236:239], a[132:135], v[124:127], v[236:239]
    ds_read_b128 a[252:255], v13 offset:2048
    v_add_f32 v36, v36, v102
    v_mfma_f32_16x16x32_bf16 v[240:243], a[136:139], v[120:123], v[240:243]
    v_exp_f32 v96, v84
    v_mfma_f32_16x16x32_bf16 v[248:251], a[136:139], v[124:127], v[248:251]
    ds_read_b128 a[112:115], v10 offset:256
    v_add_f32 v36, v36, v103
    v_mfma_f32_16x16x32_bf16 v[244:247], a[140:143], v[120:123], v[244:247]
    ds_read_b128 a[116:119], v10 offset:2304
    v_cvt_pk_bf16_f32 v109, v102, v103
    v_mfma_f32_16x16x32_bf16 v[252:255], a[140:143], v[124:127], v[252:255]
    v_exp_f32 v97, v85
    s_waitcnt lgkmcnt(6)
    v_mfma_f32_16x16x32_bf16 v[64:67], a[224:227], a[160:163], v[112:115]
    ds_read_b128 a[120:123], v11 offset:256
    v_mfma_f32_16x16x32_bf16 v[72:75], a[224:227], a[164:167], v[116:119]
    s_add_u32 m0, s48, 65536
    s_waitcnt vmcnt(4)
    buffer_load_dwordx4 v28, s[12:15], s61 offen offset:2048 nt lds
    v_mfma_f32_16x16x32_bf16 v[68:71], a[228:231], a[160:163], v[112:115]
    ds_read_b128 a[124:127], v11 offset:2304
    v_add_f32 v35, v35, v96
    v_mfma_f32_16x16x32_bf16 v[76:79], a[228:231], a[164:167], v[116:119]
    v_exp_f32 v98, v86
    v_mfma_f32_16x16x32_bf16 v[64:67], a[232:235], a[168:171], v[64:67]
    ds_read_b128 a[128:131], v12 offset:256
    v_add_f32 v35, v35, v97
    v_mfma_f32_16x16x32_bf16 v[72:75], a[232:235], a[172:175], v[72:75]
    v_cvt_pk_bf16_f32 v106, v96, v97
    v_exp_f32 v99, v87
    v_mfma_f32_16x16x32_bf16 v[68:71], a[236:239], a[168:171], v[68:71]
    ds_read_b128 a[132:135], v12 offset:2304
    v_mfma_f32_16x16x32_bf16 v[76:79], a[236:239], a[172:175], v[76:79]
    v_add_f32 v35, v35, v98
    s_waitcnt lgkmcnt(6)
    v_mfma_f32_16x16x32_bf16 v[64:67], a[240:243], a[176:179], v[64:67]
    ds_read_b128 a[136:139], v13 offset:256
    v_exp_f32 v100, v92
    v_mfma_f32_16x16x32_bf16 v[72:75], a[240:243], a[180:183], v[72:75]
    v_add_f32 v35, v35, v99
    v_cvt_pk_bf16_f32 v107, v98, v99
    v_mfma_f32_16x16x32_bf16 v[68:71], a[244:247], a[176:179], v[68:71]
    ds_read_b128 a[140:143], v13 offset:2304
    v_mfma_f32_16x16x32_bf16 v[76:79], a[244:247], a[180:183], v[76:79]
    s_add_u32 m0, s48, 65536
    s_waitcnt vmcnt(4)
    buffer_load_dwordx4 v29, s[12:15], s61 offen offset:3072 nt lds
    v_mfma_f32_16x16x32_bf16 v[64:67], a[248:251], a[184:187], v[64:67]
    s_barrier
    v_mfma_f32_16x16x32_bf16 v[72:75], a[248:251], a[188:191], v[72:75]
    ds_read_b64_tr_b16 a[224:225], v14 offset:49152
    ds_read_b64_tr_b16 a[226:227], v14 offset:51200
    v_mfma_f32_16x16x32_bf16 v[68:71], a[252:255], a[184:187], v[68:71]
    ds_read_b64_tr_b16 a[228:229], v15 offset:49152
    ds_read_b64_tr_b16 a[230:231], v15 offset:51200
    v_mfma_f32_16x16x32_bf16 v[76:79], a[252:255], a[188:191], v[76:79]
    v_exp_f32 v101, v93
    s_waitcnt lgkmcnt(8)
    v_mfma_f32_16x16x32_bf16 v[64:67], a[112:115], a[192:195], v[64:67]
    ds_read_b64_tr_b16 a[232:233], v16 offset:49152
    ds_read_b64_tr_b16 a[234:235], v16 offset:51200
    v_mfma_f32_16x16x32_bf16 v[72:75], a[112:115], a[196:199], v[72:75]
    v_add_f32 v36, v36, v100
    v_mfma_f32_16x16x32_bf16 v[68:71], a[116:119], a[192:195], v[68:71]
    ds_read_b64_tr_b16 a[236:237], v17 offset:49152
    ds_read_b64_tr_b16 a[238:239], v17 offset:51200
    v_mfma_f32_16x16x32_bf16 v[76:79], a[116:119], a[196:199], v[76:79]
    s_add_u32 m0, s48, 32768
    s_mov_b32 s61, 229376
    s_waitcnt vmcnt(4)
    buffer_load_dwordx4 v26, s[8:11], s61 offen nt lds
    v_mfma_f32_16x16x32_bf16 v[64:67], a[120:123], a[200:203], v[64:67]
    ds_read_b64_tr_b16 a[240:241], v18 offset:49152
    ds_read_b64_tr_b16 a[242:243], v18 offset:51200
    v_mfma_f32_16x16x32_bf16 v[72:75], a[120:123], a[204:207], v[72:75]
    v_exp_f32 v102, v94
    v_add_f32 v36, v36, v101
    v_mfma_f32_16x16x32_bf16 v[68:71], a[124:127], a[200:203], v[68:71]
    ds_read_b64_tr_b16 a[244:245], v19 offset:49152
    ds_read_b64_tr_b16 a[246:247], v19 offset:51200
    v_mfma_f32_16x16x32_bf16 v[76:79], a[124:127], a[204:207], v[76:79]
    v_cvt_pk_bf16_f32 v110, v100, v101
    s_waitcnt lgkmcnt(12)
    v_mfma_f32_16x16x32_bf16 v[64:67], a[128:131], a[208:211], v[64:67]
    ds_read_b64_tr_b16 a[248:249], v20 offset:49152
    ds_read_b64_tr_b16 a[250:251], v20 offset:51200
    v_mfma_f32_16x16x32_bf16 v[72:75], a[128:131], a[212:215], v[72:75]
    v_exp_f32 v103, v95
    v_add_f32 v36, v36, v102
    v_mfma_f32_16x16x32_bf16 v[68:71], a[132:135], a[208:211], v[68:71]
    ds_read_b64_tr_b16 a[252:253], v21 offset:49152
    ds_read_b64_tr_b16 a[254:255], v21 offset:51200
    v_mfma_f32_16x16x32_bf16 v[76:79], a[132:135], a[212:215], v[76:79]
    v_add_f32 v36, v36, v103
    v_cvt_pk_bf16_f32 v111, v102, v103
    v_mfma_f32_16x16x32_bf16 v[64:67], a[136:139], a[216:219], v[64:67]
    ds_read_b64_tr_b16 a[112:113], v14 offset:49408
    ds_read_b64_tr_b16 a[114:115], v14 offset:51456
    v_mfma_f32_16x16x32_bf16 v[72:75], a[136:139], a[220:223], v[72:75]
    s_add_u32 m0, s48, 32768
    s_waitcnt vmcnt(4)
    buffer_load_dwordx4 v27, s[8:11], s61 offen offset:1024 nt lds
    v_mfma_f32_16x16x32_bf16 v[68:71], a[140:143], a[216:219], v[68:71]
    v_max_f32 v39, v35, v36
    v_cmp_lt_f32 vcc, s55, v39
    s_cbranch_vccz L_nm12
    s_call_b64 s[58:59], L_fixp1
L_nm12:
    v_mfma_f32_16x16x32_bf16 v[76:79], a[140:143], a[220:223], v[76:79]
    ds_read_b64_tr_b16 a[116:117], v15 offset:49408
    ds_read_b64_tr_b16 a[118:119], v15 offset:51456
    s_waitcnt lgkmcnt(12)
    v_mfma_f32_16x16x32_bf16 v[128:131], a[224:227], v[104:107], v[128:131]
    ds_read_b64_tr_b16 a[120:121], v16 offset:49408
    v_mfma_f32_16x16x32_bf16 v[136:139], a[224:227], v[108:111], v[136:139]
    ds_read_b64_tr_b16 a[122:123], v16 offset:51456
    v_mfma_f32_16x16x32_bf16 v[132:135], a[228:231], v[104:107], v[132:135]
    ds_read_b64_tr_b16 a[124:125], v17 offset:49408
    ds_read_b64_tr_b16 a[126:127], v17 offset:51456
    v_mfma_f32_16x16x32_bf16 v[140:143], a[228:231], v[108:111], v[140:143]
    v_exp_f32 v96, v64
    v_mfma_f32_16x16x32_bf16 v[144:147], a[232:235], v[104:107], v[144:147]
    ds_read_b64_tr_b16 a[128:129], v18 offset:49408
    ds_read_b64_tr_b16 a[130:131], v18 offset:51456
    v_mfma_f32_16x16x32_bf16 v[152:155], a[232:235], v[108:111], v[152:155]
    s_add_u32 m0, s48, 32768
    s_waitcnt vmcnt(4)
    buffer_load_dwordx4 v26, s[8:11], s61 offen offset:2048 nt lds
    v_mfma_f32_16x16x32_bf16 v[148:151], a[236:239], v[104:107], v[148:151]
    ds_read_b64_tr_b16 a[132:133], v19 offset:49408
    ds_read_b64_tr_b16 a[134:135], v19 offset:51456
    v_mfma_f32_16x16x32_bf16 v[156:159], a[236:239], v[108:111], v[156:159]
    v_exp_f32 v97, v65
    s_waitcnt lgkmcnt(12)
    v_mfma_f32_16x16x32_bf16 v[160:163], a[240:243], v[104:107], v[160:163]
    ds_read_b64_tr_b16 a[136:137], v20 offset:49408
    ds_read_b64_tr_b16 a[138:139], v20 offset:51456
    v_mfma_f32_16x16x32_bf16 v[168:171], a[240:243], v[108:111], v[168:171]
    v_add_f32 v37, v35, v96
    v_mfma_f32_16x16x32_bf16 v[164:167], a[244:247], v[104:107], v[164:167]
    ds_read_b64_tr_b16 a[140:141], v21 offset:49408
    ds_read_b64_tr_b16 a[142:143], v21 offset:51456
    v_mfma_f32_16x16x32_bf16 v[172:175], a[244:247], v[108:111], v[172:175]
    v_exp_f32 v98, v66
    v_add_f32 v37, v37, v97
    v_mfma_f32_16x16x32_bf16 v[176:179], a[248:251], v[104:107], v[176:179]
    s_barrier
    v_mfma_f32_16x16x32_bf16 v[184:187], a[248:251], v[108:111], v[184:187]
    ds_read_b128 a[224:227], v10 offset:16384
    v_cvt_pk_bf16_f32 v120, v96, v97
    v_mfma_f32_16x16x32_bf16 v[180:183], a[252:255], v[104:107], v[180:183]
    s_add_u32 m0, s48, 32768
    s_waitcnt vmcnt(4)
    buffer_load_dwordx4 v27, s[8:11], s61 offen offset:3072 nt lds
    v_mfma_f32_16x16x32_bf16 v[188:191], a[252:255], v[108:111], v[188:191]
    ds_read_b128 a[228:231], v10 offset:18432
    s_waitcnt lgkmcnt(10)
    v_mfma_f32_16x16x32_bf16 v[192:195], a[112:115], v[104:107], v[192:195]
    v_exp_f32 v99, v67
    v_mfma_f32_16x16x32_bf16 v[200:203], a[112:115], v[108:111], v[200:203]
    ds_read_b128 a[232:235], v11 offset:16384
    v_add_f32 v37, v37, v98
    v_mfma_f32_16x16x32_bf16 v[196:199], a[116:119], v[104:107], v[196:199]
    ds_read_b128 a[236:239], v11 offset:18432
    v_exp_f32 v100, v72
    v_mfma_f32_16x16x32_bf16 v[204:207], a[116:119], v[108:111], v[204:207]
    v_add_f32 v37, v37, v99
    v_cvt_pk_bf16_f32 v121, v98, v99
    v_mfma_f32_16x16x32_bf16 v[208:211], a[120:123], v[104:107], v[208:211]
    v_exp_f32 v101, v73
    v_mfma_f32_16x16x32_bf16 v[216:219], a[120:123], v[108:111], v[216:219]
    ds_read_b128 a[240:243], v12 offset:16384
    v_add_f32 v38, v36, v100
    v_mfma_f32_16x16x32_bf16 v[212:215], a[124:127], v[104:107], v[212:215]
    s_add_u32 m0, s48, 81920
    s_mov_b32 s61, 212992
    s_waitcnt vmcnt(4)
    buffer_load_dwordx4 v28, s[12:15], s61 offen nt lds
    v_mfma_f32_16x16x32_bf16 v[220:223], a[124:127], v[108:111], v[220:223]
    ds_read_b128 a[244:247], v12 offset:18432
    s_waitcnt lgkmcnt(6)
    v_mfma_f32_16x16x32_bf16 v[224:227], a[128:131], v[104:107], v[224:227]
    ds_read_b128 a[248:251], v13 offset:16384
    v_exp_f32 v102, v74
    v_mfma_f32_16x16x32_bf16 v[232:235], a[128:131], v[108:111], v[232:235]
    v_add_f32 v38, v38, v101
    v_cvt_pk_bf16_f32 v124, v100, v101
    v_mfma_f32_16x16x32_bf16 v[228:231], a[132:135], v[104:107], v[228:231]
    v_exp_f32 v103, v75
    v_mfma_f32_16x16x32_bf16 v[236:239], a[132:135], v[108:111], v[236:239]
    ds_read_b128 a[252:255], v13 offset:18432
    v_add_f32 v38, v38, v102
    v_mfma_f32_16x16x32_bf16 v[240:243], a[136:139], v[104:107], v[240:243]
    ds_read_b128 a[112:115], v10 offset:16640
    v_exp_f32 v96, v68
    v_mfma_f32_16x16x32_bf16 v[248:251], a[136:139], v[108:111], v[248:251]
    v_add_f32 v38, v38, v103
    v_cvt_pk_bf16_f32 v125, v102, v103
    v_mfma_f32_16x16x32_bf16 v[244:247], a[140:143], v[104:107], v[244:247]
    v_exp_f32 v97, v69
    v_mfma_f32_16x16x32_bf16 v[252:255], a[140:143], v[108:111], v[252:255]
    ds_read_b128 a[116:119], v10 offset:18688
    s_waitcnt lgkmcnt(6)
    v_mfma_f32_16x16x32_bf16 v[80:83], a[224:227], a[160:163], v[112:115]
    ds_read_b128 a[120:123], v11 offset:16640
    v_mfma_f32_16x16x32_bf16 v[88:91], a[224:227], a[164:167], v[116:119]
    s_add_u32 m0, s48, 81920
    s_waitcnt vmcnt(4)
    buffer_load_dwordx4 v29, s[12:15], s61 offen offset:1024 nt lds
    v_mfma_f32_16x16x32_bf16 v[84:87], a[228:231], a[160:163], v[112:115]
    ds_read_b128 a[124:127], v11 offset:18688
    v_add_f32 v37, v37, v96
    v_mfma_f32_16x16x32_bf16 v[92:95], a[228:231], a[164:167], v[116:119]
    v_exp_f32 v98, v70
    v_mfma_f32_16x16x32_bf16 v[80:83], a[232:235], a[168:171], v[80:83]
    ds_read_b128 a[128:131], v12 offset:16640
    v_add_f32 v37, v37, v97
    v_mfma_f32_16x16x32_bf16 v[88:91], a[232:235], a[172:175], v[88:91]
    v_cvt_pk_bf16_f32 v122, v96, v97
    v_exp_f32 v99, v71
    v_mfma_f32_16x16x32_bf16 v[84:87], a[236:239], a[168:171], v[84:87]
    ds_read_b128 a[132:135], v12 offset:18688
    v_add_f32 v37, v37, v98
    v_mfma_f32_16x16x32_bf16 v[92:95], a[236:239], a[172:175], v[92:95]
    v_exp_f32 v100, v76
    s_waitcnt lgkmcnt(6)
    v_mfma_f32_16x16x32_bf16 v[80:83], a[240:243], a[176:179], v[80:83]
    ds_read_b128 a[136:139], v13 offset:16640
    v_mfma_f32_16x16x32_bf16 v[88:91], a[240:243], a[180:183], v[88:91]
    s_add_u32 m0, s48, 81920
    s_waitcnt vmcnt(4)
    buffer_load_dwordx4 v28, s[12:15], s61 offen offset:2048 nt lds
    v_mfma_f32_16x16x32_bf16 v[84:87], a[244:247], a[176:179], v[84:87]
    ds_read_b128 a[140:143], v13 offset:18688
    v_add_f32 v37, v37, v99
    v_mfma_f32_16x16x32_bf16 v[92:95], a[244:247], a[180:183], v[92:95]
    v_cvt_pk_bf16_f32 v123, v98, v99
    buffer_load_dwordx4 a[148:151], v48, s[36:39], 0 offen sc1
    v_mfma_f32_16x16x32_bf16 v[80:83], a[248:251], a[184:187], v[80:83]
    s_barrier
    v_mfma_f32_16x16x32_bf16 v[88:91], a[248:251], a[188:191], v[88:91]
    ds_read_b64_tr_b16 a[224:225], v14 offset:0
    ds_read_b64_tr_b16 a[226:227], v14 offset:2048
    v_mfma_f32_16x16x32_bf16 v[84:87], a[252:255], a[184:187], v[84:87]
    ds_read_b64_tr_b16 a[228:229], v15 offset:0
    ds_read_b64_tr_b16 a[230:231], v15 offset:2048
    v_mfma_f32_16x16x32_bf16 v[92:95], a[252:255], a[188:191], v[92:95]
    v_exp_f32 v101, v77
    s_waitcnt lgkmcnt(8)
    v_mfma_f32_16x16x32_bf16 v[80:83], a[112:115], a[192:195], v[80:83]
    ds_read_b64_tr_b16 a[232:233], v16 offset:0
    ds_read_b64_tr_b16 a[234:235], v16 offset:2048
    v_mfma_f32_16x16x32_bf16 v[88:91], a[112:115], a[196:199], v[88:91]
    s_add_u32 m0, s48, 81920
    s_waitcnt vmcnt(4)
    buffer_load_dwordx4 v29, s[12:15], s61 offen offset:3072 nt lds
    v_mfma_f32_16x16x32_bf16 v[84:87], a[116:119], a[192:195], v[84:87]
    ds_read_b64_tr_b16 a[236:237], v17 offset:0
    ds_read_b64_tr_b16 a[238:239], v17 offset:2048
    v_mfma_f32_16x16x32_bf16 v[92:95], a[116:119], a[196:199], v[92:95]
    v_add_f32 v38, v38, v100
    v_mfma_f32_16x16x32_bf16 v[80:83], a[120:123], a[200:203], v[80:83]
    ds_read_b64_tr_b16 a[240:241], v18 offset:0
    ds_read_b64_tr_b16 a[242:243], v18 offset:2048
    v_mfma_f32_16x16x32_bf16 v[88:91], a[120:123], a[204:207], v[88:91]
    v_exp_f32 v102, v78
    v_add_f32 v38, v38, v101
    v_mfma_f32_16x16x32_bf16 v[84:87], a[124:127], a[200:203], v[84:87]
    ds_read_b64_tr_b16 a[244:245], v19 offset:0
    ds_read_b64_tr_b16 a[246:247], v19 offset:2048
    v_mfma_f32_16x16x32_bf16 v[92:95], a[124:127], a[204:207], v[92:95]
    v_cvt_pk_bf16_f32 v126, v100, v101
    s_waitcnt lgkmcnt(12)
    v_mfma_f32_16x16x32_bf16 v[80:83], a[128:131], a[208:211], v[80:83]
    ds_read_b64_tr_b16 a[248:249], v20 offset:0
    ds_read_b64_tr_b16 a[250:251], v20 offset:2048
    v_mfma_f32_16x16x32_bf16 v[88:91], a[128:131], a[212:215], v[88:91]
    s_add_u32 m0, s48, 49152
    s_mov_b32 s61, 245760
    s_waitcnt vmcnt(4)
    buffer_load_dwordx4 v26, s[8:11], s61 offen nt lds
    v_mfma_f32_16x16x32_bf16 v[84:87], a[132:135], a[208:211], v[84:87]
    ds_read_b64_tr_b16 a[252:253], v21 offset:0
    ds_read_b64_tr_b16 a[254:255], v21 offset:2048
    v_mfma_f32_16x16x32_bf16 v[92:95], a[132:135], a[212:215], v[92:95]
    v_exp_f32 v103, v79
    v_add_f32 v38, v38, v102
    v_mfma_f32_16x16x32_bf16 v[80:83], a[136:139], a[216:219], v[80:83]
    ds_read_b64_tr_b16 a[112:113], v14 offset:256
    ds_read_b64_tr_b16 a[114:115], v14 offset:2304
    v_mfma_f32_16x16x32_bf16 v[88:91], a[136:139], a[220:223], v[88:91]
    v_add_f32 v38, v38, v103
    v_cvt_pk_bf16_f32 v127, v102, v103
    v_mfma_f32_16x16x32_bf16 v[84:87], a[140:143], a[216:219], v[84:87]
    v_max_f32 v39, v37, v38
    v_cmp_lt_f32 vcc, s55, v39
    s_cbranch_vccz L_nm13
    s_call_b64 s[58:59], L_fixp0
L_nm13:
    v_mfma_f32_16x16x32_bf16 v[92:95], a[140:143], a[220:223], v[92:95]
    ds_read_b64_tr_b16 a[116:117], v15 offset:256
    ds_read_b64_tr_b16 a[118:119], v15 offset:2304
    s_waitcnt lgkmcnt(12)
    v_mfma_f32_16x16x32_bf16 v[128:131], a[224:227], v[120:123], v[128:131]
    ds_read_b64_tr_b16 a[120:121], v16 offset:256
    v_mfma_f32_16x16x32_bf16 v[136:139], a[224:227], v[124:127], v[136:139]
    ds_read_b64_tr_b16 a[122:123], v16 offset:2304
    v_mfma_f32_16x16x32_bf16 v[132:135], a[228:231], v[120:123], v[132:135]
    ds_read_b64_tr_b16 a[124:125], v17 offset:256
    ds_read_b64_tr_b16 a[126:127], v17 offset:2304
    v_mfma_f32_16x16x32_bf16 v[140:143], a[228:231], v[124:127], v[140:143]
    s_add_u32 m0, s48, 49152
    s_waitcnt vmcnt(4)
    buffer_load_dwordx4 v27, s[8:11], s61 offen offset:1024 nt lds
    v_mfma_f32_16x16x32_bf16 v[144:147], a[232:235], v[120:123], v[144:147]
    ds_read_b64_tr_b16 a[128:129], v18 offset:256
    ds_read_b64_tr_b16 a[130:131], v18 offset:2304
    v_mfma_f32_16x16x32_bf16 v[152:155], a[232:235], v[124:127], v[152:155]
    v_exp_f32 v96, v80
    v_mfma_f32_16x16x32_bf16 v[148:151], a[236:239], v[120:123], v[148:151]
    ds_read_b64_tr_b16 a[132:133], v19 offset:256
    ds_read_b64_tr_b16 a[134:135], v19 offset:2304
    v_mfma_f32_16x16x32_bf16 v[156:159], a[236:239], v[124:127], v[156:159]
    v_exp_f32 v97, v81
    s_waitcnt lgkmcnt(12)
    v_mfma_f32_16x16x32_bf16 v[160:163], a[240:243], v[120:123], v[160:163]
    ds_read_b64_tr_b16 a[136:137], v20 offset:256
    ds_read_b64_tr_b16 a[138:139], v20 offset:2304
    v_mfma_f32_16x16x32_bf16 v[168:171], a[240:243], v[124:127], v[168:171]
    v_add_f32 v35, v37, v96
    v_mfma_f32_16x16x32_bf16 v[164:167], a[244:247], v[120:123], v[164:167]
    ds_read_b64_tr_b16 a[140:141], v21 offset:256
    ds_read_b64_tr_b16 a[142:143], v21 offset:2304
    v_mfma_f32_16x16x32_bf16 v[172:175], a[244:247], v[124:127], v[172:175]
    s_add_u32 m0, s48, 49152
    s_waitcnt vmcnt(4)
    buffer_load_dwordx4 v26, s[8:11], s61 offen offset:2048 nt lds
    v_mfma_f32_16x16x32_bf16 v[176:179], a[248:251], v[120:123], v[176:179]
    s_barrier
    ds_read_b128 a[224:227], v10 offset:32768
    v_mfma_f32_16x16x32_bf16 v[184:187], a[248:251], v[124:127], v[184:187]
    v_exp_f32 v98, v82
    v_mfma_f32_16x16x32_bf16 v[180:183], a[252:255], v[120:123], v[180:183]
    ds_read_b128 a[228:231], v10 offset:34816
    v_add_f32 v35, v35, v97
    v_mfma_f32_16x16x32_bf16 v[188:191], a[252:255], v[124:127], v[188:191]
    v_cvt_pk_bf16_f32 v104, v96, v97
    s_waitcnt lgkmcnt(10)
    v_mfma_f32_16x16x32_bf16 v[192:195], a[112:115], v[120:123], v[192:195]
    v_exp_f32 v99, v83
    v_mfma_f32_16x16x32_bf16 v[200:203], a[112:115], v[124:127], v[200:203]
    ds_read_b128 a[232:235], v11 offset:32768
    v_add_f32 v35, v35, v98
    v_mfma_f32_16x16x32_bf16 v[196:199], a[116:119], v[120:123], v[196:199]
    ds_read_b128 a[236:239], v11 offset:34816
    v_exp_f32 v100, v88
    v_mfma_f32_16x16x32_bf16 v[204:207], a[116:119], v[124:127], v[204:207]
    v_add_f32 v35, v35, v99
    v_cvt_pk_bf16_f32 v105, v98, v99
    v_mfma_f32_16x16x32_bf16 v[208:211], a[120:123], v[120:123], v[208:211]
    ds_read_b128 a[240:243], v12 offset:32768
    v_mfma_f32_16x16x32_bf16 v[216:219], a[120:123], v[124:127], v[216:219]
    s_add_u32 m0, s48, 49152
    s_waitcnt vmcnt(4)
    buffer_load_dwordx4 v27, s[8:11], s61 offen offset:3072 nt lds
    v_mfma_f32_16x16x32_bf16 v[212:215], a[124:127], v[120:123], v[212:215]
    v_exp_f32 v101, v89
    v_mfma_f32_16x16x32_bf16 v[220:223], a[124:127], v[124:127], v[220:223]
    ds_read_b128 a[244:247], v12 offset:34816
    s_waitcnt lgkmcnt(6)
    v_mfma_f32_16x16x32_bf16 v[224:227], a[128:131], v[120:123], v[224:227]
    ds_read_b128 a[248:251], v13 offset:32768
    v_add_f32 v36, v38, v100
    v_mfma_f32_16x16x32_bf16 v[232:235], a[128:131], v[124:127], v[232:235]
    v_exp_f32 v102, v90
    v_add_f32 v36, v36, v101
    v_mfma_f32_16x16x32_bf16 v[228:231], a[132:135], v[120:123], v[228:231]
    ds_read_b128 a[252:255], v13 offset:34816
    v_cvt_pk_bf16_f32 v108, v100, v101
    v_mfma_f32_16x16x32_bf16 v[236:239], a[132:135], v[124:127], v[236:239]
    v_exp_f32 v103, v91
    v_mfma_f32_16x16x32_bf16 v[240:243], a[136:139], v[120:123], v[240:243]
    ds_read_b128 a[112:115], v10 offset:33024
    v_mfma_f32_16x16x32_bf16 v[248:251], a[136:139], v[124:127], v[248:251]
    s_add_u32 m0, s48, 98304
    s_mov_b32 s61, 229376
    s_waitcnt vmcnt(4)
    buffer_load_dwordx4 v28, s[12:15], s61 offen nt lds
    v_mfma_f32_16x16x32_bf16 v[244:247], a[140:143], v[120:123], v[244:247]
    ds_read_b128 a[116:119], v10 offset:35072
    v_add_f32 v36, v36, v102
    v_mfma_f32_16x16x32_bf16 v[252:255], a[140:143], v[124:127], v[252:255]
    v_exp_f32 v96, v84
    s_waitcnt lgkmcnt(6)
    v_mfma_f32_16x16x32_bf16 v[64:67], a[224:227], a[160:163], v[112:115]
    ds_read_b128 a[120:123], v11 offset:33024
    v_mfma_f32_16x16x32_bf16 v[72:75], a[224:227], a[164:167], v[116:119]
    v_add_f32 v36, v36, v103
    v_cvt_pk_bf16_f32 v109, v102, v103
    v_mfma_f32_16x16x32_bf16 v[68:71], a[228:231], a[160:163], v[112:115]
    v_exp_f32 v97, v85
    v_mfma_f32_16x16x32_bf16 v[76:79], a[228:231], a[164:167], v[116:119]
    ds_read_b128 a[124:127], v11 offset:35072
    v_add_f32 v35, v35, v96
    v_mfma_f32_16x16x32_bf16 v[64:67], a[232:235], a[168:171], v[64:67]
    ds_read_b128 a[128:131], v12 offset:33024
    v_exp_f32 v98, v86
    v_mfma_f32_16x16x32_bf16 v[72:75], a[232:235], a[172:175], v[72:75]
    v_add_f32 v35, v35, v97
    v_cvt_pk_bf16_f32 v106, v96, v97
    v_mfma_f32_16x16x32_bf16 v[68:71], a[236:239], a[168:171], v[68:71]
    s_add_u32 m0, s48, 98304
    s_waitcnt vmcnt(4)
    buffer_load_dwordx4 v29, s[12:15], s61 offen offset:1024 nt lds
    v_mfma_f32_16x16x32_bf16 v[76:79], a[236:239], a[172:175], v[76:79]
    ds_read_b128 a[132:135], v12 offset:35072
    s_waitcnt lgkmcnt(6)
    v_mfma_f32_16x16x32_bf16 v[64:67], a[240:243], a[176:179], v[64:67]
    v_exp_f32 v99, v87
    v_mfma_f32_16x16x32_bf16 v[72:75], a[240:243], a[180:183], v[72:75]
    ds_read_b128 a[136:139], v13 offset:33024
    v_add_f32 v35, v35, v98
    v_mfma_f32_16x16x32_bf16 v[68:71], a[244:247], a[176:179], v[68:71]
    v_exp_f32 v100, v92
    v_mfma_f32_16x16x32_bf16 v[76:79], a[244:247], a[180:183], v[76:79]
    ds_read_b128 a[140:143], v13 offset:35072
    v_add_f32 v35, v35, v99
    v_mfma_f32_16x16x32_bf16 v[64:67], a[248:251], a[184:187], v[64:67]
    s_barrier
    ds_read_b64_tr_b16 a[224:225], v14 offset:16384
    v_mfma_f32_16x16x32_bf16 v[72:75], a[248:251], a[188:191], v[72:75]
    ds_read_b64_tr_b16 a[226:227], v14 offset:18432
    v_cvt_pk_bf16_f32 v107, v98, v99
    v_mfma_f32_16x16x32_bf16 v[68:71], a[252:255], a[184:187], v[68:71]
    s_add_u32 m0, s48, 98304
    s_waitcnt vmcnt(4)
    buffer_load_dwordx4 v28, s[12:15], s61 offen offset:2048 nt lds
    v_mfma_f32_16x16x32_bf16 v[76:79], a[252:255], a[188:191], v[76:79]
    ds_read_b64_tr_b16 a[228:229], v15 offset:16384
    ds_read_b64_tr_b16 a[230:231], v15 offset:18432
    s_waitcnt lgkmcnt(8)
    v_mfma_f32_16x16x32_bf16 v[64:67], a[112:115], a[192:195], v[64:67]
    ds_read_b64_tr_b16 a[232:233], v16 offset:16384
    ds_read_b64_tr_b16 a[234:235], v16 offset:18432
    v_mfma_f32_16x16x32_bf16 v[72:75], a[112:115], a[196:199], v[72:75]
    v_exp_f32 v101, v93
    v_mfma_f32_16x16x32_bf16 v[68:71], a[116:119], a[192:195], v[68:71]
    ds_read_b64_tr_b16 a[236:237], v17 offset:16384
    ds_read_b64_tr_b16 a[238:239], v17 offset:18432
    v_mfma_f32_16x16x32_bf16 v[76:79], a[116:119], a[196:199], v[76:79]
    v_add_f32 v36, v36, v100
    v_exp_f32 v102, v94
    v_mfma_f32_16x16x32_bf16 v[64:67], a[120:123], a[200:203], v[64:67]
    ds_read_b64_tr_b16 a[240:241], v18 offset:16384
    ds_read_b64_tr_b16 a[242:243], v18 offset:18432
    v_mfma_f32_16x16x32_bf16 v[72:75], a[120:123], a[204:207], v[72:75]
    v_add_f32 v36, v36, v101
    v_mfma_f32_16x16x32_bf16 v[68:71], a[124:127], a[200:203], v[68:71]
    ds_read_b64_tr_b16 a[244:245], v19 offset:16384
    ds_read_b64_tr_b16 a[246:247], v19 offset:18432
    v_mfma_f32_16x16x32_bf16 v[76:79], a[124:127], a[204:207], v[76:79]
    v_cvt_pk_bf16_f32 v110, v100, v101
    s_waitcnt lgkmcnt(12)
    v_mfma_f32_16x16x32_bf16 v[64:67], a[128:131], a[208:211], v[64:67]
    ds_read_b64_tr_b16 a[248:249], v20 offset:16384
    ds_read_b64_tr_b16 a[250:251], v20 offset:18432
    v_mfma_f32_16x16x32_bf16 v[72:75], a[128:131], a[212:215], v[72:75]
    s_add_u32 m0, s48, 98304
    s_waitcnt vmcnt(4)
    buffer_load_dwordx4 v29, s[12:15], s61 offen offset:3072 nt lds
    v_mfma_f32_16x16x32_bf16 v[68:71], a[132:135], a[208:211], v[68:71]
    ds_read_b64_tr_b16 a[252:253], v21 offset:16384
    ds_read_b64_tr_b16 a[254:255], v21 offset:18432
    v_mfma_f32_16x16x32_bf16 v[76:79], a[132:135], a[212:215], v[76:79]
    v_exp_f32 v103, v95
    v_add_f32 v36, v36, v102
    v_mfma_f32_16x16x32_bf16 v[64:67], a[136:139], a[216:219], v[64:67]
    ds_read_b64_tr_b16 a[112:113], v14 offset:16640
    ds_read_b64_tr_b16 a[114:115], v14 offset:18688
    v_mfma_f32_16x16x32_bf16 v[72:75], a[136:139], a[220:223], v[72:75]
    v_add_f32 v36, v36, v103
    v_cvt_pk_bf16_f32 v111, v102, v103
    v_mfma_f32_16x16x32_bf16 v[68:71], a[140:143], a[216:219], v[68:71]
    v_max_f32 v39, v35, v36
    v_cmp_lt_f32 vcc, s55, v39
    s_cbranch_vccz L_nm14
    s_call_b64 s[58:59], L_fixp1
L_nm14:
    v_mfma_f32_16x16x32_bf16 v[76:79], a[140:143], a[220:223], v[76:79]
    ds_read_b64_tr_b16 a[116:117], v15 offset:16640
    ds_read_b64_tr_b16 a[118:119], v15 offset:18688
    s_waitcnt lgkmcnt(12)
    v_mfma_f32_16x16x32_bf16 v[128:131], a[224:227], v[104:107], v[128:131]
    ds_read_b64_tr_b16 a[120:121], v16 offset:16640
    ds_read_b64_tr_b16 a[122:123], v16 offset:18688
    v_mfma_f32_16x16x32_bf16 v[136:139], a[224:227], v[108:111], v[136:139]
    s_add_u32 m0, s48, 114688
    s_mov_b32 s61, 245760
    s_waitcnt vmcnt(4)
    buffer_load_dwordx4 v28, s[12:15], s61 offen nt lds
    v_mfma_f32_16x16x32_bf16 v[132:135], a[228:231], v[104:107], v[132:135]
    ds_read_b64_tr_b16 a[124:125], v17 offset:16640
    ds_read_b64_tr_b16 a[126:127], v17 offset:18688
    v_mfma_f32_16x16x32_bf16 v[140:143], a[228:231], v[108:111], v[140:143]
    v_exp_f32 v96, v64
    v_mfma_f32_16x16x32_bf16 v[144:147], a[232:235], v[104:107], v[144:147]
    ds_read_b64_tr_b16 a[128:129], v18 offset:16640
    ds_read_b64_tr_b16 a[130:131], v18 offset:18688
    v_mfma_f32_16x16x32_bf16 v[152:155], a[232:235], v[108:111], v[152:155]
    v_exp_f32 v97, v65
    v_mfma_f32_16x16x32_bf16 v[148:151], a[236:239], v[104:107], v[148:151]
    ds_read_b64_tr_b16 a[132:133], v19 offset:16640
    ds_read_b64_tr_b16 a[134:135], v19 offset:18688
    v_mfma_f32_16x16x32_bf16 v[156:159], a[236:239], v[108:111], v[156:159]
    v_add_f32 v37, v35, v96
    s_waitcnt lgkmcnt(12)
    v_mfma_f32_16x16x32_bf16 v[160:163], a[240:243], v[104:107], v[160:163]
    ds_read_b64_tr_b16 a[136:137], v20 offset:16640
    ds_read_b64_tr_b16 a[138:139], v20 offset:18688
    v_mfma_f32_16x16x32_bf16 v[168:171], a[240:243], v[108:111], v[168:171]
    v_exp_f32 v98, v66
    v_add_f32 v37, v37, v97
    v_mfma_f32_16x16x32_bf16 v[164:167], a[244:247], v[104:107], v[164:167]
    ds_read_b64_tr_b16 a[140:141], v21 offset:16640
    ds_read_b64_tr_b16 a[142:143], v21 offset:18688
    v_mfma_f32_16x16x32_bf16 v[172:175], a[244:247], v[108:111], v[172:175]
    s_add_u32 m0, s48, 114688
    s_waitcnt vmcnt(4)
    buffer_load_dwordx4 v29, s[12:15], s61 offen offset:1024 nt lds
    v_mfma_f32_16x16x32_bf16 v[176:179], a[248:251], v[104:107], v[176:179]
    s_barrier
    v_mfma_f32_16x16x32_bf16 v[184:187], a[248:251], v[108:111], v[184:187]
    ds_read_b128 a[224:227], v10 offset:49152
    v_cvt_pk_bf16_f32 v120, v96, v97
    v_mfma_f32_16x16x32_bf16 v[180:183], a[252:255], v[104:107], v[180:183]
    v_exp_f32 v99, v67
    v_mfma_f32_16x16x32_bf16 v[188:191], a[252:255], v[108:111], v[188:191]
    ds_read_b128 a[228:231], v10 offset:51200
    s_waitcnt lgkmcnt(10)
    v_mfma_f32_16x16x32_bf16 v[192:195], a[112:115], v[104:107], v[192:195]
    ds_read_b128 a[232:235], v11 offset:49152
    v_add_f32 v37, v37, v98
    v_mfma_f32_16x16x32_bf16 v[200:203], a[112:115], v[108:111], v[200:203]
    v_exp_f32 v100, v72
    v_mfma_f32_16x16x32_bf16 v[196:199], a[116:119], v[104:107], v[196:199]
    ds_read_b128 a[236:239], v11 offset:51200
    v_mfma_f32_16x16x32_bf16 v[204:207], a[116:119], v[108:111], v[204:207]
    s_add_u32 m0, s48, 114688
    s_waitcnt vmcnt(4)
    buffer_load_dwordx4 v28, s[12:15], s61 offen offset:2048 nt lds
    v_mfma_f32_16x16x32_bf16 v[208:211], a[120:123], v[104:107], v[208:211]
    ds_read_b128 a[240:243], v12 offset:49152
    v_add_f32 v37, v37, v99
    v_mfma_f32_16x16x32_bf16 v[216:219], a[120:123], v[108:111], v[216:219]
    v_cvt_pk_bf16_f32 v121, v98, v99
    v_exp_f32 v101, v73
    v_mfma_f32_16x16x32_bf16 v[212:215], a[124:127], v[104:107], v[212:215]
    ds_read_b128 a[244:247], v12 offset:51200
    v_mfma_f32_16x16x32_bf16 v[220:223], a[124:127], v[108:111], v[220:223]
    v_add_f32 v38, v36, v100
    s_waitcnt lgkmcnt(6)
    v_mfma_f32_16x16x32_bf16 v[224:227], a[128:131], v[104:107], v[224:227]
    ds_read_b128 a[248:251], v13 offset:49152
    v_exp_f32 v102, v74
    v_mfma_f32_16x16x32_bf16 v[232:235], a[128:131], v[108:111], v[232:235]
    v_add_f32 v38, v38, v101
    v_cvt_pk_bf16_f32 v124, v100, v101
    v_mfma_f32_16x16x32_bf16 v[228:231], a[132:135], v[104:107], v[228:231]
    v_exp_f32 v103, v75
    v_mfma_f32_16x16x32_bf16 v[236:239], a[132:135], v[108:111], v[236:239]
    ds_read_b128 a[252:255], v13 offset:51200
    v_add_f32 v38, v38, v102
    v_mfma_f32_16x16x32_bf16 v[240:243], a[136:139], v[104:107], v[240:243]
    ds_read_b128 a[112:115], v10 offset:49408
    v_mfma_f32_16x16x32_bf16 v[248:251], a[136:139], v[108:111], v[248:251]
    s_add_u32 m0, s48, 114688
    s_waitcnt vmcnt(4)
    buffer_load_dwordx4 v29, s[12:15], s61 offen offset:3072 nt lds
    v_mfma_f32_16x16x32_bf16 v[244:247], a[140:143], v[104:107], v[244:247]
    v_exp_f32 v96, v68
    v_mfma_f32_16x16x32_bf16 v[252:255], a[140:143], v[108:111], v[252:255]
    ds_read_b128 a[116:119], v10 offset:51456
    s_waitcnt lgkmcnt(6)
    v_mfma_f32_16x16x32_bf16 v[80:83], a[224:227], a[160:163], v[112:115]
    ds_read_b128 a[120:123], v11 offset:49408
    v_add_f32 v38, v38, v103
    v_mfma_f32_16x16x32_bf16 v[88:91], a[224:227], a[164:167], v[116:119]
    v_cvt_pk_bf16_f32 v125, v102, v103
    v_exp_f32 v97, v69
    v_mfma_f32_16x16x32_bf16 v[84:87], a[228:231], a[160:163], v[112:115]
    ds_read_b128 a[124:127], v11 offset:51456
    v_add_f32 v37, v37, v96
    v_mfma_f32_16x16x32_bf16 v[92:95], a[228:231], a[164:167], v[116:119]
    v_exp_f32 v98, v70
    v_mfma_f32_16x16x32_bf16 v[80:83], a[232:235], a[168:171], v[80:83]
    ds_read_b128 a[128:131], v12 offset:49408
    v_mfma_f32_16x16x32_bf16 v[88:91], a[232:235], a[172:175], v[88:91]
L_pg8:
    s_cbranch_execz L_pgr5
    v_add_f32 v37, v37, v97
    v_cvt_pk_bf16_f32 v122, v96, v97
    v_mfma_f32_16x16x32_bf16 v[84:87], a[236:239], a[168:171], v[84:87]
    v_exp_f32 v99, v71
    v_mfma_f32_16x16x32_bf16 v[92:95], a[236:239], a[172:175], v[92:95]
    ds_read_b128 a[132:135], v12 offset:51456
    s_waitcnt lgkmcnt(6)
    v_mfma_f32_16x16x32_bf16 v[80:83], a[240:243], a[176:179], v[80:83]
    ds_read_b128 a[136:139], v13 offset:49408
    v_add_f32 v37, v37, v98
    v_mfma_f32_16x16x32_bf16 v[88:91], a[240:243], a[180:183], v[88:91]
    v_exp_f32 v100, v76
    v_add_f32 v37, v37, v99
    v_mfma_f32_16x16x32_bf16 v[84:87], a[244:247], a[176:179], v[84:87]
    ds_read_b128 a[140:143], v13 offset:51456
    v_cvt_pk_bf16_f32 v123, v98, v99
    v_mfma_f32_16x16x32_bf16 v[92:95], a[244:247], a[180:183], v[92:95]
    v_exp_f32 v101, v77
    v_mfma_f32_16x16x32_bf16 v[80:83], a[248:251], a[184:187], v[80:83]
    s_waitcnt vmcnt(4)
    s_barrier
    v_mfma_f32_16x16x32_bf16 v[88:91], a[248:251], a[188:191], v[88:91]
    ds_read_b64_tr_b16 a[224:225], v14 offset:32768
    ds_read_b64_tr_b16 a[226:227], v14 offset:34816
    v_mfma_f32_16x16x32_bf16 v[84:87], a[252:255], a[184:187], v[84:87]
    ds_read_b64_tr_b16 a[228:229], v15 offset:32768
    ds_read_b64_tr_b16 a[230:231], v15 offset:34816
    v_mfma_f32_16x16x32_bf16 v[92:95], a[252:255], a[188:191], v[92:95]
    v_add_f32 v38, v38, v100
    s_waitcnt lgkmcnt(8)
    v_mfma_f32_16x16x32_bf16 v[80:83], a[112:115], a[192:195], v[80:83]
    ds_read_b64_tr_b16 a[232:233], v16 offset:32768
    ds_read_b64_tr_b16 a[234:235], v16 offset:34816
    v_mfma_f32_16x16x32_bf16 v[88:91], a[112:115], a[196:199], v[88:91]
    s_add_u32 m0, s48, 131072
    s_nop 0
    buffer_load_dwordx4 v30, s[20:23], s51 offen  lds
    v_mfma_f32_16x16x32_bf16 v[84:87], a[116:119], a[192:195], v[84:87]
    ds_read_b64_tr_b16 a[236:237], v17 offset:32768
    ds_read_b64_tr_b16 a[238:239], v17 offset:34816
    v_mfma_f32_16x16x32_bf16 v[92:95], a[116:119], a[196:199], v[92:95]
    v_exp_f32 v102, v78
    buffer_load_dwordx4 v31, s[20:23], s51 offen offset:1024  lds
    v_mfma_f32_16x16x32_bf16 v[80:83], a[120:123], a[200:203], v[80:83]
    ds_read_b64_tr_b16 a[240:241], v18 offset:32768
    ds_read_b64_tr_b16 a[242:243], v18 offset:34816
    v_mfma_f32_16x16x32_bf16 v[88:91], a[120:123], a[204:207], v[88:91]
    buffer_load_dwordx4 v32, s[20:23], s51 offen offset:2048  lds
    v_mfma_f32_16x16x32_bf16 v[84:87], a[124:127], a[200:203], v[84:87]
    ds_read_b64_tr_b16 a[244:245], v19 offset:32768
    ds_read_b64_tr_b16 a[246:247], v19 offset:34816
    v_mfma_f32_16x16x32_bf16 v[92:95], a[124:127], a[204:207], v[92:95]
    v_add_f32 v38, v38, v101
    buffer_load_dwordx4 v33, s[20:23], s51 offen offset:3072  lds
    s_waitcnt lgkmcnt(12)
    v_mfma_f32_16x16x32_bf16 v[80:83], a[128:131], a[208:211], v[80:83]
    ds_read_b64_tr_b16 a[248:249], v20 offset:32768
    ds_read_b64_tr_b16 a[250:251], v20 offset:34816
    v_mfma_f32_16x16x32_bf16 v[88:91], a[128:131], a[212:215], v[88:91]
    v_cvt_pk_bf16_f32 v126, v100, v101
    v_mfma_f32_16x16x32_bf16 v[84:87], a[132:135], a[208:211], v[84:87]
    ds_read_b64_tr_b16 a[252:253], v21 offset:32768
    ds_read_b64_tr_b16 a[254:255], v21 offset:34816
    v_mfma_f32_16x16x32_bf16 v[92:95], a[132:135], a[212:215], v[92:95]
    v_exp_f32 v103, v79
    v_add_f32 v38, v38, v102
    v_mfma_f32_16x16x32_bf16 v[80:83], a[136:139], a[216:219], v[80:83]
    ds_read_b64_tr_b16 a[112:113], v14 offset:33024
    ds_read_b64_tr_b16 a[114:115], v14 offset:35072
    v_mfma_f32_16x16x32_bf16 v[88:91], a[136:139], a[220:223], v[88:91]
    v_add_f32 v38, v38, v103
    v_cvt_pk_bf16_f32 v127, v102, v103
    v_mfma_f32_16x16x32_bf16 v[84:87], a[140:143], a[216:219], v[84:87]
    v_max_f32 v39, v37, v38
    v_cmp_lt_f32 vcc, s55, v39
    s_cbranch_vccz L_nm15
    s_call_b64 s[58:59], L_fixp0
L_nm15:
    v_mfma_f32_16x16x32_bf16 v[92:95], a[140:143], a[220:223], v[92:95]
    ds_read_b64_tr_b16 a[116:117], v15 offset:33024
    ds_read_b64_tr_b16 a[118:119], v15 offset:35072
    s_waitcnt lgkmcnt(12)
    v_mfma_f32_16x16x32_bf16 v[128:131], a[224:227], v[120:123], v[128:131]
    ds_read_b64_tr_b16 a[120:121], v16 offset:33024
    v_mfma_f32_16x16x32_bf16 v[136:139], a[224:227], v[124:127], v[136:139]
    ds_read_b64_tr_b16 a[122:123], v16 offset:35072
    v_mfma_f32_16x16x32_bf16 v[132:135], a[228:231], v[120:123], v[132:135]
    ds_read_b64_tr_b16 a[124:125], v17 offset:33024
    ds_read_b64_tr_b16 a[126:127], v17 offset:35072
    v_exp_f32 v96, v80
    v_mfma_f32_16x16x32_bf16 v[140:143], a[228:231], v[124:127], v[140:143]
    s_add_u32 m0, s48, 147456
    s_add_u32 s60, s51, 114688
    buffer_load_dwordx4 v30, s[20:23], s60 offen  lds
    v_mfma_f32_16x16x32_bf16 v[144:147], a[232:235], v[120:123], v[144:147]
    ds_read_b64_tr_b16 a[128:129], v18 offset:33024
    ds_read_b64_tr_b16 a[130:131], v18 offset:35072
    v_exp_f32 v97, v81
    v_mfma_f32_16x16x32_bf16 v[152:155], a[232:235], v[124:127], v[152:155]
    v_add_f32 v35, v37, v96
    v_exp_f32 v98, v82
    buffer_load_dwordx4 v31, s[20:23], s60 offen offset:1024  lds
    v_mfma_f32_16x16x32_bf16 v[148:151], a[236:239], v[120:123], v[148:151]
    ds_read_b64_tr_b16 a[132:133], v19 offset:33024
    ds_read_b64_tr_b16 a[134:135], v19 offset:35072
    v_add_f32 v35, v35, v97
    buffer_load_dwordx4 v32, s[20:23], s60 offen offset:2048  lds
    v_mfma_f32_16x16x32_bf16 v[156:159], a[236:239], v[124:127], v[156:159]
    v_cvt_pk_bf16_f32 v104, v96, v97
    v_exp_f32 v99, v83
    s_waitcnt lgkmcnt(12)
    v_mfma_f32_16x16x32_bf16 v[160:163], a[240:243], v[120:123], v[160:163]
    ds_read_b64_tr_b16 a[136:137], v20 offset:33024
    ds_read_b64_tr_b16 a[138:139], v20 offset:35072
    v_mfma_f32_16x16x32_bf16 v[168:171], a[240:243], v[124:127], v[168:171]
    buffer_load_dwordx4 v33, s[20:23], s60 offen offset:3072  lds
    s_add_u32 s51, s51, 128
    s_cmp_eq_u32 s51, 896
    s_cselect_b32 s51, 0, s51
    v_mfma_f32_16x16x32_bf16 v[164:167], a[244:247], v[120:123], v[164:167]
    ds_read_b64_tr_b16 a[140:141], v21 offset:33024
    ds_read_b64_tr_b16 a[142:143], v21 offset:35072
    v_add_f32 v35, v35, v98
    v_mfma_f32_16x16x32_bf16 v[172:175], a[244:247], v[124:127], v[172:175]
    v_exp_f32 v100, v88
    v_add_f32 v35, v35, v99
    v_cvt_pk_bf16_f32 v105, v98, v99
    v_mfma_f32_16x16x32_bf16 v[176:179], a[248:251], v[120:123], v[176:179]
    s_waitcnt vmcnt(8)
    s_barrier
    ds_read_b64_tr_b16 a[224:225], v14 offset:49152
    ds_read_b64_tr_b16 a[226:227], v14 offset:51200
    v_mfma_f32_16x16x32_bf16 v[184:187], a[248:251], v[124:127], v[184:187]
    v_exp_f32 v101, v89
    v_add_f32 v36, v38, v100
    v_exp_f32 v102, v90
    v_mfma_f32_16x16x32_bf16 v[180:183], a[252:255], v[120:123], v[180:183]
    ds_read_b64_tr_b16 a[228:229], v15 offset:49152
    ds_read_b64_tr_b16 a[230:231], v15 offset:51200
    v_add_f32 v36, v36, v101
    v_mfma_f32_16x16x32_bf16 v[188:191], a[252:255], v[124:127], v[188:191]
    v_cvt_pk_bf16_f32 v108, v100, v101
    v_exp_f32 v103, v91
    s_waitcnt lgkmcnt(12)
    v_mfma_f32_16x16x32_bf16 v[192:195], a[112:115], v[120:123], v[192:195]
    ds_read_b64_tr_b16 a[232:233], v16 offset:49152
    ds_read_b64_tr_b16 a[234:235], v16 offset:51200
    v_add_f32 v36, v36, v102
    v_mfma_f32_16x16x32_bf16 v[200:203], a[112:115], v[124:127], v[200:203]
    v_exp_f32 v96, v84
    v_add_f32 v36, v36, v103
    v_cvt_pk_bf16_f32 v109, v102, v103
    v_mfma_f32_16x16x32_bf16 v[196:199], a[116:119], v[120:123], v[196:199]
    ds_read_b64_tr_b16 a[236:237], v17 offset:49152
    ds_read_b64_tr_b16 a[238:239], v17 offset:51200
    v_exp_f32 v97, v85
    v_mfma_f32_16x16x32_bf16 v[204:207], a[116:119], v[124:127], v[204:207]
    v_add_f32 v35, v35, v96
    v_exp_f32 v98, v86
    v_mfma_f32_16x16x32_bf16 v[208:211], a[120:123], v[120:123], v[208:211]
    ds_read_b64_tr_b16 a[240:241], v18 offset:49152
    ds_read_b64_tr_b16 a[242:243], v18 offset:51200
    v_add_f32 v35, v35, v97
    v_mfma_f32_16x16x32_bf16 v[216:219], a[120:123], v[124:127], v[216:219]
    v_cvt_pk_bf16_f32 v106, v96, v97
    v_exp_f32 v99, v87
    v_add_f32 v35, v35, v98
    v_mfma_f32_16x16x32_bf16 v[212:215], a[124:127], v[120:123], v[212:215]
    ds_read_b64_tr_b16 a[244:245], v19 offset:49152
    ds_read_b64_tr_b16 a[246:247], v19 offset:51200
    s_add_u32 m0, s48, 0
    s_nop 0
    buffer_load_dwordx4 v30, s[20:23], s51 offen  lds
    v_mfma_f32_16x16x32_bf16 v[220:223], a[124:127], v[124:127], v[220:223]
    v_exp_f32 v100, v92
    v_add_f32 v35, v35, v99
    s_waitcnt lgkmcnt(12)
    v_mfma_f32_16x16x32_bf16 v[224:227], a[128:131], v[120:123], v[224:227]
    ds_read_b64_tr_b16 a[248:249], v20 offset:49152
    ds_read_b64_tr_b16 a[250:251], v20 offset:51200
    buffer_load_dwordx4 v31, s[20:23], s51 offen offset:1024  lds
    v_mfma_f32_16x16x32_bf16 v[232:235], a[128:131], v[124:127], v[232:235]
    v_cvt_pk_bf16_f32 v107, v98, v99
    v_exp_f32 v101, v93
    v_add_f32 v36, v36, v100
    v_mfma_f32_16x16x32_bf16 v[228:231], a[132:135], v[120:123], v[228:231]
    ds_read_b64_tr_b16 a[252:253], v21 offset:49152
    ds_read_b64_tr_b16 a[254:255], v21 offset:51200
    buffer_load_dwordx4 v32, s[20:23], s51 offen offset:2048  lds
    v_mfma_f32_16x16x32_bf16 v[236:239], a[132:135], v[124:127], v[236:239]
    v_exp_f32 v102, v94
    v_add_f32 v36, v36, v101
    v_cvt_pk_bf16_f32 v110, v100, v101
    v_mfma_f32_16x16x32_bf16 v[240:243], a[136:139], v[120:123], v[240:243]
    ds_read_b64_tr_b16 a[112:113], v14 offset:49408
    ds_read_b64_tr_b16 a[114:115], v14 offset:51456
    v_exp_f32 v103, v95
    v_mfma_f32_16x16x32_bf16 v[248:251], a[136:139], v[124:127], v[248:251]
    v_add_f32 v36, v36, v102
    v_add_f32 v36, v36, v103
    v_cvt_pk_bf16_f32 v111, v102, v103
    buffer_load_dwordx4 v33, s[20:23], s51 offen offset:3072  lds
    v_mfma_f32_16x16x32_bf16 v[244:247], a[140:143], v[120:123], v[244:247]
    ds_read_b64_tr_b16 a[116:117], v15 offset:49408
    ds_read_b64_tr_b16 a[118:119], v15 offset:51456
    v_mfma_f32_16x16x32_bf16 v[252:255], a[140:143], v[124:127], v[252:255]
    v_max_f32 v39, v35, v36
    v_cmp_lt_f32 vcc, s55, v39
    s_cbranch_vccz L_nm16
    s_call_b64 s[58:59], L_fixp1
L_nm16:
    s_waitcnt lgkmcnt(12)
    v_mfma_f32_16x16x32_bf16 v[128:131], a[224:227], v[104:107], v[128:131]
    ds_read_b64_tr_b16 a[120:121], v16 offset:49408
    v_mfma_f32_16x16x32_bf16 v[136:139], a[224:227], v[108:111], v[136:139]
    ds_read_b64_tr_b16 a[122:123], v16 offset:51456
    v_mfma_f32_16x16x32_bf16 v[132:135], a[228:231], v[104:107], v[132:135]
    ds_read_b64_tr_b16 a[124:125], v17 offset:49408
    v_mfma_f32_16x16x32_bf16 v[140:143], a[228:231], v[108:111], v[140:143]
    ds_read_b64_tr_b16 a[126:127], v17 offset:51456
    v_mfma_f32_16x16x32_bf16 v[144:147], a[232:235], v[104:107], v[144:147]
    ds_read_b64_tr_b16 a[128:129], v18 offset:49408
    v_mfma_f32_16x16x32_bf16 v[152:155], a[232:235], v[108:111], v[152:155]
    ds_read_b64_tr_b16 a[130:131], v18 offset:51456
    v_mfma_f32_16x16x32_bf16 v[148:151], a[236:239], v[104:107], v[148:151]
    ds_read_b64_tr_b16 a[132:133], v19 offset:49408
    ds_read_b64_tr_b16 a[134:135], v19 offset:51456
    v_cvt_pk_bf16_f32 v128, v128, v129
    v_mfma_f32_16x16x32_bf16 v[156:159], a[236:239], v[108:111], v[156:159]
    v_cvt_pk_bf16_f32 v129, v130, v131
    v_cvt_pk_bf16_f32 v130, v132, v133
    s_waitcnt lgkmcnt(12)
    v_mfma_f32_16x16x32_bf16 v[160:163], a[240:243], v[104:107], v[160:163]
    ds_read_b64_tr_b16 a[136:137], v20 offset:49408
    ds_read_b64_tr_b16 a[138:139], v20 offset:51456
    v_cvt_pk_bf16_f32 v131, v134, v135
    v_mfma_f32_16x16x32_bf16 v[168:171], a[240:243], v[108:111], v[168:171]
    v_cvt_pk_bf16_f32 v136, v136, v137
    s_add_u32 m0, s48, 16384
    s_add_u32 s60, s51, 114688
    buffer_load_dwordx4 v30, s[20:23], s60 offen  lds
    v_mfma_f32_16x16x32_bf16 v[164:167], a[244:247], v[104:107], v[164:167]
    ds_read_b64_tr_b16 a[140:141], v21 offset:49408
    ds_read_b64_tr_b16 a[142:143], v21 offset:51456
    buffer_load_dwordx4 v31, s[20:23], s60 offen offset:1024  lds
    v_mfma_f32_16x16x32_bf16 v[172:175], a[244:247], v[108:111], v[172:175]
    v_cvt_pk_bf16_f32 v137, v138, v139
    v_cvt_pk_bf16_f32 v138, v140, v141
    v_cvt_pk_bf16_f32 v139, v142, v143
    v_mfma_f32_16x16x32_bf16 v[176:179], a[248:251], v[104:107], v[176:179]
    s_waitcnt vmcnt(10)
    s_barrier
    ds_read_b64_tr_b16 a[224:225], v22 offset:0
    ds_read_b64_tr_b16 a[226:227], v22 offset:2048
    v_mfma_f32_16x16x32_bf16 v[184:187], a[248:251], v[108:111], v[184:187]
    v_cvt_pk_bf16_f32 v144, v144, v145
    v_cvt_pk_bf16_f32 v145, v146, v147
    buffer_load_dwordx4 v32, s[20:23], s60 offen offset:2048  lds
    v_mfma_f32_16x16x32_bf16 v[180:183], a[252:255], v[104:107], v[180:183]
    buffer_load_dwordx4 v33, s[20:23], s60 offen offset:3072  lds
    s_add_u32 s51, s51, 128
    s_cmp_eq_u32 s51, 896
    s_cselect_b32 s51, 0, s51
    v_mfma_f32_16x16x32_bf16 v[188:191], a[252:255], v[108:111], v[188:191]
    ds_read_b64_tr_b16 a[228:229], v23 offset:0
    ds_read_b64_tr_b16 a[230:231], v23 offset:2048
    v_cvt_pk_bf16_f32 v146, v148, v149
    s_waitcnt lgkmcnt(12)
    v_mfma_f32_16x16x32_bf16 v[192:195], a[112:115], v[104:107], v[192:195]
    ds_read_b64_tr_b16 a[232:233], v24 offset:0
    ds_read_b64_tr_b16 a[234:235], v24 offset:2048
    v_cvt_pk_bf16_f32 v147, v150, v151
    v_mfma_f32_16x16x32_bf16 v[200:203], a[112:115], v[108:111], v[200:203]
    v_cvt_pk_bf16_f32 v152, v152, v153
    v_cvt_pk_bf16_f32 v153, v154, v155
    v_cvt_pk_bf16_f32 v154, v156, v157
    v_cvt_pk_bf16_f32 v155, v158, v159
    v_mfma_f32_16x16x32_bf16 v[196:199], a[116:119], v[104:107], v[196:199]
    ds_read_b64_tr_b16 a[236:237], v25 offset:0
    ds_read_b64_tr_b16 a[238:239], v25 offset:2048
    v_mfma_f32_16x16x32_bf16 v[204:207], a[116:119], v[108:111], v[204:207]
    v_cvt_pk_bf16_f32 v160, v160, v161
    v_cvt_pk_bf16_f32 v161, v162, v163
    v_cvt_pk_bf16_f32 v162, v164, v165
    v_mfma_f32_16x16x32_bf16 v[208:211], a[120:123], v[104:107], v[208:211]
    ds_read_b64_tr_b16 a[240:241], v22 offset:4096
    ds_read_b64_tr_b16 a[242:243], v22 offset:6144
    v_mfma_f32_16x16x32_bf16 v[216:219], a[120:123], v[108:111], v[216:219]
    v_cvt_pk_bf16_f32 v163, v166, v167
    v_cvt_pk_bf16_f32 v168, v168, v169
    v_cvt_pk_bf16_f32 v169, v170, v171
    v_mfma_f32_16x16x32_bf16 v[212:215], a[124:127], v[104:107], v[212:215]
    ds_read_b64_tr_b16 a[244:245], v23 offset:4096
    ds_read_b64_tr_b16 a[246:247], v23 offset:6144
    v_mfma_f32_16x16x32_bf16 v[220:223], a[124:127], v[108:111], v[220:223]
    v_cvt_pk_bf16_f32 v170, v172, v173
    v_cvt_pk_bf16_f32 v171, v174, v175
    s_waitcnt lgkmcnt(12)
    v_mfma_f32_16x16x32_bf16 v[224:227], a[128:131], v[104:107], v[224:227]
    ds_read_b64_tr_b16 a[248:249], v24 offset:4096
    ds_read_b64_tr_b16 a[250:251], v24 offset:6144
    v_mfma_f32_16x16x32_bf16 v[232:235], a[128:131], v[108:111], v[232:235]
    v_cvt_pk_bf16_f32 v176, v176, v177
    v_cvt_pk_bf16_f32 v177, v178, v179
    v_cvt_pk_bf16_f32 v178, v180, v181
    v_mfma_f32_16x16x32_bf16 v[228:231], a[132:135], v[104:107], v[228:231]
    ds_read_b64_tr_b16 a[252:253], v25 offset:4096
    ds_read_b64_tr_b16 a[254:255], v25 offset:6144
    v_cvt_pk_bf16_f32 v179, v182, v183
    v_mfma_f32_16x16x32_bf16 v[236:239], a[132:135], v[108:111], v[236:239]
    v_cvt_pk_bf16_f32 v184, v184, v185
    v_cvt_pk_bf16_f32 v185, v186, v187
    v_cvt_pk_bf16_f32 v186, v188, v189
    v_mfma_f32_16x16x32_bf16 v[240:243], a[136:139], v[104:107], v[240:243]
    ds_read_b64_tr_b16 a[112:113], v22 offset:8192
    ds_read_b64_tr_b16 a[114:115], v22 offset:10240
    v_mfma_f32_16x16x32_bf16 v[248:251], a[136:139], v[108:111], v[248:251]
    v_cvt_pk_bf16_f32 v187, v190, v191
    s_add_u32 m0, s48, 32768
    s_nop 0
    buffer_load_dwordx4 v30, s[20:23], s51 offen  lds
    v_mfma_f32_16x16x32_bf16 v[244:247], a[140:143], v[104:107], v[244:247]
    ds_read_b64_tr_b16 a[116:117], v23 offset:8192
    ds_read_b64_tr_b16 a[118:119], v23 offset:10240
    buffer_load_dwordx4 v31, s[20:23], s51 offen offset:1024  lds
    v_mfma_f32_16x16x32_bf16 v[252:255], a[140:143], v[108:111], v[252:255]
    v_cvt_pk_bf16_f32 v192, v192, v193
    v_cvt_pk_bf16_f32 v193, v194, v195
    s_waitcnt lgkmcnt(12)
    v_mfma_f32_16x16x32_bf16 v[64:67], a[224:227], v[128:131], 0
    ds_read_b64_tr_b16 a[120:121], v24 offset:8192
    ds_read_b64_tr_b16 a[122:123], v24 offset:10240
    buffer_load_dwordx4 v32, s[20:23], s51 offen offset:2048  lds
    v_mfma_f32_16x16x32_bf16 v[72:75], a[224:227], v[136:139], 0
    v_cvt_pk_bf16_f32 v194, v196, v197
    v_cvt_pk_bf16_f32 v195, v198, v199
    v_cvt_pk_bf16_f32 v200, v200, v201
    v_mfma_f32_16x16x32_bf16 v[68:71], a[228:231], v[128:131], 0
    ds_read_b64_tr_b16 a[124:125], v25 offset:8192
    ds_read_b64_tr_b16 a[126:127], v25 offset:10240
    buffer_load_dwordx4 v33, s[20:23], s51 offen offset:3072  lds
    v_mfma_f32_16x16x32_bf16 v[76:79], a[228:231], v[136:139], 0
    v_cvt_pk_bf16_f32 v201, v202, v203
    v_cvt_pk_bf16_f32 v202, v204, v205
    v_cvt_pk_bf16_f32 v203, v206, v207
    v_mfma_f32_16x16x32_bf16 v[80:83], a[232:235], v[128:131], 0
    ds_read_b64_tr_b16 a[128:129], v22 offset:12288
    ds_read_b64_tr_b16 a[130:131], v22 offset:14336
    v_mfma_f32_16x16x32_bf16 v[88:91], a[232:235], v[136:139], 0
    v_cvt_pk_bf16_f32 v208, v208, v209
    v_cvt_pk_bf16_f32 v209, v210, v211
    v_cvt_pk_bf16_f32 v210, v212, v213
    v_mfma_f32_16x16x32_bf16 v[84:87], a[236:239], v[128:131], 0
    ds_read_b64_tr_b16 a[132:133], v23 offset:12288
    ds_read_b64_tr_b16 a[134:135], v23 offset:14336
    v_cvt_pk_bf16_f32 v211, v214, v215
    v_mfma_f32_16x16x32_bf16 v[92:95], a[236:239], v[136:139], 0
    v_cvt_pk_bf16_f32 v216, v216, v217
    v_cvt_pk_bf16_f32 v217, v218, v219
    s_waitcnt lgkmcnt(12)
    v_mfma_f32_16x16x32_bf16 v[64:67], a[240:243], v[144:147], v[64:67]
    ds_read_b64_tr_b16 a[136:137], v24 offset:12288
    ds_read_b64_tr_b16 a[138:139], v24 offset:14336
    v_mfma_f32_16x16x32_bf16 v[72:75], a[240:243], v[152:155], v[72:75]
    v_permlane32_swap_b32 v35, v36
    v_cvt_pk_bf16_f32 v218, v220, v221
    v_cvt_pk_bf16_f32 v219, v222, v223
    v_mfma_f32_16x16x32_bf16 v[68:71], a[244:247], v[144:147], v[68:71]
    ds_read_b64_tr_b16 a[140:141], v25 offset:12288
    ds_read_b64_tr_b16 a[142:143], v25 offset:14336
    v_add_f32 v35, v35, v36
    v_mfma_f32_16x16x32_bf16 v[76:79], a[244:247], v[152:155], v[76:79]
    v_cvt_pk_bf16_f32 v224, v224, v225
    v_cvt_pk_bf16_f32 v225, v226, v227
    v_cvt_pk_bf16_f32 v226, v228, v229
    v_cvt_pk_bf16_f32 v227, v230, v231
    v_mfma_f32_16x16x32_bf16 v[80:83], a[248:251], v[144:147], v[80:83]
    s_waitcnt vmcnt(12)
    s_barrier
    ds_read_b64_tr_b16 a[224:225], v22 offset:16384
    v_mfma_f32_16x16x32_bf16 v[88:91], a[248:251], v[152:155], v[88:91]
    ds_read_b64_tr_b16 a[226:227], v22 offset:18432
    v_mov_b32 v36, v35
    v_cvt_pk_bf16_f32 v232, v232, v233
    v_mfma_f32_16x16x32_bf16 v[84:87], a[252:255], v[144:147], v[84:87]
    ds_read_b64_tr_b16 a[228:229], v23 offset:16384
    ds_read_b64_tr_b16 a[230:231], v23 offset:18432
    v_permlane16_swap_b32 v35, v36
    v_mfma_f32_16x16x32_bf16 v[92:95], a[252:255], v[152:155], v[92:95]
    v_cvt_pk_bf16_f32 v233, v234, v235
    v_cvt_pk_bf16_f32 v234, v236, v237
    v_cvt_pk_bf16_f32 v235, v238, v239
    s_waitcnt lgkmcnt(12)
    v_mfma_f32_16x16x32_bf16 v[64:67], a[112:115], v[160:163], v[64:67]
    ds_read_b64_tr_b16 a[232:233], v24 offset:16384
    ds_read_b64_tr_b16 a[234:235], v24 offset:18432
    v_add_f32 v35, v35, v36
    v_cvt_pk_bf16_f32 v240, v240, v241
    v_mfma_f32_16x16x32_bf16 v[72:75], a[112:115], v[168:171], v[72:75]
    v_cvt_pk_bf16_f32 v241, v242, v243
    s_add_u32 m0, s48, 49152
    s_add_u32 s60, s51, 114688
    buffer_load_dwordx4 v30, s[20:23], s60 offen  lds
    v_mfma_f32_16x16x32_bf16 v[68:71], a[116:119], v[160:163], v[68:71]
    ds_read_b64_tr_b16 a[236:237], v25 offset:16384
    ds_read_b64_tr_b16 a[238:239], v25 offset:18432
    buffer_load_dwordx4 v31, s[20:23], s60 offen offset:1024  lds
    v_mfma_f32_16x16x32_bf16 v[76:79], a[116:119], v[168:171], v[76:79]
    v_rcp_f32 v43, v35
    v_cvt_pk_bf16_f32 v242, v244, v245
    v_cvt_pk_bf16_f32 v243, v246, v247
    v_mfma_f32_16x16x32_bf16 v[80:83], a[120:123], v[160:163], v[80:83]
    ds_read_b64_tr_b16 a[240:241], v22 offset:20480
    ds_read_b64_tr_b16 a[242:243], v22 offset:22528
    v_mov_b32 v44, v43
    buffer_load_dwordx4 v32, s[20:23], s60 offen offset:2048  lds
    v_mfma_f32_16x16x32_bf16 v[88:91], a[120:123], v[168:171], v[88:91]
    v_cvt_pk_bf16_f32 v248, v248, v249
    v_cvt_pk_bf16_f32 v249, v250, v251
    v_cvt_pk_bf16_f32 v250, v252, v253
    v_cvt_pk_bf16_f32 v251, v254, v255
    v_mfma_f32_16x16x32_bf16 v[84:87], a[124:127], v[160:163], v[84:87]
    buffer_load_dwordx4 v33, s[20:23], s60 offen offset:3072  lds
    s_add_u32 s51, s51, 128
    s_cmp_eq_u32 s51, 896
    s_cselect_b32 s51, 0, s51
    v_mfma_f32_16x16x32_bf16 v[92:95], a[124:127], v[168:171], v[92:95]
    ds_read_b64_tr_b16 a[244:245], v23 offset:20480
    ds_read_b64_tr_b16 a[246:247], v23 offset:22528
    v_permlane32_swap_b32 v43, v44
    s_waitcnt lgkmcnt(12)
    v_mfma_f32_16x16x32_bf16 v[64:67], a[128:131], v[176:179], v[64:67]
    ds_read_b64_tr_b16 a[248:249], v24 offset:20480
    v_mfma_f32_16x16x32_bf16 v[72:75], a[128:131], v[184:187], v[72:75]
    ds_read_b64_tr_b16 a[250:251], v24 offset:22528
    v_mfma_f32_16x16x32_bf16 v[68:71], a[132:135], v[176:179], v[68:71]
    ds_read_b64_tr_b16 a[252:253], v25 offset:20480
    v_mfma_f32_16x16x32_bf16 v[76:79], a[132:135], v[184:187], v[76:79]
    ds_read_b64_tr_b16 a[254:255], v25 offset:22528
    v_mfma_f32_16x16x32_bf16 v[80:83], a[136:139], v[176:179], v[80:83]
    ds_read_b64_tr_b16 a[112:113], v22 offset:24576
    v_mfma_f32_16x16x32_bf16 v[88:91], a[136:139], v[184:187], v[88:91]
    ds_read_b64_tr_b16 a[114:115], v22 offset:26624
    v_mfma_f32_16x16x32_bf16 v[84:87], a[140:143], v[176:179], v[84:87]
    ds_read_b64_tr_b16 a[116:117], v23 offset:24576
    ds_read_b64_tr_b16 a[118:119], v23 offset:26624
    v_mfma_f32_16x16x32_bf16 v[92:95], a[140:143], v[184:187], v[92:95]
    s_waitcnt lgkmcnt(12)
    v_mfma_f32_16x16x32_bf16 v[64:67], a[224:227], v[192:195], v[64:67]
    ds_read_b64_tr_b16 a[120:121], v24 offset:24576
    v_mfma_f32_16x16x32_bf16 v[72:75], a[224:227], v[200:203], v[72:75]
    ds_read_b64_tr_b16 a[122:123], v24 offset:26624
    v_mfma_f32_16x16x32_bf16 v[68:71], a[228:231], v[192:195], v[68:71]
    ds_read_b64_tr_b16 a[124:125], v25 offset:24576
    ds_read_b64_tr_b16 a[126:127], v25 offset:26624
    v_mfma_f32_16x16x32_bf16 v[76:79], a[228:231], v[200:203], v[76:79]
    s_add_u32 m0, s48, 65536
    s_nop 0
    buffer_load_dwordx4 v30, s[20:23], s51 offen  lds
    v_mfma_f32_16x16x32_bf16 v[80:83], a[232:235], v[192:195], v[80:83]
    ds_read_b64_tr_b16 a[128:129], v22 offset:28672
    ds_read_b64_tr_b16 a[130:131], v22 offset:30720
    v_mfma_f32_16x16x32_bf16 v[88:91], a[232:235], v[200:203], v[88:91]
    buffer_load_dwordx4 v31, s[20:23], s51 offen offset:1024  lds
    v_mfma_f32_16x16x32_bf16 v[84:87], a[236:239], v[192:195], v[84:87]
    v_accvgpr_read_b32 v39, a149
    v_accvgpr_read_b32 v49, a148
    v_readfirstlane_b32 s100, v39
    v_cmp_eq_u32 vcc, 0, v49
    s_cbranch_vccz L_chk_ok
    s_call_b64 s[58:59], L_chk_wait
L_chk_ok:
    s_cmp_eq_u32 s100, s101
    s_cselect_b32 s78, s78, 0x7ff00000
    v_lshl_add_u32 v62, v62, 16, s78
    v_mfma_f32_16x16x32_bf16 v[92:95], a[236:239], v[200:203], v[92:95]
    ds_read_b64_tr_b16 a[132:133], v23 offset:28672
    ds_read_b64_tr_b16 a[134:135], v23 offset:30720
    buffer_load_dwordx4 v32, s[20:23], s51 offen offset:2048  lds
    s_waitcnt lgkmcnt(12)
    v_mfma_f32_16x16x32_bf16 v[64:67], a[240:243], v[208:211], v[64:67]
    ds_read_b64_tr_b16 a[136:137], v24 offset:28672
    ds_read_b64_tr_b16 a[138:139], v24 offset:30720
    v_mfma_f32_16x16x32_bf16 v[72:75], a[240:243], v[216:219], v[72:75]
    buffer_load_dwordx4 v33, s[20:23], s51 offen offset:3072  lds
    v_mfma_f32_16x16x32_bf16 v[68:71], a[244:247], v[208:211], v[68:71]
    ds_read_b64_tr_b16 a[140:141], v25 offset:28672
    v_mfma_f32_16x16x32_bf16 v[76:79], a[244:247], v[216:219], v[76:79]
    ds_read_b64_tr_b16 a[142:143], v25 offset:30720
    v_mfma_f32_16x16x32_bf16 v[80:83], a[248:251], v[208:211], v[80:83]
    s_waitcnt vmcnt(16)
    s_barrier
    v_add_u32 v22, 4294836224, v22
    ds_read_b64_tr_b16 a[224:225], v22 offset:0
    ds_read_b64_tr_b16 a[226:227], v22 offset:2048
    v_mfma_f32_16x16x32_bf16 v[88:91], a[248:251], v[216:219], v[88:91]
    v_add_u32 v23, 4294836224, v23
    s_add_u32 s9, s56, 4096
    s_and_b32 s3, s9, 8192
    s_add_u32 s9, s9, s3
    v_mfma_f32_16x16x32_bf16 v[84:87], a[252:255], v[208:211], v[84:87]
    ds_read_b64_tr_b16 a[228:229], v22 offset:4096
    ds_read_b64_tr_b16 a[230:231], v22 offset:6144
    v_mfma_f32_16x16x32_bf16 v[92:95], a[252:255], v[216:219], v[92:95]
    v_add_u32 v24, 4294836224, v24
    s_waitcnt lgkmcnt(12)
    v_mfma_f32_16x16x32_bf16 v[64:67], a[112:115], v[224:227], v[64:67]
    ds_read_b64_tr_b16 a[232:233], v22 offset:8192
    ds_read_b64_tr_b16 a[234:235], v22 offset:10240
    v_add_u32 v25, 4294836224, v25
    v_mfma_f32_16x16x32_bf16 v[72:75], a[112:115], v[232:235], v[72:75]
    s_cmp_eq_u32 s9, 53248
    s_cselect_b32 s9, 0, s9
    v_mfma_f32_16x16x32_bf16 v[68:71], a[116:119], v[224:227], v[68:71]
    ds_read_b64_tr_b16 a[236:237], v22 offset:12288
    v_mfma_f32_16x16x32_bf16 v[76:79], a[116:119], v[232:235], v[76:79]
    ds_read_b64_tr_b16 a[238:239], v22 offset:14336
    v_mfma_f32_16x16x32_bf16 v[80:83], a[120:123], v[224:227], v[80:83]
    ds_read_b64_tr_b16 a[240:241], v23 offset:0
    v_mfma_f32_16x16x32_bf16 v[88:91], a[120:123], v[232:235], v[88:91]
    ds_read_b64_tr_b16 a[242:243], v23 offset:2048
    v_mfma_f32_16x16x32_bf16 v[84:87], a[124:127], v[224:227], v[84:87]
    s_add_u32 m0, s48, 81920
    s_add_u32 s60, s51, 114688
    buffer_load_dwordx4 v30, s[20:23], s60 offen  lds
    v_mfma_f32_16x16x32_bf16 v[92:95], a[124:127], v[232:235], v[92:95]
    ds_read_b64_tr_b16 a[244:245], v23 offset:4096
    ds_read_b64_tr_b16 a[246:247], v23 offset:6144
    s_waitcnt lgkmcnt(12)
    v_mfma_f32_16x16x32_bf16 v[64:67], a[128:131], v[240:243], v[64:67]
    ds_read_b64_tr_b16 a[248:249], v23 offset:8192
    ds_read_b64_tr_b16 a[250:251], v23 offset:10240
    v_mfma_f32_16x16x32_bf16 v[72:75], a[128:131], v[248:251], v[72:75]
    buffer_load_dwordx4 v31, s[20:23], s60 offen offset:1024  lds
    v_mfma_f32_16x16x32_bf16 v[68:71], a[132:135], v[240:243], v[68:71]
    ds_read_b64_tr_b16 a[252:253], v23 offset:12288
    ds_read_b64_tr_b16 a[254:255], v23 offset:14336
    v_mfma_f32_16x16x32_bf16 v[76:79], a[132:135], v[248:251], v[76:79]
    buffer_load_dwordx4 v32, s[20:23], s60 offen offset:2048  lds
    v_mfma_f32_16x16x32_bf16 v[80:83], a[136:139], v[240:243], v[80:83]
    ds_read_b64_tr_b16 a[112:113], v24 offset:0
    ds_read_b64_tr_b16 a[114:115], v24 offset:2048
    buffer_load_dword a152, v62, s[32:35], 0 offen
    v_mfma_f32_16x16x32_bf16 v[88:91], a[136:139], v[248:251], v[88:91]
    buffer_load_dwordx4 v33, s[20:23], s60 offen offset:3072  lds
    s_add_u32 s51, s51, 128
    s_cmp_eq_u32 s51, 896
    s_cselect_b32 s51, 0, s51
    v_mfma_f32_16x16x32_bf16 v[84:87], a[140:143], v[240:243], v[84:87]
    ds_read_b64_tr_b16 a[116:117], v24 offset:4096
    ds_read_b64_tr_b16 a[118:119], v24 offset:6144
    v_mfma_f32_16x16x32_bf16 v[92:95], a[140:143], v[248:251], v[92:95]
    s_waitcnt lgkmcnt(12)
    v_mfma_f32_16x16x32_bf16 v[96:99], a[224:227], v[128:131], 0
    ds_read_b64_tr_b16 a[120:121], v24 offset:8192
    v_mfma_f32_16x16x32_bf16 v[104:107], a[224:227], v[136:139], 0
    ds_read_b64_tr_b16 a[122:123], v24 offset:10240
    v_mfma_f32_16x16x32_bf16 v[96:99], a[228:231], v[144:147], v[96:99]
    ds_read_b64_tr_b16 a[124:125], v24 offset:12288
    ds_read_b64_tr_b16 a[126:127], v24 offset:14336
    v_mul_f32 v64, v64, v43
    v_mfma_f32_16x16x32_bf16 v[104:107], a[228:231], v[152:155], v[104:107]
    v_mul_f32 v65, v65, v43
    v_mul_f32 v66, v66, v43
    v_mul_f32 v67, v67, v43
    v_mfma_f32_16x16x32_bf16 v[96:99], a[232:235], v[160:163], v[96:99]
    ds_read_b64_tr_b16 a[128:129], v25 offset:0
    ds_read_b64_tr_b16 a[130:131], v25 offset:2048
    v_mul_f32 v68, v68, v43
    v_mfma_f32_16x16x32_bf16 v[104:107], a[232:235], v[168:171], v[104:107]
L_pg9:
    s_cbranch_execz L_pgr9
    v_mul_f32 v69, v69, v43
    v_mul_f32 v70, v70, v43
    v_mul_f32 v71, v71, v43
    v_mfma_f32_16x16x32_bf16 v[96:99], a[236:239], v[176:179], v[96:99]
    ds_read_b64_tr_b16 a[132:133], v25 offset:4096
    ds_read_b64_tr_b16 a[134:135], v25 offset:6144
    v_cvt_pk_bf16_f32 v132, v64, v65
    v_mfma_f32_16x16x32_bf16 v[104:107], a[236:239], v[184:187], v[104:107]
    v_cvt_pk_bf16_f32 v133, v66, v67
    v_cvt_pk_bf16_f32 v134, v68, v69
    s_waitcnt lgkmcnt(12)
    v_mfma_f32_16x16x32_bf16 v[100:103], a[240:243], v[128:131], 0
    ds_read_b64_tr_b16 a[136:137], v25 offset:8192
    ds_read_b64_tr_b16 a[138:139], v25 offset:10240
    s_add_u32 m0, s48, 98304
    s_nop 0
    buffer_load_dwordx4 v30, s[20:23], s51 offen  lds
    v_mfma_f32_16x16x32_bf16 v[108:111], a[240:243], v[136:139], 0
    v_cvt_pk_bf16_f32 v135, v70, v71
    v_mul_f32 v72, v72, v44
    v_mul_f32 v73, v73, v44
    v_mfma_f32_16x16x32_bf16 v[100:103], a[244:247], v[144:147], v[100:103]
    ds_read_b64_tr_b16 a[140:141], v25 offset:12288
    ds_read_b64_tr_b16 a[142:143], v25 offset:14336
    buffer_load_dwordx4 v31, s[20:23], s51 offen offset:1024  lds
    v_mfma_f32_16x16x32_bf16 v[108:111], a[244:247], v[152:155], v[108:111]
    v_mul_f32 v74, v74, v44
    v_mul_f32 v75, v75, v44
    v_mul_f32 v76, v76, v44
    v_mfma_f32_16x16x32_bf16 v[100:103], a[248:251], v[160:163], v[100:103]
    s_waitcnt vmcnt(19)
    s_barrier
    ds_read_b64_tr_b16 a[224:225], v22 offset:16384
    v_mfma_f32_16x16x32_bf16 v[108:111], a[248:251], v[168:171], v[108:111]
    ds_read_b64_tr_b16 a[226:227], v22 offset:18432
    v_mul_f32 v77, v77, v44
    buffer_load_dwordx4 v32, s[20:23], s51 offen offset:2048  lds
    v_mfma_f32_16x16x32_bf16 v[100:103], a[252:255], v[176:179], v[100:103]
    ds_read_b64_tr_b16 a[228:229], v22 offset:20480
    ds_read_b64_tr_b16 a[230:231], v22 offset:22528
    buffer_load_dwordx4 v33, s[20:23], s51 offen offset:3072  lds
    v_mfma_f32_16x16x32_bf16 v[108:111], a[252:255], v[184:187], v[108:111]
    v_mul_f32 v78, v78, v44
    v_mul_f32 v79, v79, v44
    s_waitcnt lgkmcnt(12)
    v_mfma_f32_16x16x32_bf16 v[112:115], a[112:115], v[128:131], 0
    ds_read_b64_tr_b16 a[232:233], v22 offset:24576
    ds_read_b64_tr_b16 a[234:235], v22 offset:26624
    v_cvt_pk_bf16_f32 v140, v72, v73
    v_mfma_f32_16x16x32_bf16 v[120:123], a[112:115], v[136:139], 0
    v_cvt_pk_bf16_f32 v141, v74, v75
    v_cvt_pk_bf16_f32 v142, v76, v77
    v_cvt_pk_bf16_f32 v143, v78, v79
    v_mfma_f32_16x16x32_bf16 v[112:115], a[116:119], v[144:147], v[112:115]
    ds_read_b64_tr_b16 a[236:237], v22 offset:28672
    ds_read_b64_tr_b16 a[238:239], v22 offset:30720
    v_mfma_f32_16x16x32_bf16 v[120:123], a[116:119], v[152:155], v[120:123]
    v_mul_f32 v80, v80, v43
    v_mul_f32 v81, v81, v43
    v_mfma_f32_16x16x32_bf16 v[112:115], a[120:123], v[160:163], v[112:115]
    ds_read_b64_tr_b16 a[240:241], v23 offset:16384
    ds_read_b64_tr_b16 a[242:243], v23 offset:18432
    v_mfma_f32_16x16x32_bf16 v[120:123], a[120:123], v[168:171], v[120:123]
    v_mul_f32 v82, v82, v43
    v_mul_f32 v83, v83, v43
    v_mul_f32 v84, v84, v43
    v_mfma_f32_16x16x32_bf16 v[112:115], a[124:127], v[176:179], v[112:115]
    ds_read_b64_tr_b16 a[244:245], v23 offset:20480
    ds_read_b64_tr_b16 a[246:247], v23 offset:22528
    v_mfma_f32_16x16x32_bf16 v[120:123], a[124:127], v[184:187], v[120:123]
    v_mul_f32 v85, v85, v43
    s_waitcnt lgkmcnt(12)
    v_mfma_f32_16x16x32_bf16 v[116:119], a[128:131], v[128:131], 0
    ds_read_b64_tr_b16 a[248:249], v23 offset:24576
    ds_read_b64_tr_b16 a[250:251], v23 offset:26624
    v_mfma_f32_16x16x32_bf16 v[124:127], a[128:131], v[136:139], 0
    v_mul_f32 v86, v86, v43
    v_mul_f32 v87, v87, v43
    v_cvt_pk_bf16_f32 v148, v80, v81
    v_mfma_f32_16x16x32_bf16 v[116:119], a[132:135], v[144:147], v[116:119]
    ds_read_b64_tr_b16 a[252:253], v23 offset:28672
    ds_read_b64_tr_b16 a[254:255], v23 offset:30720
    v_mfma_f32_16x16x32_bf16 v[124:127], a[132:135], v[152:155], v[124:127]
    v_cvt_pk_bf16_f32 v149, v82, v83
    v_cvt_pk_bf16_f32 v150, v84, v85
    v_mfma_f32_16x16x32_bf16 v[116:119], a[136:139], v[160:163], v[116:119]
    ds_read_b64_tr_b16 a[112:113], v24 offset:16384
    ds_read_b64_tr_b16 a[114:115], v24 offset:18432
    v_mfma_f32_16x16x32_bf16 v[124:127], a[136:139], v[168:171], v[124:127]
    v_cvt_pk_bf16_f32 v151, v86, v87
    v_mul_f32 v88, v88, v44
    v_mul_f32 v89, v89, v44
    v_mfma_f32_16x16x32_bf16 v[116:119], a[140:143], v[176:179], v[116:119]
    ds_read_b64_tr_b16 a[116:117], v24 offset:20480
    ds_read_b64_tr_b16 a[118:119], v24 offset:22528
    v_mfma_f32_16x16x32_bf16 v[124:127], a[140:143], v[184:187], v[124:127]
    v_mul_f32 v90, v90, v44
    s_waitcnt lgkmcnt(12)
    v_mfma_f32_16x16x32_bf16 v[96:99], a[224:227], v[192:195], v[96:99]
    ds_read_b64_tr_b16 a[120:121], v24 offset:24576
    ds_read_b64_tr_b16 a[122:123], v24 offset:26624
    v_mfma_f32_16x16x32_bf16 v[104:107], a[224:227], v[200:203], v[104:107]
    s_add_u32 m0, s48, 114688
    s_add_u32 s60, s51, 114688
    buffer_load_dwordx4 v30, s[20:23], s60 offen  lds
    v_mfma_f32_16x16x32_bf16 v[96:99], a[228:231], v[208:211], v[96:99]
    ds_read_b64_tr_b16 a[124:125], v24 offset:28672
    ds_read_b64_tr_b16 a[126:127], v24 offset:30720
    v_mfma_f32_16x16x32_bf16 v[104:107], a[228:231], v[216:219], v[104:107]
    v_mul_f32 v91, v91, v44
    buffer_load_dwordx4 v31, s[20:23], s60 offen offset:1024  lds
    v_mfma_f32_16x16x32_bf16 v[96:99], a[232:235], v[224:227], v[96:99]
    ds_read_b64_tr_b16 a[128:129], v25 offset:16384
    ds_read_b64_tr_b16 a[130:131], v25 offset:18432
    v_mfma_f32_16x16x32_bf16 v[104:107], a[232:235], v[232:235], v[104:107]
    v_mul_f32 v92, v92, v44
    v_mul_f32 v93, v93, v44
    buffer_load_dwordx4 v32, s[20:23], s60 offen offset:2048  lds
    v_mfma_f32_16x16x32_bf16 v[96:99], a[236:239], v[240:243], v[96:99]
    buffer_load_dwordx4 v33, s[20:23], s60 offen offset:3072  lds
    s_add_u32 s51, s51, 128
    s_cmp_eq_u32 s51, 896
    s_cselect_b32 s51, 0, s51
    v_mfma_f32_16x16x32_bf16 v[104:107], a[236:239], v[248:251], v[104:107]
    ds_read_b64_tr_b16 a[132:133], v25 offset:20480
    ds_read_b64_tr_b16 a[134:135], v25 offset:22528
    s_waitcnt lgkmcnt(12)
    v_mfma_f32_16x16x32_bf16 v[100:103], a[240:243], v[192:195], v[100:103]
    ds_read_b64_tr_b16 a[136:137], v25 offset:24576
    ds_read_b64_tr_b16 a[138:139], v25 offset:26624
    v_mfma_f32_16x16x32_bf16 v[108:111], a[240:243], v[200:203], v[108:111]
    v_mul_f32 v94, v94, v44
    v_mul_f32 v95, v95, v44
    v_mfma_f32_16x16x32_bf16 v[100:103], a[244:247], v[208:211], v[100:103]
    ds_read_b64_tr_b16 a[140:141], v25 offset:28672
    ds_read_b64_tr_b16 a[142:143], v25 offset:30720
    v_mfma_f32_16x16x32_bf16 v[108:111], a[244:247], v[216:219], v[108:111]
    v_cvt_pk_bf16_f32 v156, v88, v89
    v_cvt_pk_bf16_f32 v157, v90, v91
    v_cvt_pk_bf16_f32 v158, v92, v93
    v_mfma_f32_16x16x32_bf16 v[100:103], a[248:251], v[224:227], v[100:103]
    s_waitcnt vmcnt(21)
    s_barrier
    ds_read_b64_tr_b16 a[224:225], v22 offset:32768
    ds_read_b64_tr_b16 a[226:227], v22 offset:34816
    v_mfma_f32_16x16x32_bf16 v[108:111], a[248:251], v[232:235], v[108:111]
    s_add_u32 s10, s9, 4096
    s_and_b32 s3, s10, 8192
    s_add_u32 s10, s10, s3
    v_mfma_f32_16x16x32_bf16 v[100:103], a[252:255], v[240:243], v[100:103]
    ds_read_b64_tr_b16 a[228:229], v22 offset:36864
    ds_read_b64_tr_b16 a[230:231], v22 offset:38912
    v_mfma_f32_16x16x32_bf16 v[108:111], a[252:255], v[248:251], v[108:111]
    v_cvt_pk_bf16_f32 v159, v94, v95
    s_waitcnt lgkmcnt(12)
    v_mfma_f32_16x16x32_bf16 v[112:115], a[112:115], v[192:195], v[112:115]
    ds_read_b64_tr_b16 a[232:233], v22 offset:40960
    ds_read_b64_tr_b16 a[234:235], v22 offset:43008
    v_mfma_f32_16x16x32_bf16 v[120:123], a[112:115], v[200:203], v[120:123]
    s_cmp_eq_u32 s10, 53248
    s_cselect_b32 s10, 0, s10
    v_mfma_f32_16x16x32_bf16 v[112:115], a[116:119], v[208:211], v[112:115]
    ds_read_b64_tr_b16 a[236:237], v22 offset:45056
    ds_read_b64_tr_b16 a[238:239], v22 offset:47104
    v_mfma_f32_16x16x32_bf16 v[120:123], a[116:119], v[216:219], v[120:123]
    v_mul_f32 v96, v96, v43
    v_mul_f32 v97, v97, v43
    buffer_store_dwordx4 v[132:135], v34, s[28:31], s56 offen sc1
    v_mfma_f32_16x16x32_bf16 v[112:115], a[120:123], v[224:227], v[112:115]
    ds_read_b64_tr_b16 a[240:241], v23 offset:32768
    ds_read_b64_tr_b16 a[242:243], v23 offset:34816
    v_mfma_f32_16x16x32_bf16 v[120:123], a[120:123], v[232:235], v[120:123]
    v_mul_f32 v98, v98, v43
    v_mul_f32 v99, v99, v43
    v_mfma_f32_16x16x32_bf16 v[112:115], a[124:127], v[240:243], v[112:115]
    ds_read_b64_tr_b16 a[244:245], v23 offset:36864
    ds_read_b64_tr_b16 a[246:247], v23 offset:38912
    v_mfma_f32_16x16x32_bf16 v[120:123], a[124:127], v[248:251], v[120:123]
    v_mul_f32 v100, v100, v43
    v_mul_f32 v101, v101, v43
    s_waitcnt lgkmcnt(12)
    v_mfma_f32_16x16x32_bf16 v[116:119], a[128:131], v[192:195], v[116:119]
    ds_read_b64_tr_b16 a[248:249], v23 offset:40960
    ds_read_b64_tr_b16 a[250:251], v23 offset:43008
    v_mfma_f32_16x16x32_bf16 v[124:127], a[128:131], v[200:203], v[124:127]
    v_mul_f32 v102, v102, v43
    v_mul_f32 v103, v103, v43
    v_mfma_f32_16x16x32_bf16 v[116:119], a[132:135], v[208:211], v[116:119]
    ds_read_b64_tr_b16 a[252:253], v23 offset:45056
    ds_read_b64_tr_b16 a[254:255], v23 offset:47104
    v_mfma_f32_16x16x32_bf16 v[124:127], a[132:135], v[216:219], v[124:127]
    v_cvt_pk_bf16_f32 v96, v96, v97
    v_cvt_pk_bf16_f32 v97, v98, v99
    v_cvt_pk_bf16_f32 v98, v100, v101
    v_mfma_f32_16x16x32_bf16 v[116:119], a[136:139], v[224:227], v[116:119]
    ds_read_b64_tr_b16 a[112:113], v24 offset:32768
    ds_read_b64_tr_b16 a[114:115], v24 offset:34816
    v_mfma_f32_16x16x32_bf16 v[124:127], a[136:139], v[232:235], v[124:127]
    v_cvt_pk_bf16_f32 v99, v102, v103
    buffer_store_dwordx4 v[96:99], v34, s[28:31], s9 offen sc1
    v_mfma_f32_16x16x32_bf16 v[116:119], a[140:143], v[240:243], v[116:119]
    ds_read_b64_tr_b16 a[116:117], v24 offset:36864
    ds_read_b64_tr_b16 a[118:119], v24 offset:38912
    v_mfma_f32_16x16x32_bf16 v[124:127], a[140:143], v[248:251], v[124:127]
    v_mul_f32 v104, v104, v44
    v_mul_f32 v105, v105, v44
    s_waitcnt lgkmcnt(12)
    v_mfma_f32_16x16x32_bf16 v[64:67], a[224:227], v[128:131], 0
    ds_read_b64_tr_b16 a[120:121], v24 offset:40960
    ds_read_b64_tr_b16 a[122:123], v24 offset:43008
    v_mfma_f32_16x16x32_bf16 v[72:75], a[224:227], v[136:139], 0
    s_add_u32 m0, s48, 0
    s_nop 0
    buffer_load_dwordx4 v30, s[20:23], s51 offen  lds
    v_mfma_f32_16x16x32_bf16 v[64:67], a[228:231], v[144:147], v[64:67]
    ds_read_b64_tr_b16 a[124:125], v24 offset:45056
    ds_read_b64_tr_b16 a[126:127], v24 offset:47104
    v_mfma_f32_16x16x32_bf16 v[72:75], a[228:231], v[152:155], v[72:75]
    v_mul_f32 v106, v106, v44
    buffer_store_dwordx4 v[140:143], v34, s[28:31], s56 offen offset:1024 sc1
    buffer_load_dwordx4 v31, s[20:23], s51 offen offset:1024  lds
    v_mfma_f32_16x16x32_bf16 v[64:67], a[232:235], v[160:163], v[64:67]
    ds_read_b64_tr_b16 a[128:129], v25 offset:32768
    ds_read_b64_tr_b16 a[130:131], v25 offset:34816
    v_mfma_f32_16x16x32_bf16 v[72:75], a[232:235], v[168:171], v[72:75]
    v_mul_f32 v107, v107, v44
    buffer_load_dwordx4 v32, s[20:23], s51 offen offset:2048  lds
    v_mfma_f32_16x16x32_bf16 v[64:67], a[236:239], v[176:179], v[64:67]
    ds_read_b64_tr_b16 a[132:133], v25 offset:36864
    ds_read_b64_tr_b16 a[134:135], v25 offset:38912
    v_mfma_f32_16x16x32_bf16 v[72:75], a[236:239], v[184:187], v[72:75]
    v_mul_f32 v108, v108, v44
    buffer_load_dwordx4 v33, s[20:23], s51 offen offset:3072  lds
    s_waitcnt lgkmcnt(12)
    v_mfma_f32_16x16x32_bf16 v[68:71], a[240:243], v[128:131], 0
    ds_read_b64_tr_b16 a[136:137], v25 offset:40960
    ds_read_b64_tr_b16 a[138:139], v25 offset:43008
    v_mfma_f32_16x16x32_bf16 v[76:79], a[240:243], v[136:139], 0
    v_mul_f32 v109, v109, v44
    v_mul_f32 v110, v110, v44
    v_mfma_f32_16x16x32_bf16 v[68:71], a[244:247], v[144:147], v[68:71]
    ds_read_b64_tr_b16 a[140:141], v25 offset:45056
    ds_read_b64_tr_b16 a[142:143], v25 offset:47104
    v_mfma_f32_16x16x32_bf16 v[76:79], a[244:247], v[152:155], v[76:79]
    v_mul_f32 v111, v111, v44
    v_cvt_pk_bf16_f32 v104, v104, v105
    v_cvt_pk_bf16_f32 v105, v106, v107
    v_mfma_f32_16x16x32_bf16 v[68:71], a[248:251], v[160:163], v[68:71]
    s_waitcnt vmcnt(24)
    s_barrier
    v_mfma_f32_16x16x32_bf16 v[76:79], a[248:251], v[168:171], v[76:79]
    ds_read_b64_tr_b16 a[224:225], v22 offset:49152
    ds_read_b64_tr_b16 a[226:227], v22 offset:51200
    v_mfma_f32_16x16x32_bf16 v[68:71], a[252:255], v[176:179], v[68:71]
    ds_read_b64_tr_b16 a[228:229], v22 offset:53248
    ds_read_b64_tr_b16 a[230:231], v22 offset:55296
    v_mfma_f32_16x16x32_bf16 v[76:79], a[252:255], v[184:187], v[76:79]
    v_cvt_pk_bf16_f32 v106, v108, v109
    v_cvt_pk_bf16_f32 v107, v110, v111
    s_waitcnt lgkmcnt(12)
    v_mfma_f32_16x16x32_bf16 v[80:83], a[112:115], v[128:131], 0
    ds_read_b64_tr_b16 a[232:233], v22 offset:57344
    ds_read_b64_tr_b16 a[234:235], v22 offset:59392
    v_mfma_f32_16x16x32_bf16 v[88:91], a[112:115], v[136:139], 0
    buffer_store_dwordx4 v[104:107], v34, s[28:31], s9 offen offset:1024 sc1
    buffer_store_dwordx4 v[148:151], v34, s[28:31], s56 offen offset:2048 sc1
    v_mfma_f32_16x16x32_bf16 v[80:83], a[116:119], v[144:147], v[80:83]
    ds_read_b64_tr_b16 a[236:237], v22 offset:61440
    ds_read_b64_tr_b16 a[238:239], v22 offset:63488
    v_mfma_f32_16x16x32_bf16 v[88:91], a[116:119], v[152:155], v[88:91]
    v_mul_f32 v112, v112, v43
    v_mul_f32 v113, v113, v43
    v_mul_f32 v114, v114, v43
    v_mfma_f32_16x16x32_bf16 v[80:83], a[120:123], v[160:163], v[80:83]
    ds_read_b64_tr_b16 a[240:241], v23 offset:49152
    ds_read_b64_tr_b16 a[242:243], v23 offset:51200
    v_mfma_f32_16x16x32_bf16 v[88:91], a[120:123], v[168:171], v[88:91]
    v_mul_f32 v115, v115, v43
    v_mul_f32 v116, v116, v43
    v_mfma_f32_16x16x32_bf16 v[80:83], a[124:127], v[176:179], v[80:83]
    ds_read_b64_tr_b16 a[244:245], v23 offset:53248
    ds_read_b64_tr_b16 a[246:247], v23 offset:55296
    v_mfma_f32_16x16x32_bf16 v[88:91], a[124:127], v[184:187], v[88:91]
    v_mul_f32 v117, v117, v43
    v_mul_f32 v118, v118, v43
    s_waitcnt lgkmcnt(12)
    v_mfma_f32_16x16x32_bf16 v[84:87], a[128:131], v[128:131], 0
    ds_read_b64_tr_b16 a[248:249], v23 offset:57344
    ds_read_b64_tr_b16 a[250:251], v23 offset:59392
    v_mfma_f32_16x16x32_bf16 v[92:95], a[128:131], v[136:139], 0
    v_mul_f32 v119, v119, v43
    v_cvt_pk_bf16_f32 v112, v112, v113
    v_cvt_pk_bf16_f32 v113, v114, v115
    v_mfma_f32_16x16x32_bf16 v[84:87], a[132:135], v[144:147], v[84:87]
    ds_read_b64_tr_b16 a[252:253], v23 offset:61440
    ds_read_b64_tr_b16 a[254:255], v23 offset:63488
    v_mfma_f32_16x16x32_bf16 v[92:95], a[132:135], v[152:155], v[92:95]
    v_cvt_pk_bf16_f32 v114, v116, v117
    v_cvt_pk_bf16_f32 v115, v118, v119
    v_mfma_f32_16x16x32_bf16 v[84:87], a[136:139], v[160:163], v[84:87]
    ds_read_b64_tr_b16 a[112:113], v24 offset:49152
    ds_read_b64_tr_b16 a[114:115], v24 offset:51200
    v_mfma_f32_16x16x32_bf16 v[92:95], a[136:139], v[168:171], v[92:95]
    buffer_store_dwordx4 v[112:115], v34, s[28:31], s9 offen offset:2048 sc1
    v_mul_f32 v120, v120, v44
    v_mul_f32 v121, v121, v44
    v_mfma_f32_16x16x32_bf16 v[84:87], a[140:143], v[176:179], v[84:87]
    ds_read_b64_tr_b16 a[116:117], v24 offset:53248
    ds_read_b64_tr_b16 a[118:119], v24 offset:55296
    v_mfma_f32_16x16x32_bf16 v[92:95], a[140:143], v[184:187], v[92:95]
    v_mul_f32 v122, v122, v44
    v_mul_f32 v123, v123, v44
    s_waitcnt lgkmcnt(12)
    v_mfma_f32_16x16x32_bf16 v[64:67], a[224:227], v[192:195], v[64:67]
    ds_read_b64_tr_b16 a[120:121], v24 offset:57344
    ds_read_b64_tr_b16 a[122:123], v24 offset:59392
    buffer_store_dwordx4 v[156:159], v34, s[28:31], s56 offen offset:3072 sc1
    v_mfma_f32_16x16x32_bf16 v[72:75], a[224:227], v[200:203], v[72:75]
    s_add_u32 m0, s48, 16384
    s_add_u32 s60, s51, 114688
    buffer_load_dwordx4 v30, s[20:23], s60 offen  lds
    v_mfma_f32_16x16x32_bf16 v[64:67], a[228:231], v[208:211], v[64:67]
    ds_read_b64_tr_b16 a[124:125], v24 offset:61440
    ds_read_b64_tr_b16 a[126:127], v24 offset:63488
    v_mfma_f32_16x16x32_bf16 v[72:75], a[228:231], v[216:219], v[72:75]
    v_mul_f32 v124, v124, v44
    buffer_load_dwordx4 v31, s[20:23], s60 offen offset:1024  lds
    v_mfma_f32_16x16x32_bf16 v[64:67], a[232:235], v[224:227], v[64:67]
    ds_read_b64_tr_b16 a[128:129], v25 offset:49152
    ds_read_b64_tr_b16 a[130:131], v25 offset:51200
    v_mfma_f32_16x16x32_bf16 v[72:75], a[232:235], v[232:235], v[72:75]
    v_mul_f32 v125, v125, v44
    v_mul_f32 v126, v126, v44
    buffer_load_dwordx4 v32, s[20:23], s60 offen offset:2048  lds
    v_mfma_f32_16x16x32_bf16 v[64:67], a[236:239], v[240:243], v[64:67]
    buffer_load_dwordx4 v33, s[20:23], s60 offen offset:3072  lds
    s_add_u32 s51, s51, 128
    s_cmp_eq_u32 s51, 896
    s_cselect_b32 s51, 0, s51
    v_mfma_f32_16x16x32_bf16 v[72:75], a[236:239], v[248:251], v[72:75]
    ds_read_b64_tr_b16 a[132:133], v25 offset:53248
    ds_read_b64_tr_b16 a[134:135], v25 offset:55296
    s_waitcnt lgkmcnt(12)
    v_mfma_f32_16x16x32_bf16 v[68:71], a[240:243], v[192:195], v[68:71]
    ds_read_b64_tr_b16 a[136:137], v25 offset:57344
    ds_read_b64_tr_b16 a[138:139], v25 offset:59392
    v_mfma_f32_16x16x32_bf16 v[76:79], a[240:243], v[200:203], v[76:79]
    v_mul_f32 v127, v127, v44
    v_cvt_pk_bf16_f32 v120, v120, v121
    v_cvt_pk_bf16_f32 v121, v122, v123
    v_mfma_f32_16x16x32_bf16 v[68:71], a[244:247], v[208:211], v[68:71]
    ds_read_b64_tr_b16 a[140:141], v25 offset:61440
    ds_read_b64_tr_b16 a[142:143], v25 offset:63488
    v_mfma_f32_16x16x32_bf16 v[76:79], a[244:247], v[216:219], v[76:79]
    v_cvt_pk_bf16_f32 v122, v124, v125
    v_cvt_pk_bf16_f32 v123, v126, v127
    v_mfma_f32_16x16x32_bf16 v[68:71], a[248:251], v[224:227], v[68:71]
    s_waitcnt vmcnt(28)
    s_barrier
    v_add_u32 v22, 65536, v22
    ds_read_b64_tr_b16 a[224:225], v22 offset:0
    ds_read_b64_tr_b16 a[226:227], v22 offset:2048
    v_mfma_f32_16x16x32_bf16 v[76:79], a[248:251], v[232:235], v[76:79]
    v_add_u32 v23, 65536, v23
    s_add_u32 s11, s10, 4096
    s_and_b32 s3, s11, 8192
    s_add_u32 s11, s11, s3
    v_mfma_f32_16x16x32_bf16 v[68:71], a[252:255], v[240:243], v[68:71]
    ds_read_b64_tr_b16 a[228:229], v22 offset:4096
    ds_read_b64_tr_b16 a[230:231], v22 offset:6144
    v_add_u32 v24, 65536, v24
    v_mfma_f32_16x16x32_bf16 v[76:79], a[252:255], v[248:251], v[76:79]
    buffer_store_dwordx4 v[120:123], v34, s[28:31], s9 offen offset:3072 sc1
    s_waitcnt lgkmcnt(12)
    v_mfma_f32_16x16x32_bf16 v[80:83], a[112:115], v[192:195], v[80:83]
    ds_read_b64_tr_b16 a[232:233], v22 offset:8192
    ds_read_b64_tr_b16 a[234:235], v22 offset:10240
    v_add_u32 v25, 65536, v25
    v_mfma_f32_16x16x32_bf16 v[88:91], a[112:115], v[200:203], v[88:91]
    s_cmp_eq_u32 s11, 53248
    s_cselect_b32 s11, 0, s11
    v_mfma_f32_16x16x32_bf16 v[80:83], a[116:119], v[208:211], v[80:83]
    ds_read_b64_tr_b16 a[236:237], v22 offset:12288
    ds_read_b64_tr_b16 a[238:239], v22 offset:14336
    v_mfma_f32_16x16x32_bf16 v[88:91], a[116:119], v[216:219], v[88:91]
    v_mul_f32 v64, v64, v43
    v_mul_f32 v65, v65, v43
    v_mfma_f32_16x16x32_bf16 v[80:83], a[120:123], v[224:227], v[80:83]
    ds_read_b64_tr_b16 a[240:241], v23 offset:0
    ds_read_b64_tr_b16 a[242:243], v23 offset:2048
    v_mfma_f32_16x16x32_bf16 v[88:91], a[120:123], v[232:235], v[88:91]
    v_mul_f32 v66, v66, v43
    v_mul_f32 v67, v67, v43
    v_mul_f32 v68, v68, v43
    v_mfma_f32_16x16x32_bf16 v[80:83], a[124:127], v[240:243], v[80:83]
    ds_read_b64_tr_b16 a[244:245], v23 offset:4096
    ds_read_b64_tr_b16 a[246:247], v23 offset:6144
    v_mfma_f32_16x16x32_bf16 v[88:91], a[124:127], v[248:251], v[88:91]
    v_mul_f32 v69, v69, v43
    s_waitcnt lgkmcnt(12)
    v_mfma_f32_16x16x32_bf16 v[84:87], a[128:131], v[192:195], v[84:87]
    ds_read_b64_tr_b16 a[248:249], v23 offset:8192
    ds_read_b64_tr_b16 a[250:251], v23 offset:10240
    v_mfma_f32_16x16x32_bf16 v[92:95], a[128:131], v[200:203], v[92:95]
    v_mul_f32 v70, v70, v43
    v_mul_f32 v71, v71, v43
    v_mfma_f32_16x16x32_bf16 v[84:87], a[132:135], v[208:211], v[84:87]
    ds_read_b64_tr_b16 a[252:253], v23 offset:12288
    ds_read_b64_tr_b16 a[254:255], v23 offset:14336
    v_mfma_f32_16x16x32_bf16 v[92:95], a[132:135], v[216:219], v[92:95]
    v_cvt_pk_bf16_f32 v64, v64, v65
    v_cvt_pk_bf16_f32 v65, v66, v67
    v_cvt_pk_bf16_f32 v66, v68, v69
    v_mfma_f32_16x16x32_bf16 v[84:87], a[136:139], v[224:227], v[84:87]
    ds_read_b64_tr_b16 a[112:113], v24 offset:0
    ds_read_b64_tr_b16 a[114:115], v24 offset:2048
    v_mfma_f32_16x16x32_bf16 v[92:95], a[136:139], v[232:235], v[92:95]
    v_cvt_pk_bf16_f32 v67, v70, v71
    buffer_store_dwordx4 v[64:67], v34, s[28:31], s10 offen sc1
    v_mfma_f32_16x16x32_bf16 v[84:87], a[140:143], v[240:243], v[84:87]
    ds_read_b64_tr_b16 a[116:117], v24 offset:4096
    ds_read_b64_tr_b16 a[118:119], v24 offset:6144
    v_mfma_f32_16x16x32_bf16 v[92:95], a[140:143], v[248:251], v[92:95]
    v_mul_f32 v72, v72, v44
    s_waitcnt lgkmcnt(12)
    v_mfma_f32_16x16x32_bf16 v[96:99], a[224:227], v[128:131], 0
    ds_read_b64_tr_b16 a[120:121], v24 offset:8192
    ds_read_b64_tr_b16 a[122:123], v24 offset:10240
    v_mfma_f32_16x16x32_bf16 v[104:107], a[224:227], v[136:139], 0
    v_mul_f32 v73, v73, v44
    s_add_u32 m0, s48, 32768
    s_nop 0
    buffer_load_dwordx4 v30, s[20:23], s51 offen  lds
    v_mfma_f32_16x16x32_bf16 v[96:99], a[228:231], v[144:147], v[96:99]
    ds_read_b64_tr_b16 a[124:125], v24 offset:12288
    ds_read_b64_tr_b16 a[126:127], v24 offset:14336
    v_mfma_f32_16x16x32_bf16 v[104:107], a[228:231], v[152:155], v[104:107]
    v_mul_f32 v74, v74, v44
    buffer_load_dwordx4 v31, s[20:23], s51 offen offset:1024  lds
    v_mfma_f32_16x16x32_bf16 v[96:99], a[232:235], v[160:163], v[96:99]
    ds_read_b64_tr_b16 a[128:129], v25 offset:0
    ds_read_b64_tr_b16 a[130:131], v25 offset:2048
    v_mfma_f32_16x16x32_bf16 v[104:107], a[232:235], v[168:171], v[104:107]
    v_mul_f32 v75, v75, v44
    buffer_load_dwordx4 v32, s[20:23], s51 offen offset:2048  lds
    v_mfma_f32_16x16x32_bf16 v[96:99], a[236:239], v[176:179], v[96:99]
    ds_read_b64_tr_b16 a[132:133], v25 offset:4096
    ds_read_b64_tr_b16 a[134:135], v25 offset:6144
    v_mfma_f32_16x16x32_bf16 v[104:107], a[236:239], v[184:187], v[104:107]
    buffer_load_dwordx4 v33, s[20:23], s51 offen offset:3072  lds
    s_waitcnt lgkmcnt(12)
    v_mfma_f32_16x16x32_bf16 v[100:103], a[240:243], v[128:131], 0
    ds_read_b64_tr_b16 a[136:137], v25 offset:8192
    ds_read_b64_tr_b16 a[138:139], v25 offset:10240
    v_mfma_f32_16x16x32_bf16 v[108:111], a[240:243], v[136:139], 0
    v_mul_f32 v76, v76, v44
    v_mul_f32 v77, v77, v44
    v_mul_f32 v78, v78, v44
    v_mfma_f32_16x16x32_bf16 v[100:103], a[244:247], v[144:147], v[100:103]
    ds_read_b64_tr_b16 a[140:141], v25 offset:12288
    ds_read_b64_tr_b16 a[142:143], v25 offset:14336
    v_mfma_f32_16x16x32_bf16 v[108:111], a[244:247], v[152:155], v[108:111]
    v_mul_f32 v79, v79, v44
    v_cvt_pk_bf16_f32 v72, v72, v73
    v_mfma_f32_16x16x32_bf16 v[100:103], a[248:251], v[160:163], v[100:103]
    s_waitcnt vmcnt(29)
    s_barrier
    v_mfma_f32_16x16x32_bf16 v[108:111], a[248:251], v[168:171], v[108:111]
    ds_read_b64_tr_b16 a[224:225], v22 offset:16384
    ds_read_b64_tr_b16 a[226:227], v22 offset:18432
    v_mfma_f32_16x16x32_bf16 v[100:103], a[252:255], v[176:179], v[100:103]
    ds_read_b64_tr_b16 a[228:229], v22 offset:20480
    ds_read_b64_tr_b16 a[230:231], v22 offset:22528
    v_mfma_f32_16x16x32_bf16 v[108:111], a[252:255], v[184:187], v[108:111]
    v_cvt_pk_bf16_f32 v73, v74, v75
    v_cvt_pk_bf16_f32 v74, v76, v77
    s_waitcnt lgkmcnt(12)
    v_mfma_f32_16x16x32_bf16 v[112:115], a[112:115], v[128:131], 0
    ds_read_b64_tr_b16 a[232:233], v22 offset:24576
    ds_read_b64_tr_b16 a[234:235], v22 offset:26624
    v_mfma_f32_16x16x32_bf16 v[120:123], a[112:115], v[136:139], 0
    v_cvt_pk_bf16_f32 v75, v78, v79
    buffer_store_dwordx4 v[72:75], v34, s[28:31], s10 offen offset:1024 sc1
    v_mfma_f32_16x16x32_bf16 v[112:115], a[116:119], v[144:147], v[112:115]
    ds_read_b64_tr_b16 a[236:237], v22 offset:28672
    ds_read_b64_tr_b16 a[238:239], v22 offset:30720
    v_mfma_f32_16x16x32_bf16 v[120:123], a[116:119], v[152:155], v[120:123]
    v_mul_f32 v80, v80, v43
    v_mul_f32 v81, v81, v43
    v_mul_f32 v82, v82, v43
    v_mfma_f32_16x16x32_bf16 v[112:115], a[120:123], v[160:163], v[112:115]
    ds_read_b64_tr_b16 a[240:241], v23 offset:16384
    ds_read_b64_tr_b16 a[242:243], v23 offset:18432
    v_mfma_f32_16x16x32_bf16 v[120:123], a[120:123], v[168:171], v[120:123]
    v_mul_f32 v83, v83, v43
    v_mul_f32 v84, v84, v43
    v_mfma_f32_16x16x32_bf16 v[112:115], a[124:127], v[176:179], v[112:115]
    ds_read_b64_tr_b16 a[244:245], v23 offset:20480
    ds_read_b64_tr_b16 a[246:247], v23 offset:22528
    v_mfma_f32_16x16x32_bf16 v[120:123], a[124:127], v[184:187], v[120:123]
    v_mul_f32 v85, v85, v43
    v_mul_f32 v86, v86, v43
    s_waitcnt lgkmcnt(12)
    v_mfma_f32_16x16x32_bf16 v[116:119], a[128:131], v[128:131], 0
    ds_read_b64_tr_b16 a[248:249], v23 offset:24576
    ds_read_b64_tr_b16 a[250:251], v23 offset:26624
    v_mfma_f32_16x16x32_bf16 v[124:127], a[128:131], v[136:139], 0
    v_mul_f32 v87, v87, v43
    v_cvt_pk_bf16_f32 v80, v80, v81
    v_mfma_f32_16x16x32_bf16 v[116:119], a[132:135], v[144:147], v[116:119]
    ds_read_b64_tr_b16 a[252:253], v23 offset:28672
    ds_read_b64_tr_b16 a[254:255], v23 offset:30720
    v_mfma_f32_16x16x32_bf16 v[124:127], a[132:135], v[152:155], v[124:127]
    v_cvt_pk_bf16_f32 v81, v82, v83
    v_cvt_pk_bf16_f32 v82, v84, v85
    v_cvt_pk_bf16_f32 v83, v86, v87
    v_mfma_f32_16x16x32_bf16 v[116:119], a[136:139], v[160:163], v[116:119]
    ds_read_b64_tr_b16 a[112:113], v24 offset:16384
    ds_read_b64_tr_b16 a[114:115], v24 offset:18432
    v_mfma_f32_16x16x32_bf16 v[124:127], a[136:139], v[168:171], v[124:127]
    buffer_store_dwordx4 v[80:83], v34, s[28:31], s10 offen offset:2048 sc1
    v_mul_f32 v88, v88, v44
    v_mfma_f32_16x16x32_bf16 v[116:119], a[140:143], v[176:179], v[116:119]
    ds_read_b64_tr_b16 a[116:117], v24 offset:20480
    ds_read_b64_tr_b16 a[118:119], v24 offset:22528
    v_mfma_f32_16x16x32_bf16 v[124:127], a[140:143], v[184:187], v[124:127]
    v_mul_f32 v89, v89, v44
    v_mul_f32 v90, v90, v44
    s_waitcnt lgkmcnt(12)
    v_mfma_f32_16x16x32_bf16 v[96:99], a[224:227], v[192:195], v[96:99]
    ds_read_b64_tr_b16 a[120:121], v24 offset:24576
    ds_read_b64_tr_b16 a[122:123], v24 offset:26624
    v_mfma_f32_16x16x32_bf16 v[104:107], a[224:227], v[200:203], v[104:107]
    s_add_u32 m0, s48, 49152
    s_add_u32 s60, s51, 114688
    buffer_load_dwordx4 v30, s[20:23], s60 offen  lds
    v_mfma_f32_16x16x32_bf16 v[96:99], a[228:231], v[208:211], v[96:99]
    ds_read_b64_tr_b16 a[124:125], v24 offset:28672
    ds_read_b64_tr_b16 a[126:127], v24 offset:30720
    v_mfma_f32_16x16x32_bf16 v[104:107], a[228:231], v[216:219], v[104:107]
    v_mul_f32 v91, v91, v44
    buffer_load_dwordx4 v31, s[20:23], s60 offen offset:1024  lds
    v_mfma_f32_16x16x32_bf16 v[96:99], a[232:235], v[224:227], v[96:99]
    ds_read_b64_tr_b16 a[128:129], v25 offset:16384
    ds_read_b64_tr_b16 a[130:131], v25 offset:18432
    v_mfma_f32_16x16x32_bf16 v[104:107], a[232:235], v[232:235], v[104:107]
    v_mul_f32 v92, v92, v44
    v_mul_f32 v93, v93, v44
    buffer_load_dwordx4 v32, s[20:23], s60 offen offset:2048  lds
    v_mfma_f32_16x16x32_bf16 v[96:99], a[236:239], v[240:243], v[96:99]
    ds_read_b64_tr_b16 a[132:133], v25 offset:20480
    ds_read_b64_tr_b16 a[134:135], v25 offset:22528
    v_mfma_f32_16x16x32_bf16 v[104:107], a[236:239], v[248:251], v[104:107]
    buffer_load_dwordx4 v33, s[20:23], s60 offen offset:3072  lds
    s_waitcnt lgkmcnt(12)
    v_mfma_f32_16x16x32_bf16 v[100:103], a[240:243], v[192:195], v[100:103]
    ds_read_b64_tr_b16 a[136:137], v25 offset:24576
    ds_read_b64_tr_b16 a[138:139], v25 offset:26624
    v_mfma_f32_16x16x32_bf16 v[108:111], a[240:243], v[200:203], v[108:111]
    v_mul_f32 v94, v94, v44
    v_mul_f32 v95, v95, v44
    v_cvt_pk_bf16_f32 v88, v88, v89
    v_mfma_f32_16x16x32_bf16 v[100:103], a[244:247], v[208:211], v[100:103]
    ds_read_b64_tr_b16 a[140:141], v25 offset:28672
    ds_read_b64_tr_b16 a[142:143], v25 offset:30720
    v_mfma_f32_16x16x32_bf16 v[108:111], a[244:247], v[216:219], v[108:111]
    v_cvt_pk_bf16_f32 v89, v90, v91
    v_cvt_pk_bf16_f32 v90, v92, v93
    v_mfma_f32_16x16x32_bf16 v[100:103], a[248:251], v[224:227], v[100:103]
    s_waitcnt vmcnt(31)
    s_barrier
    ds_read_b64_tr_b16 a[224:225], v22 offset:32768
    ds_read_b64_tr_b16 a[226:227], v22 offset:34816
    v_mfma_f32_16x16x32_bf16 v[108:111], a[248:251], v[232:235], v[108:111]
    s_add_u32 s12, s11, 4096
    s_and_b32 s3, s12, 8192
    s_add_u32 s12, s12, s3
    v_mfma_f32_16x16x32_bf16 v[100:103], a[252:255], v[240:243], v[100:103]
    ds_read_b64_tr_b16 a[228:229], v22 offset:36864
L_pg10:
    s_cbranch_execz L_pgr9
    ds_read_b64_tr_b16 a[230:231], v22 offset:38912
    v_mfma_f32_16x16x32_bf16 v[108:111], a[252:255], v[248:251], v[108:111]
    v_cvt_pk_bf16_f32 v91, v94, v95
    buffer_store_dwordx4 v[88:91], v34, s[28:31], s10 offen offset:3072 sc1
    s_waitcnt lgkmcnt(12)
    v_mfma_f32_16x16x32_bf16 v[112:115], a[112:115], v[192:195], v[112:115]
    ds_read_b64_tr_b16 a[232:233], v22 offset:40960
    ds_read_b64_tr_b16 a[234:235], v22 offset:43008
    v_mfma_f32_16x16x32_bf16 v[120:123], a[112:115], v[200:203], v[120:123]
    s_cmp_eq_u32 s12, 53248
    s_cselect_b32 s12, 0, s12
    v_mfma_f32_16x16x32_bf16 v[112:115], a[116:119], v[208:211], v[112:115]
    ds_read_b64_tr_b16 a[236:237], v22 offset:45056
    ds_read_b64_tr_b16 a[238:239], v22 offset:47104
    v_mfma_f32_16x16x32_bf16 v[120:123], a[116:119], v[216:219], v[120:123]
    s_waitcnt vmcnt(12)
    v_or_b32 v50, 3, v51
    s_cmp_lg_u32 s100, s101
    s_cbranch_scc1 L_far0
    buffer_store_byte v50, v45, s[32:35], 0 offen
L_bk0:
    v_mfma_f32_16x16x32_bf16 v[112:115], a[120:123], v[224:227], v[112:115]
    ds_read_b64_tr_b16 a[240:241], v23 offset:32768
    ds_read_b64_tr_b16 a[242:243], v23 offset:34816
    v_mfma_f32_16x16x32_bf16 v[120:123], a[120:123], v[232:235], v[120:123]
    v_mul_f32 v96, v96, v43
    v_mul_f32 v97, v97, v43
    v_mfma_f32_16x16x32_bf16 v[112:115], a[124:127], v[240:243], v[112:115]
    ds_read_b64_tr_b16 a[244:245], v23 offset:36864
    ds_read_b64_tr_b16 a[246:247], v23 offset:38912
    v_mfma_f32_16x16x32_bf16 v[120:123], a[124:127], v[248:251], v[120:123]
    v_mul_f32 v98, v98, v43
    v_mul_f32 v99, v99, v43
    s_waitcnt lgkmcnt(12)
    v_mfma_f32_16x16x32_bf16 v[116:119], a[128:131], v[192:195], v[116:119]
    ds_read_b64_tr_b16 a[248:249], v23 offset:40960
    ds_read_b64_tr_b16 a[250:251], v23 offset:43008
    v_mfma_f32_16x16x32_bf16 v[124:127], a[128:131], v[200:203], v[124:127]
    v_mul_f32 v100, v100, v43
    v_mul_f32 v101, v101, v43
    v_mfma_f32_16x16x32_bf16 v[116:119], a[132:135], v[208:211], v[116:119]
    ds_read_b64_tr_b16 a[252:253], v23 offset:45056
    ds_read_b64_tr_b16 a[254:255], v23 offset:47104
    v_mfma_f32_16x16x32_bf16 v[124:127], a[132:135], v[216:219], v[124:127]
    v_mul_f32 v102, v102, v43
    v_mul_f32 v103, v103, v43
    v_mfma_f32_16x16x32_bf16 v[116:119], a[136:139], v[224:227], v[116:119]
    ds_read_b64_tr_b16 a[112:113], v24 offset:32768
    ds_read_b64_tr_b16 a[114:115], v24 offset:34816
    v_mfma_f32_16x16x32_bf16 v[124:127], a[136:139], v[232:235], v[124:127]
    v_cvt_pk_bf16_f32 v96, v96, v97
    v_cvt_pk_bf16_f32 v97, v98, v99
    v_mfma_f32_16x16x32_bf16 v[116:119], a[140:143], v[240:243], v[116:119]
    ds_read_b64_tr_b16 a[116:117], v24 offset:36864
    ds_read_b64_tr_b16 a[118:119], v24 offset:38912
    v_mfma_f32_16x16x32_bf16 v[124:127], a[140:143], v[248:251], v[124:127]
    v_cvt_pk_bf16_f32 v98, v100, v101
    s_waitcnt lgkmcnt(12)
    v_mfma_f32_16x16x32_bf16 v[64:67], a[224:227], v[128:131], 0
    ds_read_b64_tr_b16 a[120:121], v24 offset:40960
    ds_read_b64_tr_b16 a[122:123], v24 offset:43008
    v_mfma_f32_16x16x32_bf16 v[72:75], a[224:227], v[136:139], 0
    v_cvt_pk_bf16_f32 v99, v102, v103
    buffer_store_dwordx4 v[96:99], v34, s[28:31], s11 offen sc1
    v_mul_f32 v104, v104, v44
    v_mfma_f32_16x16x32_bf16 v[64:67], a[228:231], v[144:147], v[64:67]
    ds_read_b64_tr_b16 a[124:125], v24 offset:45056
    ds_read_b64_tr_b16 a[126:127], v24 offset:47104
    v_mfma_f32_16x16x32_bf16 v[72:75], a[228:231], v[152:155], v[72:75]
    v_mul_f32 v105, v105, v44
    v_mul_f32 v106, v106, v44
    v_mfma_f32_16x16x32_bf16 v[64:67], a[232:235], v[160:163], v[64:67]
    ds_read_b64_tr_b16 a[128:129], v25 offset:32768
    ds_read_b64_tr_b16 a[130:131], v25 offset:34816
    v_mfma_f32_16x16x32_bf16 v[72:75], a[232:235], v[168:171], v[72:75]
    v_mul_f32 v107, v107, v44
    s_mov_b32 s79, 0
    v_mfma_f32_16x16x32_bf16 v[64:67], a[236:239], v[176:179], v[64:67]
    ds_read_b64_tr_b16 a[132:133], v25 offset:36864
    ds_read_b64_tr_b16 a[134:135], v25 offset:38912
    v_mfma_f32_16x16x32_bf16 v[72:75], a[236:239], v[184:187], v[72:75]
    v_mul_f32 v108, v108, v44
    s_waitcnt lgkmcnt(12)
    v_mfma_f32_16x16x32_bf16 v[68:71], a[240:243], v[128:131], 0
    ds_read_b64_tr_b16 a[136:137], v25 offset:40960
    ds_read_b64_tr_b16 a[138:139], v25 offset:43008
    v_mfma_f32_16x16x32_bf16 v[76:79], a[240:243], v[136:139], 0
    v_mul_f32 v109, v109, v44
    v_mul_f32 v110, v110, v44
    s_mov_b32 s8, s56
    v_mfma_f32_16x16x32_bf16 v[68:71], a[244:247], v[144:147], v[68:71]
    ds_read_b64_tr_b16 a[140:141], v25 offset:45056
    ds_read_b64_tr_b16 a[142:143], v25 offset:47104
    v_mfma_f32_16x16x32_bf16 v[76:79], a[244:247], v[152:155], v[76:79]
    v_mul_f32 v111, v111, v44
    v_cvt_pk_bf16_f32 v104, v104, v105
    v_mfma_f32_16x16x32_bf16 v[68:71], a[248:251], v[160:163], v[68:71]
    s_barrier
    ds_read_b64_tr_b16 a[224:225], v22 offset:49152
    v_mfma_f32_16x16x32_bf16 v[76:79], a[248:251], v[168:171], v[76:79]
    ds_read_b64_tr_b16 a[226:227], v22 offset:51200
    v_cvt_pk_bf16_f32 v105, v106, v107
    v_mfma_f32_16x16x32_bf16 v[68:71], a[252:255], v[176:179], v[68:71]
    ds_read_b64_tr_b16 a[228:229], v22 offset:53248
    ds_read_b64_tr_b16 a[230:231], v22 offset:55296
    v_mfma_f32_16x16x32_bf16 v[76:79], a[252:255], v[184:187], v[76:79]
    v_cvt_pk_bf16_f32 v106, v108, v109
    s_waitcnt lgkmcnt(12)
    v_mfma_f32_16x16x32_bf16 v[80:83], a[112:115], v[128:131], 0
    ds_read_b64_tr_b16 a[232:233], v22 offset:57344
    ds_read_b64_tr_b16 a[234:235], v22 offset:59392
    v_mfma_f32_16x16x32_bf16 v[88:91], a[112:115], v[136:139], 0
    v_cvt_pk_bf16_f32 v107, v110, v111
    buffer_store_dwordx4 v[104:107], v34, s[28:31], s11 offen offset:1024 sc1
    v_mfma_f32_16x16x32_bf16 v[80:83], a[116:119], v[144:147], v[80:83]
    ds_read_b64_tr_b16 a[236:237], v22 offset:61440
    ds_read_b64_tr_b16 a[238:239], v22 offset:63488
    v_mfma_f32_16x16x32_bf16 v[88:91], a[116:119], v[152:155], v[88:91]
    v_mul_f32 v112, v112, v43
    v_mul_f32 v113, v113, v43
    v_mfma_f32_16x16x32_bf16 v[80:83], a[120:123], v[160:163], v[80:83]
    ds_read_b64_tr_b16 a[240:241], v23 offset:49152
    ds_read_b64_tr_b16 a[242:243], v23 offset:51200
    v_mfma_f32_16x16x32_bf16 v[88:91], a[120:123], v[168:171], v[88:91]
    v_mul_f32 v114, v114, v43
    v_mul_f32 v115, v115, v43
    v_mfma_f32_16x16x32_bf16 v[80:83], a[124:127], v[176:179], v[80:83]
    ds_read_b64_tr_b16 a[244:245], v23 offset:53248
    ds_read_b64_tr_b16 a[246:247], v23 offset:55296
    v_mfma_f32_16x16x32_bf16 v[88:91], a[124:127], v[184:187], v[88:91]
    v_mul_f32 v116, v116, v43
    v_mul_f32 v117, v117, v43
    s_waitcnt lgkmcnt(12)
    v_mfma_f32_16x16x32_bf16 v[84:87], a[128:131], v[128:131], 0
    ds_read_b64_tr_b16 a[248:249], v23 offset:57344
    ds_read_b64_tr_b16 a[250:251], v23 offset:59392
    v_mfma_f32_16x16x32_bf16 v[92:95], a[128:131], v[136:139], 0
    v_mul_f32 v118, v118, v43
    v_mul_f32 v119, v119, v43
    v_add_u32 v11, 262144, v56
    v_mfma_f32_16x16x32_bf16 v[84:87], a[132:135], v[144:147], v[84:87]
    ds_read_b64_tr_b16 a[252:253], v23 offset:61440
    ds_read_b64_tr_b16 a[254:255], v23 offset:63488
    v_mfma_f32_16x16x32_bf16 v[92:95], a[132:135], v[152:155], v[92:95]
    v_cvt_pk_bf16_f32 v112, v112, v113
    v_cvt_pk_bf16_f32 v113, v114, v115
    v_mfma_f32_16x16x32_bf16 v[84:87], a[136:139], v[160:163], v[84:87]
    ds_read_b64_tr_b16 a[112:113], v24 offset:49152
    ds_read_b64_tr_b16 a[114:115], v24 offset:51200
    v_mfma_f32_16x16x32_bf16 v[92:95], a[136:139], v[168:171], v[92:95]
    v_cvt_pk_bf16_f32 v114, v116, v117
    v_cvt_pk_bf16_f32 v115, v118, v119
    v_mfma_f32_16x16x32_bf16 v[84:87], a[140:143], v[176:179], v[84:87]
    ds_read_b64_tr_b16 a[116:117], v24 offset:53248
    ds_read_b64_tr_b16 a[118:119], v24 offset:55296
    v_mfma_f32_16x16x32_bf16 v[92:95], a[140:143], v[184:187], v[92:95]
    buffer_store_dwordx4 v[112:115], v34, s[28:31], s11 offen offset:2048 sc1
    v_mul_f32 v120, v120, v44
    s_waitcnt lgkmcnt(12)
    v_mfma_f32_16x16x32_bf16 v[64:67], a[224:227], v[192:195], v[64:67]
    ds_read_b64_tr_b16 a[120:121], v24 offset:57344
    ds_read_b64_tr_b16 a[122:123], v24 offset:59392
    v_mfma_f32_16x16x32_bf16 v[72:75], a[224:227], v[200:203], v[72:75]
    v_mul_f32 v121, v121, v44
    v_mul_f32 v122, v122, v44
    v_mfma_f32_16x16x32_bf16 v[64:67], a[228:231], v[208:211], v[64:67]
    ds_read_b64_tr_b16 a[124:125], v24 offset:61440
    ds_read_b64_tr_b16 a[126:127], v24 offset:63488
    v_mfma_f32_16x16x32_bf16 v[72:75], a[228:231], v[216:219], v[72:75]
    v_mul_f32 v123, v123, v44
    v_mul_f32 v124, v124, v44
    v_mfma_f32_16x16x32_bf16 v[64:67], a[232:235], v[224:227], v[64:67]
    ds_read_b64_tr_b16 a[128:129], v25 offset:49152
    ds_read_b64_tr_b16 a[130:131], v25 offset:51200
    v_mfma_f32_16x16x32_bf16 v[72:75], a[232:235], v[232:235], v[72:75]
    v_mul_f32 v125, v125, v44
    v_mul_f32 v126, v126, v44
    v_mfma_f32_16x16x32_bf16 v[64:67], a[236:239], v[240:243], v[64:67]
    ds_read_b64_tr_b16 a[132:133], v25 offset:53248
    ds_read_b64_tr_b16 a[134:135], v25 offset:55296
    v_mfma_f32_16x16x32_bf16 v[72:75], a[236:239], v[248:251], v[72:75]
    v_mul_f32 v127, v127, v44
    v_add_u32 v12, 524288, v56
    s_waitcnt lgkmcnt(12)
    v_mfma_f32_16x16x32_bf16 v[68:71], a[240:243], v[192:195], v[68:71]
    ds_read_b64_tr_b16 a[136:137], v25 offset:57344
    ds_read_b64_tr_b16 a[138:139], v25 offset:59392
    v_mfma_f32_16x16x32_bf16 v[76:79], a[240:243], v[200:203], v[76:79]
    v_cvt_pk_bf16_f32 v120, v120, v121
    v_cvt_pk_bf16_f32 v121, v122, v123
    v_cvt_pk_bf16_f32 v122, v124, v125
    v_mfma_f32_16x16x32_bf16 v[68:71], a[244:247], v[208:211], v[68:71]
    ds_read_b64_tr_b16 a[140:141], v25 offset:61440
    ds_read_b64_tr_b16 a[142:143], v25 offset:63488
    v_mfma_f32_16x16x32_bf16 v[76:79], a[244:247], v[216:219], v[76:79]
    v_cvt_pk_bf16_f32 v123, v126, v127
    buffer_store_dwordx4 v[120:123], v34, s[28:31], s11 offen offset:3072 sc1
    v_mfma_f32_16x16x32_bf16 v[68:71], a[248:251], v[224:227], v[68:71]
    s_barrier
    v_add_u32 v22, 4294901760, v22
    ds_read_b64_tr_b16 a[224:225], v22 offset:0
    ds_read_b64_tr_b16 a[226:227], v22 offset:2048
    v_mfma_f32_16x16x32_bf16 v[76:79], a[248:251], v[232:235], v[76:79]
    v_add_u32 v23, 4294901760, v23
    s_add_u32 s13, s12, 4096
    s_and_b32 s3, s13, 8192
    s_add_u32 s13, s13, s3
    v_mfma_f32_16x16x32_bf16 v[68:71], a[252:255], v[240:243], v[68:71]
    ds_read_b64_tr_b16 a[228:229], v22 offset:4096
    ds_read_b64_tr_b16 a[230:231], v22 offset:6144
    v_mfma_f32_16x16x32_bf16 v[76:79], a[252:255], v[248:251], v[76:79]
    v_add_u32 v24, 4294901760, v24
    s_waitcnt lgkmcnt(12)
    v_mfma_f32_16x16x32_bf16 v[80:83], a[112:115], v[192:195], v[80:83]
    ds_read_b64_tr_b16 a[232:233], v22 offset:8192
    ds_read_b64_tr_b16 a[234:235], v22 offset:10240
    v_add_u32 v25, 4294901760, v25
    v_mfma_f32_16x16x32_bf16 v[88:91], a[112:115], v[200:203], v[88:91]
    s_cmp_eq_u32 s13, 53248
    s_cselect_b32 s13, 0, s13
    v_mfma_f32_16x16x32_bf16 v[80:83], a[116:119], v[208:211], v[80:83]
    ds_read_b64_tr_b16 a[236:237], v22 offset:12288
    ds_read_b64_tr_b16 a[238:239], v22 offset:14336
    v_mfma_f32_16x16x32_bf16 v[88:91], a[116:119], v[216:219], v[88:91]
    v_mul_f32 v64, v64, v43
    v_mul_f32 v65, v65, v43
    v_mfma_f32_16x16x32_bf16 v[80:83], a[120:123], v[224:227], v[80:83]
    ds_read_b64_tr_b16 a[240:241], v23 offset:0
    ds_read_b64_tr_b16 a[242:243], v23 offset:2048
    v_mfma_f32_16x16x32_bf16 v[88:91], a[120:123], v[232:235], v[88:91]
    v_mul_f32 v66, v66, v43
    v_mul_f32 v67, v67, v43
    v_mfma_f32_16x16x32_bf16 v[80:83], a[124:127], v[240:243], v[80:83]
    ds_read_b64_tr_b16 a[244:245], v23 offset:4096
    ds_read_b64_tr_b16 a[246:247], v23 offset:6144
    v_mfma_f32_16x16x32_bf16 v[88:91], a[124:127], v[248:251], v[88:91]
    v_mul_f32 v68, v68, v43
    s_waitcnt lgkmcnt(12)
    v_mfma_f32_16x16x32_bf16 v[84:87], a[128:131], v[192:195], v[84:87]
    ds_read_b64_tr_b16 a[248:249], v23 offset:8192
    ds_read_b64_tr_b16 a[250:251], v23 offset:10240
    v_mfma_f32_16x16x32_bf16 v[92:95], a[128:131], v[200:203], v[92:95]
    v_mul_f32 v69, v69, v43
    v_mul_f32 v70, v70, v43
    v_add_u32 v13, 786432, v56
    v_mfma_f32_16x16x32_bf16 v[84:87], a[132:135], v[208:211], v[84:87]
    ds_read_b64_tr_b16 a[252:253], v23 offset:12288
    ds_read_b64_tr_b16 a[254:255], v23 offset:14336
    v_mfma_f32_16x16x32_bf16 v[92:95], a[132:135], v[216:219], v[92:95]
    v_mul_f32 v71, v71, v43
    v_cvt_pk_bf16_f32 v64, v64, v65
    v_mfma_f32_16x16x32_bf16 v[84:87], a[136:139], v[224:227], v[84:87]
    ds_read_b64_tr_b16 a[112:113], v24 offset:0
    ds_read_b64_tr_b16 a[114:115], v24 offset:2048
    v_mfma_f32_16x16x32_bf16 v[92:95], a[136:139], v[232:235], v[92:95]
    v_cvt_pk_bf16_f32 v65, v66, v67
    v_cvt_pk_bf16_f32 v66, v68, v69
    v_mfma_f32_16x16x32_bf16 v[84:87], a[140:143], v[240:243], v[84:87]
    ds_read_b64_tr_b16 a[116:117], v24 offset:4096
    ds_read_b64_tr_b16 a[118:119], v24 offset:6144
    v_mfma_f32_16x16x32_bf16 v[92:95], a[140:143], v[248:251], v[92:95]
    v_cvt_pk_bf16_f32 v67, v70, v71
    s_waitcnt lgkmcnt(12)
    v_mfma_f32_16x16x32_bf16 v[96:99], a[224:227], v[128:131], 0
    ds_read_b64_tr_b16 a[120:121], v24 offset:8192
    ds_read_b64_tr_b16 a[122:123], v24 offset:10240
    v_mfma_f32_16x16x32_bf16 v[104:107], a[224:227], v[136:139], 0
    buffer_store_dwordx4 v[64:67], v34, s[28:31], s12 offen sc1
    v_mul_f32 v72, v72, v44
    v_mfma_f32_16x16x32_bf16 v[96:99], a[228:231], v[144:147], v[96:99]
    ds_read_b64_tr_b16 a[124:125], v24 offset:12288
    ds_read_b64_tr_b16 a[126:127], v24 offset:14336
    v_mfma_f32_16x16x32_bf16 v[104:107], a[228:231], v[152:155], v[104:107]
    v_mul_f32 v73, v73, v44
    v_mul_f32 v74, v74, v44
    v_mfma_f32_16x16x32_bf16 v[96:99], a[232:235], v[160:163], v[96:99]
    ds_read_b64_tr_b16 a[128:129], v25 offset:0
    ds_read_b64_tr_b16 a[130:131], v25 offset:2048
    v_mfma_f32_16x16x32_bf16 v[104:107], a[232:235], v[168:171], v[104:107]
    v_mul_f32 v75, v75, v44
    v_mul_f32 v76, v76, v44
    v_lshl_add_u32 v18, v4, 3, 7
    v_mfma_f32_16x16x32_bf16 v[96:99], a[236:239], v[176:179], v[96:99]
    ds_read_b64_tr_b16 a[132:133], v25 offset:4096
    ds_read_b64_tr_b16 a[134:135], v25 offset:6144
    v_mfma_f32_16x16x32_bf16 v[104:107], a[236:239], v[184:187], v[104:107]
    v_mul_f32 v77, v77, v44
    s_waitcnt lgkmcnt(12)
    v_mfma_f32_16x16x32_bf16 v[100:103], a[240:243], v[128:131], 0
    ds_read_b64_tr_b16 a[136:137], v25 offset:8192
    ds_read_b64_tr_b16 a[138:139], v25 offset:10240
    v_mfma_f32_16x16x32_bf16 v[108:111], a[240:243], v[136:139], 0
    v_mul_f32 v78, v78, v44
    v_mul_f32 v79, v79, v44
    v_mfma_f32_16x16x32_bf16 v[100:103], a[244:247], v[144:147], v[100:103]
    ds_read_b64_tr_b16 a[140:141], v25 offset:12288
    ds_read_b64_tr_b16 a[142:143], v25 offset:14336
    v_mfma_f32_16x16x32_bf16 v[108:111], a[244:247], v[152:155], v[108:111]
    v_cvt_pk_bf16_f32 v72, v72, v73
    v_cvt_pk_bf16_f32 v73, v74, v75
    v_mfma_f32_16x16x32_bf16 v[100:103], a[248:251], v[160:163], v[100:103]
    s_barrier
    v_mfma_f32_16x16x32_bf16 v[108:111], a[248:251], v[168:171], v[108:111]
    ds_read_b64_tr_b16 a[224:225], v22 offset:16384
    ds_read_b64_tr_b16 a[226:227], v22 offset:18432
    v_mfma_f32_16x16x32_bf16 v[100:103], a[252:255], v[176:179], v[100:103]
    ds_read_b64_tr_b16 a[228:229], v22 offset:20480
    ds_read_b64_tr_b16 a[230:231], v22 offset:22528
    v_mfma_f32_16x16x32_bf16 v[108:111], a[252:255], v[184:187], v[108:111]
    v_cvt_pk_bf16_f32 v74, v76, v77
    s_waitcnt lgkmcnt(12)
    v_mfma_f32_16x16x32_bf16 v[112:115], a[112:115], v[128:131], 0
    ds_read_b64_tr_b16 a[232:233], v22 offset:24576
    ds_read_b64_tr_b16 a[234:235], v22 offset:26624
    v_mfma_f32_16x16x32_bf16 v[120:123], a[112:115], v[136:139], 0
    v_cvt_pk_bf16_f32 v75, v78, v79
    buffer_store_dwordx4 v[72:75], v34, s[28:31], s12 offen offset:1024 sc1
    v_mfma_f32_16x16x32_bf16 v[112:115], a[116:119], v[144:147], v[112:115]
    ds_read_b64_tr_b16 a[236:237], v22 offset:28672
    ds_read_b64_tr_b16 a[238:239], v22 offset:30720
    v_mfma_f32_16x16x32_bf16 v[120:123], a[116:119], v[152:155], v[120:123]
    v_mul_f32 v80, v80, v43
    v_mul_f32 v81, v81, v43
    v_mfma_f32_16x16x32_bf16 v[112:115], a[120:123], v[160:163], v[112:115]
    ds_read_b64_tr_b16 a[240:241], v23 offset:16384
    ds_read_b64_tr_b16 a[242:243], v23 offset:18432
    v_mfma_f32_16x16x32_bf16 v[120:123], a[120:123], v[168:171], v[120:123]
    v_mul_f32 v82, v82, v43
    v_mul_f32 v83, v83, v43
    v_mul_f32 v84, v84, v43
    v_mfma_f32_16x16x32_bf16 v[112:115], a[124:127], v[176:179], v[112:115]
    ds_read_b64_tr_b16 a[244:245], v23 offset:20480
    ds_read_b64_tr_b16 a[246:247], v23 offset:22528
    v_mfma_f32_16x16x32_bf16 v[120:123], a[124:127], v[184:187], v[120:123]
    v_mul_f32 v85, v85, v43
    s_waitcnt lgkmcnt(12)
    v_mfma_f32_16x16x32_bf16 v[116:119], a[128:131], v[128:131], 0
    ds_read_b64_tr_b16 a[248:249], v23 offset:24576
    ds_read_b64_tr_b16 a[250:251], v23 offset:26624
    v_mfma_f32_16x16x32_bf16 v[124:127], a[128:131], v[136:139], 0
    s_mov_b64 s[64:65], 0
    s_mov_b64 s[66:67], 0
    s_buffer_load_dwordx4 s[64:67], s[32:35], s78
    s_add_u32 s78, s78, 0x10000
    v_mfma_f32_16x16x32_bf16 v[116:119], a[132:135], v[144:147], v[116:119]
    ds_read_b64_tr_b16 a[252:253], v23 offset:28672
    ds_read_b64_tr_b16 a[254:255], v23 offset:30720
    v_mfma_f32_16x16x32_bf16 v[124:127], a[132:135], v[152:155], v[124:127]
    v_mul_f32 v86, v86, v43
    v_mul_f32 v87, v87, v43
    v_mfma_f32_16x16x32_bf16 v[116:119], a[136:139], v[160:163], v[116:119]
    ds_read_b64_tr_b16 a[112:113], v24 offset:16384
    ds_read_b64_tr_b16 a[114:115], v24 offset:18432
    v_mfma_f32_16x16x32_bf16 v[124:127], a[136:139], v[168:171], v[124:127]
    v_cvt_pk_bf16_f32 v80, v80, v81
    v_cvt_pk_bf16_f32 v81, v82, v83
    v_cvt_pk_bf16_f32 v82, v84, v85
    v_mfma_f32_16x16x32_bf16 v[116:119], a[140:143], v[176:179], v[116:119]
    ds_read_b64_tr_b16 a[116:117], v24 offset:20480
    ds_read_b64_tr_b16 a[118:119], v24 offset:22528
    v_mfma_f32_16x16x32_bf16 v[124:127], a[140:143], v[184:187], v[124:127]
    v_cvt_pk_bf16_f32 v83, v86, v87
    s_waitcnt lgkmcnt(12)
    v_mfma_f32_16x16x32_bf16 v[96:99], a[224:227], v[192:195], v[96:99]
    ds_read_b64_tr_b16 a[120:121], v24 offset:24576
    ds_read_b64_tr_b16 a[122:123], v24 offset:26624
    v_mfma_f32_16x16x32_bf16 v[104:107], a[224:227], v[200:203], v[104:107]
    buffer_store_dwordx4 v[80:83], v34, s[28:31], s12 offen offset:2048 sc1
    v_mul_f32 v88, v88, v44
    v_mfma_f32_16x16x32_bf16 v[96:99], a[228:231], v[208:211], v[96:99]
    ds_read_b64_tr_b16 a[124:125], v24 offset:28672
    ds_read_b64_tr_b16 a[126:127], v24 offset:30720
    v_mfma_f32_16x16x32_bf16 v[104:107], a[228:231], v[216:219], v[104:107]
    v_mul_f32 v89, v89, v44
    v_mul_f32 v90, v90, v44
    v_mfma_f32_16x16x32_bf16 v[96:99], a[232:235], v[224:227], v[96:99]
    ds_read_b64_tr_b16 a[128:129], v25 offset:16384
    ds_read_b64_tr_b16 a[130:131], v25 offset:18432
    v_mfma_f32_16x16x32_bf16 v[104:107], a[232:235], v[232:235], v[104:107]
    v_mul_f32 v91, v91, v44
    v_mul_f32 v92, v92, v44
    v_mul_f32 v93, v93, v44
    v_mfma_f32_16x16x32_bf16 v[96:99], a[236:239], v[240:243], v[96:99]
    ds_read_b64_tr_b16 a[132:133], v25 offset:20480
    ds_read_b64_tr_b16 a[134:135], v25 offset:22528
    v_mfma_f32_16x16x32_bf16 v[104:107], a[236:239], v[248:251], v[104:107]
    v_mul_f32 v94, v94, v44
    s_waitcnt lgkmcnt(12)
    v_mfma_f32_16x16x32_bf16 v[100:103], a[240:243], v[192:195], v[100:103]
    ds_read_b64_tr_b16 a[136:137], v25 offset:24576
    ds_read_b64_tr_b16 a[138:139], v25 offset:26624
    v_mfma_f32_16x16x32_bf16 v[108:111], a[240:243], v[200:203], v[108:111]
    v_mul_f32 v95, v95, v44
    v_cvt_pk_bf16_f32 v88, v88, v89
    v_mfma_f32_16x16x32_bf16 v[100:103], a[244:247], v[208:211], v[100:103]
    ds_read_b64_tr_b16 a[140:141], v25 offset:28672
    ds_read_b64_tr_b16 a[142:143], v25 offset:30720
    v_mfma_f32_16x16x32_bf16 v[108:111], a[244:247], v[216:219], v[108:111]
    v_cvt_pk_bf16_f32 v89, v90, v91
    v_cvt_pk_bf16_f32 v90, v92, v93
    v_cvt_pk_bf16_f32 v91, v94, v95
    v_mfma_f32_16x16x32_bf16 v[100:103], a[248:251], v[224:227], v[100:103]
    s_waitcnt vmcnt(15)
    s_barrier
    ds_read_b64_tr_b16 a[224:225], v22 offset:32768
    ds_read_b64_tr_b16 a[226:227], v22 offset:34816
    v_mfma_f32_16x16x32_bf16 v[108:111], a[248:251], v[232:235], v[108:111]
    s_add_u32 s14, s13, 4096
    s_and_b32 s3, s14, 8192
    s_add_u32 s14, s14, s3
    v_mfma_f32_16x16x32_bf16 v[100:103], a[252:255], v[240:243], v[100:103]
    ds_read_b64_tr_b16 a[228:229], v22 offset:36864
    ds_read_b64_tr_b16 a[230:231], v22 offset:38912
    v_mfma_f32_16x16x32_bf16 v[108:111], a[252:255], v[248:251], v[108:111]
    buffer_store_dwordx4 v[88:91], v34, s[28:31], s12 offen offset:3072 sc1
    s_waitcnt lgkmcnt(12)
    v_mfma_f32_16x16x32_bf16 v[112:115], a[112:115], v[192:195], v[112:115]
    ds_read_b64_tr_b16 a[232:233], v22 offset:40960
    ds_read_b64_tr_b16 a[234:235], v22 offset:43008
    s_cmp_eq_u32 s14, 53248
    s_cselect_b32 s14, 0, s14
    v_mfma_f32_16x16x32_bf16 v[120:123], a[112:115], v[200:203], v[120:123]
    s_and_b64 s[76:77], s[64:65], s[66:67]
    s_and_b32 s76, s76, s77
    s_and_b32 s76, s76, 33686018
    v_mfma_f32_16x16x32_bf16 v[112:115], a[116:119], v[208:211], v[112:115]
    ds_read_b64_tr_b16 a[236:237], v22 offset:45056
    ds_read_b64_tr_b16 a[238:239], v22 offset:47104
    s_waitcnt vmcnt(4)
    v_or_b32 v50, 15, v51
    s_cmp_lg_u32 s100, s101
    s_cbranch_scc1 L_far1
    buffer_store_byte v50, v45, s[32:35], 0 offen
L_bk1:
    v_mfma_f32_16x16x32_bf16 v[120:123], a[116:119], v[216:219], v[120:123]
    s_cmp_eq_u32 s76, 33686018
    s_cselect_b32 s76, 0, 99
    s_cmp_eq_u32 s79, s76
    s_cselect_b32 s79, 2, s79
    s_cselect_b32 s76, 0, 0x800000
    v_mfma_f32_16x16x32_bf16 v[112:115], a[120:123], v[224:227], v[112:115]
    ds_read_b64_tr_b16 a[240:241], v23 offset:32768
    ds_read_b64_tr_b16 a[242:243], v23 offset:34816
    v_bfe_u32 v14, s64, v18, 1
    v_lshl_add_u32 v14, v14, 13, v56
    v_mfma_f32_16x16x32_bf16 v[120:123], a[120:123], v[232:235], v[120:123]
    v_or_b32 v14, s76, v14
    v_bfe_u32 v15, s65, v18, 1
    v_lshl_add_u32 v15, v15, 13, v11
    v_or_b32 v15, s76, v15
    v_mfma_f32_16x16x32_bf16 v[112:115], a[124:127], v[240:243], v[112:115]
    ds_read_b64_tr_b16 a[244:245], v23 offset:36864
    ds_read_b64_tr_b16 a[246:247], v23 offset:38912
    v_bfe_u32 v16, s66, v18, 1
    v_lshl_add_u32 v16, v16, 13, v12
    v_mfma_f32_16x16x32_bf16 v[120:123], a[124:127], v[248:251], v[120:123]
    v_or_b32 v16, s76, v16
    v_bfe_u32 v17, s67, v18, 1
    v_lshl_add_u32 v17, v17, 13, v13
    v_or_b32 v17, s76, v17
    s_waitcnt lgkmcnt(12)
    v_mfma_f32_16x16x32_bf16 v[116:119], a[128:131], v[192:195], v[116:119]
    ds_read_b64_tr_b16 a[248:249], v23 offset:40960
    ds_read_b64_tr_b16 a[250:251], v23 offset:43008
    v_mfma_f32_16x16x32_bf16 v[124:127], a[128:131], v[200:203], v[124:127]
    v_mul_f32 v96, v96, v43
    v_mul_f32 v97, v97, v43
    buffer_load_dwordx4 a[0:3], v14, s[28:31], s8 offen sc1
    v_mfma_f32_16x16x32_bf16 v[116:119], a[132:135], v[208:211], v[116:119]
    ds_read_b64_tr_b16 a[252:253], v23 offset:45056
    ds_read_b64_tr_b16 a[254:255], v23 offset:47104
    v_mfma_f32_16x16x32_bf16 v[124:127], a[132:135], v[216:219], v[124:127]
    v_mul_f32 v98, v98, v43
    v_mul_f32 v99, v99, v43
    v_mfma_f32_16x16x32_bf16 v[116:119], a[136:139], v[224:227], v[116:119]
    ds_read_b64_tr_b16 a[112:113], v24 offset:32768
    ds_read_b64_tr_b16 a[114:115], v24 offset:34816
    v_mfma_f32_16x16x32_bf16 v[124:127], a[136:139], v[232:235], v[124:127]
    v_mul_f32 v100, v100, v43
    v_mul_f32 v101, v101, v43
    v_mul_f32 v102, v102, v43
    v_mfma_f32_16x16x32_bf16 v[116:119], a[140:143], v[240:243], v[116:119]
    ds_read_b64_tr_b16 a[116:117], v24 offset:36864
    ds_read_b64_tr_b16 a[118:119], v24 offset:38912
    v_mfma_f32_16x16x32_bf16 v[124:127], a[140:143], v[248:251], v[124:127]
    v_mul_f32 v103, v103, v43
    buffer_load_dwordx4 a[4:7], v15, s[28:31], s8 offen sc1
    s_waitcnt lgkmcnt(12)
    v_mfma_f32_16x16x32_bf16 v[64:67], a[224:227], v[128:131], 0
    ds_read_b64_tr_b16 a[120:121], v24 offset:40960
    ds_read_b64_tr_b16 a[122:123], v24 offset:43008
    v_mfma_f32_16x16x32_bf16 v[72:75], a[224:227], v[136:139], 0
    v_cvt_pk_bf16_f32 v96, v96, v97
    v_cvt_pk_bf16_f32 v97, v98, v99
    v_mfma_f32_16x16x32_bf16 v[64:67], a[228:231], v[144:147], v[64:67]
    ds_read_b64_tr_b16 a[124:125], v24 offset:45056
    ds_read_b64_tr_b16 a[126:127], v24 offset:47104
    v_mfma_f32_16x16x32_bf16 v[72:75], a[228:231], v[152:155], v[72:75]
    v_cvt_pk_bf16_f32 v98, v100, v101
    v_cvt_pk_bf16_f32 v99, v102, v103
    buffer_store_dwordx4 v[96:99], v34, s[28:31], s13 offen sc1
    v_mfma_f32_16x16x32_bf16 v[64:67], a[232:235], v[160:163], v[64:67]
    ds_read_b64_tr_b16 a[128:129], v25 offset:32768
    ds_read_b64_tr_b16 a[130:131], v25 offset:34816
    v_mfma_f32_16x16x32_bf16 v[72:75], a[232:235], v[168:171], v[72:75]
    v_mul_f32 v104, v104, v44
    v_mul_f32 v105, v105, v44
    buffer_load_dwordx4 a[8:11], v16, s[28:31], s8 offen sc1
    v_mfma_f32_16x16x32_bf16 v[64:67], a[236:239], v[176:179], v[64:67]
    ds_read_b64_tr_b16 a[132:133], v25 offset:36864
    ds_read_b64_tr_b16 a[134:135], v25 offset:38912
    v_mfma_f32_16x16x32_bf16 v[72:75], a[236:239], v[184:187], v[72:75]
    v_mul_f32 v106, v106, v44
    v_mul_f32 v107, v107, v44
    s_waitcnt lgkmcnt(12)
    v_mfma_f32_16x16x32_bf16 v[68:71], a[240:243], v[128:131], 0
    ds_read_b64_tr_b16 a[136:137], v25 offset:40960
    ds_read_b64_tr_b16 a[138:139], v25 offset:43008
    v_mfma_f32_16x16x32_bf16 v[76:79], a[240:243], v[136:139], 0
    v_mul_f32 v108, v108, v44
    v_mul_f32 v109, v109, v44
    v_mfma_f32_16x16x32_bf16 v[68:71], a[244:247], v[144:147], v[68:71]
    ds_read_b64_tr_b16 a[140:141], v25 offset:45056
    ds_read_b64_tr_b16 a[142:143], v25 offset:47104
    v_mfma_f32_16x16x32_bf16 v[76:79], a[244:247], v[152:155], v[76:79]
    v_mul_f32 v110, v110, v44
    v_mul_f32 v111, v111, v44
    buffer_load_dwordx4 a[12:15], v17, s[28:31], s8 offen sc1
    v_mfma_f32_16x16x32_bf16 v[68:71], a[248:251], v[160:163], v[68:71]
    s_barrier
    ds_read_b64_tr_b16 a[224:225], v22 offset:49152
    v_mfma_f32_16x16x32_bf16 v[76:79], a[248:251], v[168:171], v[76:79]
    ds_read_b64_tr_b16 a[226:227], v22 offset:51200
    v_cvt_pk_bf16_f32 v104, v104, v105
    v_mfma_f32_16x16x32_bf16 v[68:71], a[252:255], v[176:179], v[68:71]
    ds_read_b64_tr_b16 a[228:229], v22 offset:53248
    ds_read_b64_tr_b16 a[230:231], v22 offset:55296
    v_mfma_f32_16x16x32_bf16 v[76:79], a[252:255], v[184:187], v[76:79]
    v_cvt_pk_bf16_f32 v105, v106, v107
    s_waitcnt lgkmcnt(12)
    v_mfma_f32_16x16x32_bf16 v[80:83], a[112:115], v[128:131], 0
    ds_read_b64_tr_b16 a[232:233], v22 offset:57344
    ds_read_b64_tr_b16 a[234:235], v22 offset:59392
    v_mfma_f32_16x16x32_bf16 v[88:91], a[112:115], v[136:139], 0
    v_cvt_pk_bf16_f32 v106, v108, v109
    v_cvt_pk_bf16_f32 v107, v110, v111
    buffer_store_dwordx4 v[104:107], v34, s[28:31], s13 offen offset:1024 sc1
    v_mfma_f32_16x16x32_bf16 v[80:83], a[116:119], v[144:147], v[80:83]
    ds_read_b64_tr_b16 a[236:237], v22 offset:61440
    ds_read_b64_tr_b16 a[238:239], v22 offset:63488
    v_mfma_f32_16x16x32_bf16 v[88:91], a[116:119], v[152:155], v[88:91]
    v_mul_f32 v112, v112, v43
    buffer_load_dwordx4 a[16:19], v14, s[28:31], s9 offen sc1
    v_mfma_f32_16x16x32_bf16 v[80:83], a[120:123], v[160:163], v[80:83]
    ds_read_b64_tr_b16 a[240:241], v23 offset:49152
    ds_read_b64_tr_b16 a[242:243], v23 offset:51200
    v_mfma_f32_16x16x32_bf16 v[88:91], a[120:123], v[168:171], v[88:91]
    v_mul_f32 v113, v113, v43
    v_mul_f32 v114, v114, v43
    v_mfma_f32_16x16x32_bf16 v[80:83], a[124:127], v[176:179], v[80:83]
    ds_read_b64_tr_b16 a[244:245], v23 offset:53248
    ds_read_b64_tr_b16 a[246:247], v23 offset:55296
    v_mfma_f32_16x16x32_bf16 v[88:91], a[124:127], v[184:187], v[88:91]
    v_mul_f32 v115, v115, v43
    s_waitcnt lgkmcnt(12)
    v_mfma_f32_16x16x32_bf16 v[84:87], a[128:131], v[128:131], 0
    ds_read_b64_tr_b16 a[248:249], v23 offset:57344
    ds_read_b64_tr_b16 a[250:251], v23 offset:59392
    v_mfma_f32_16x16x32_bf16 v[92:95], a[128:131], v[136:139], 0
    v_mul_f32 v116, v116, v43
    buffer_load_dwordx4 a[20:23], v15, s[28:31], s9 offen sc1
    v_mfma_f32_16x16x32_bf16 v[84:87], a[132:135], v[144:147], v[84:87]
    ds_read_b64_tr_b16 a[252:253], v23 offset:61440
    ds_read_b64_tr_b16 a[254:255], v23 offset:63488
    v_mfma_f32_16x16x32_bf16 v[92:95], a[132:135], v[152:155], v[92:95]
    v_mul_f32 v117, v117, v43
    v_mul_f32 v118, v118, v43
    v_mfma_f32_16x16x32_bf16 v[84:87], a[136:139], v[160:163], v[84:87]
    ds_read_b64_tr_b16 a[112:113], v24 offset:49152
    ds_read_b64_tr_b16 a[114:115], v24 offset:51200
    v_mfma_f32_16x16x32_bf16 v[92:95], a[136:139], v[168:171], v[92:95]
    v_mul_f32 v119, v119, v43
    v_cvt_pk_bf16_f32 v112, v112, v113
    v_mfma_f32_16x16x32_bf16 v[84:87], a[140:143], v[176:179], v[84:87]
L_pg11:
    s_cbranch_execz L_pgr9
    ds_read_b64_tr_b16 a[116:117], v24 offset:53248
    ds_read_b64_tr_b16 a[118:119], v24 offset:55296
    v_mfma_f32_16x16x32_bf16 v[92:95], a[140:143], v[184:187], v[92:95]
    buffer_load_dwordx4 a[24:27], v16, s[28:31], s9 offen sc1
    s_waitcnt lgkmcnt(12)
    v_mfma_f32_16x16x32_bf16 v[64:67], a[224:227], v[192:195], v[64:67]
    ds_read_b64_tr_b16 a[120:121], v24 offset:57344
    ds_read_b64_tr_b16 a[122:123], v24 offset:59392
    v_mfma_f32_16x16x32_bf16 v[72:75], a[224:227], v[200:203], v[72:75]
    v_cvt_pk_bf16_f32 v113, v114, v115
    v_cvt_pk_bf16_f32 v114, v116, v117
    v_mfma_f32_16x16x32_bf16 v[64:67], a[228:231], v[208:211], v[64:67]
    ds_read_b64_tr_b16 a[124:125], v24 offset:61440
    ds_read_b64_tr_b16 a[126:127], v24 offset:63488
    v_mfma_f32_16x16x32_bf16 v[72:75], a[228:231], v[216:219], v[72:75]
    v_cvt_pk_bf16_f32 v115, v118, v119
    buffer_store_dwordx4 v[112:115], v34, s[28:31], s13 offen offset:2048 sc1
    v_mfma_f32_16x16x32_bf16 v[64:67], a[232:235], v[224:227], v[64:67]
    ds_read_b64_tr_b16 a[128:129], v25 offset:49152
    ds_read_b64_tr_b16 a[130:131], v25 offset:51200
    v_mfma_f32_16x16x32_bf16 v[72:75], a[232:235], v[232:235], v[72:75]
    v_mul_f32 v120, v120, v44
    buffer_load_dwordx4 a[28:31], v17, s[28:31], s9 offen sc1
    v_mfma_f32_16x16x32_bf16 v[64:67], a[236:239], v[240:243], v[64:67]
    ds_read_b64_tr_b16 a[132:133], v25 offset:53248
    ds_read_b64_tr_b16 a[134:135], v25 offset:55296
    v_mfma_f32_16x16x32_bf16 v[72:75], a[236:239], v[248:251], v[72:75]
    v_mul_f32 v121, v121, v44
    s_waitcnt lgkmcnt(12)
    v_mfma_f32_16x16x32_bf16 v[68:71], a[240:243], v[192:195], v[68:71]
    ds_read_b64_tr_b16 a[136:137], v25 offset:57344
    ds_read_b64_tr_b16 a[138:139], v25 offset:59392
    v_mfma_f32_16x16x32_bf16 v[76:79], a[240:243], v[200:203], v[76:79]
    v_mul_f32 v122, v122, v44
    v_mul_f32 v123, v123, v44
    v_mfma_f32_16x16x32_bf16 v[68:71], a[244:247], v[208:211], v[68:71]
    ds_read_b64_tr_b16 a[140:141], v25 offset:61440
    ds_read_b64_tr_b16 a[142:143], v25 offset:63488
    v_mfma_f32_16x16x32_bf16 v[76:79], a[244:247], v[216:219], v[76:79]
    v_mul_f32 v124, v124, v44
    v_mul_f32 v125, v125, v44
    v_mfma_f32_16x16x32_bf16 v[68:71], a[248:251], v[224:227], v[68:71]
    v_mul_f32 v126, v126, v44
    v_mul_f32 v127, v127, v44
    v_mfma_f32_16x16x32_bf16 v[76:79], a[248:251], v[232:235], v[76:79]
    v_cvt_pk_bf16_f32 v120, v120, v121
    v_cvt_pk_bf16_f32 v121, v122, v123
    v_mfma_f32_16x16x32_bf16 v[68:71], a[252:255], v[240:243], v[68:71]
    v_cvt_pk_bf16_f32 v122, v124, v125
    v_cvt_pk_bf16_f32 v123, v126, v127
    v_mfma_f32_16x16x32_bf16 v[76:79], a[252:255], v[248:251], v[76:79]
    buffer_store_dwordx4 v[120:123], v34, s[28:31], s13 offen offset:3072 sc1
    s_waitcnt lgkmcnt(8)
    v_mfma_f32_16x16x32_bf16 v[80:83], a[112:115], v[192:195], v[80:83]
    v_mfma_f32_16x16x32_bf16 v[88:91], a[112:115], v[200:203], v[88:91]
    v_mfma_f32_16x16x32_bf16 v[80:83], a[116:119], v[208:211], v[80:83]
    v_mul_f32 v64, v64, v43
    v_mul_f32 v65, v65, v43
    v_mfma_f32_16x16x32_bf16 v[88:91], a[116:119], v[216:219], v[88:91]
    v_mul_f32 v66, v66, v43
    v_mul_f32 v67, v67, v43
    v_mfma_f32_16x16x32_bf16 v[80:83], a[120:123], v[224:227], v[80:83]
    v_mul_f32 v68, v68, v43
    v_mul_f32 v69, v69, v43
    v_mfma_f32_16x16x32_bf16 v[88:91], a[120:123], v[232:235], v[88:91]
    v_mul_f32 v70, v70, v43
    v_mul_f32 v71, v71, v43
    v_cvt_pk_bf16_f32 v64, v64, v65
    v_mfma_f32_16x16x32_bf16 v[80:83], a[124:127], v[240:243], v[80:83]
    v_cvt_pk_bf16_f32 v65, v66, v67
    v_cvt_pk_bf16_f32 v66, v68, v69
    v_mfma_f32_16x16x32_bf16 v[88:91], a[124:127], v[248:251], v[88:91]
    v_cvt_pk_bf16_f32 v67, v70, v71
    s_waitcnt lgkmcnt(0)
    v_mfma_f32_16x16x32_bf16 v[84:87], a[128:131], v[192:195], v[84:87]
    buffer_store_dwordx4 v[64:67], v34, s[28:31], s14 offen sc1
    v_mul_f32 v72, v72, v44
    v_mfma_f32_16x16x32_bf16 v[92:95], a[128:131], v[200:203], v[92:95]
    v_mul_f32 v73, v73, v44
    v_mul_f32 v74, v74, v44
    v_mfma_f32_16x16x32_bf16 v[84:87], a[132:135], v[208:211], v[84:87]
    v_mul_f32 v75, v75, v44
    v_mul_f32 v76, v76, v44
    v_mfma_f32_16x16x32_bf16 v[92:95], a[132:135], v[216:219], v[92:95]
    s_buffer_load_dwordx4 s[64:67], s[32:35], s78
    s_add_u32 s78, s78, 0x10000
    v_mfma_f32_16x16x32_bf16 v[84:87], a[136:139], v[224:227], v[84:87]
    v_mul_f32 v77, v77, v44
    v_mul_f32 v78, v78, v44
    v_mfma_f32_16x16x32_bf16 v[92:95], a[136:139], v[232:235], v[92:95]
    v_mul_f32 v79, v79, v44
    v_cvt_pk_bf16_f32 v72, v72, v73
    v_cvt_pk_bf16_f32 v73, v74, v75
    v_mfma_f32_16x16x32_bf16 v[84:87], a[140:143], v[240:243], v[84:87]
    v_cvt_pk_bf16_f32 v74, v76, v77
    v_cvt_pk_bf16_f32 v75, v78, v79
    v_mfma_f32_16x16x32_bf16 v[92:95], a[140:143], v[248:251], v[92:95]
    buffer_store_dwordx4 v[72:75], v34, s[28:31], s14 offen offset:1024 sc1
    v_mul_f32 v80, v80, v43
    v_mul_f32 v81, v81, v43
    v_mul_f32 v82, v82, v43
    v_mul_f32 v83, v83, v43
    v_mul_f32 v84, v84, v43
    v_mul_f32 v85, v85, v43
    v_mul_f32 v86, v86, v43
    v_mul_f32 v87, v87, v43
    v_cvt_pk_bf16_f32 v80, v80, v81
    v_cvt_pk_bf16_f32 v81, v82, v83
    v_cvt_pk_bf16_f32 v82, v84, v85
    v_cvt_pk_bf16_f32 v83, v86, v87
    buffer_store_dwordx4 v[80:83], v34, s[28:31], s14 offen offset:2048 sc1
    v_mul_f32 v88, v88, v44
    v_mul_f32 v89, v89, v44
    v_mul_f32 v90, v90, v44
    v_mul_f32 v91, v91, v44
    v_mul_f32 v92, v92, v44
    v_mul_f32 v93, v93, v44
    v_mul_f32 v94, v94, v44
    v_mul_f32 v95, v95, v44
    v_cvt_pk_bf16_f32 v88, v88, v89
    v_cvt_pk_bf16_f32 v89, v90, v91
    v_cvt_pk_bf16_f32 v90, v92, v93
    v_cvt_pk_bf16_f32 v91, v94, v95
    buffer_store_dwordx4 v[88:91], v34, s[28:31], s14 offen offset:3072 sc1
    s_lshr_b32 s16, s8, 6
    s_and_b32 s3, s16, 0x40
    s_add_u32 s16, s16, s3
    s_lshr_b32 s17, s9, 6
    s_and_b32 s3, s17, 0x40
    s_add_u32 s17, s17, s3
    s_lshr_b32 s18, s10, 6
    s_and_b32 s3, s18, 0x40
    s_add_u32 s18, s18, s3
    s_lshr_b32 s19, s11, 6
    s_and_b32 s3, s19, 0x40
    s_add_u32 s19, s19, s3
    s_lshr_b32 s20, s12, 6
    s_and_b32 s3, s20, 0x40
    s_add_u32 s20, s20, s3
    s_lshr_b32 s21, s13, 6
    s_and_b32 s3, s21, 0x40
    s_add_u32 s21, s21, s3
    s_lshr_b32 s22, s14, 6
    s_and_b32 s3, s22, 0x40
    s_add_u32 s22, s22, s3
    s_waitcnt lgkmcnt(0)
    v_bfe_u32 v14, s64, v18, 1
    v_lshl_add_u32 v14, v14, 13, v56
    v_bfe_u32 v15, s65, v18, 1
    v_lshl_add_u32 v15, v15, 13, v11
    v_bfe_u32 v16, s66, v18, 1
    v_lshl_add_u32 v16, v16, 13, v12
    v_bfe_u32 v17, s67, v18, 1
    v_lshl_add_u32 v17, v17, 13, v13
    s_and_b64 s[64:65], s[64:65], s[66:67]
    s_and_b32 s64, s64, s65
    s_lshr_b32 s3, s64, 16
    s_and_b32 s64, s64, s3
    s_lshr_b32 s3, s64, 8
    s_and_b32 s64, s64, s3
    s_cmp_lg_u32 s79, 2
    s_cbranch_scc1 L_p0x
    s_bitcmp1_b32 s64, 2
    s_cbranch_scc0 L_pub2
    buffer_load_dwordx4 a[32:35], v14, s[28:31], s10 offen sc1
    buffer_load_dwordx4 a[36:39], v15, s[28:31], s10 offen sc1
    buffer_load_dwordx4 a[40:43], v16, s[28:31], s10 offen sc1
    buffer_load_dwordx4 a[44:47], v17, s[28:31], s10 offen sc1
    s_waitcnt vmcnt(8)
    v_or_b32 v50, 63, v51
    s_cmp_lg_u32 s100, s101
    s_cbranch_scc1 L_far2
    buffer_store_byte v50, v45, s[32:35], 0 offen
L_bk2:
    s_waitcnt vmcnt(5)
    v_or_b32 v50, 127, v51
    s_cmp_lg_u32 s100, s101
    s_cbranch_scc1 L_far3
    buffer_store_byte v50, v45, s[32:35], 0 offen
L_bk3:
    s_branch L_c3
L_pub2:
    s_waitcnt vmcnt(4)
    v_or_b32 v50, 63, v51
    s_cmp_lg_u32 s100, s101
    s_cbranch_scc1 L_far4
    buffer_store_byte v50, v45, s[32:35], 0 offen
L_bk4:
    s_waitcnt vmcnt(1)
    v_or_b32 v50, 127, v51
    s_cmp_lg_u32 s100, s101
    s_cbranch_scc1 L_far5
    buffer_store_byte v50, v45, s[32:35], 0 offen
L_bk5:
    s_branch L_w2
L_p0x:
    s_waitcnt vmcnt(4)
    v_or_b32 v50, 63, v51
    s_cmp_lg_u32 s100, s101
    s_cbranch_scc1 L_far6
    buffer_store_byte v50, v45, s[32:35], 0 offen
L_bk6:
    s_waitcnt vmcnt(1)
    v_or_b32 v50, 127, v51
    s_cmp_lg_u32 s100, s101
    s_cbranch_scc1 L_far7
    buffer_store_byte v50, v45, s[32:35], 0 offen
L_bk7:
    s_branch L_c0
L_w0:
    s_call_b64 s[58:59], L_sp
L_c0:
    s_bitcmp1_b32 s64, 0
    s_cbranch_scc0 L_w0
    buffer_load_dwordx4 a[0:3], v14, s[28:31], s8 offen sc1
    buffer_load_dwordx4 a[4:7], v15, s[28:31], s8 offen sc1
    buffer_load_dwordx4 a[8:11], v16, s[28:31], s8 offen sc1
    buffer_load_dwordx4 a[12:15], v17, s[28:31], s8 offen sc1
    s_branch L_c1
L_w1:
    s_call_b64 s[58:59], L_sp
L_c1:
    s_bitcmp1_b32 s64, 1
    s_cbranch_scc0 L_w1
    buffer_load_dwordx4 a[16:19], v14, s[28:31], s9 offen sc1
    buffer_load_dwordx4 a[20:23], v15, s[28:31], s9 offen sc1
    buffer_load_dwordx4 a[24:27], v16, s[28:31], s9 offen sc1
    buffer_load_dwordx4 a[28:31], v17, s[28:31], s9 offen sc1
    s_branch L_c2
L_w2:
    s_call_b64 s[58:59], L_sp
L_c2:
    s_bitcmp1_b32 s64, 2
    s_cbranch_scc0 L_w2
    buffer_load_dwordx4 a[32:35], v14, s[28:31], s10 offen sc1
    buffer_load_dwordx4 a[36:39], v15, s[28:31], s10 offen sc1
    buffer_load_dwordx4 a[40:43], v16, s[28:31], s10 offen sc1
    buffer_load_dwordx4 a[44:47], v17, s[28:31], s10 offen sc1
    s_branch L_c3
L_w3:
    s_call_b64 s[58:59], L_sp
L_c3:
    s_bitcmp1_b32 s64, 3
    s_cbranch_scc0 L_w3
    buffer_load_dwordx4 a[48:51], v14, s[28:31], s11 offen sc1
    buffer_load_dwordx4 a[52:55], v15, s[28:31], s11 offen sc1
    buffer_load_dwordx4 a[56:59], v16, s[28:31], s11 offen sc1
    buffer_load_dwordx4 a[60:63], v17, s[28:31], s11 offen sc1
    s_branch L_c4
L_w4:
    s_call_b64 s[58:59], L_sp
L_c4:
    s_bitcmp1_b32 s64, 4
    s_cbranch_scc0 L_w4
    buffer_load_dwordx4 a[64:67], v14, s[28:31], s12 offen sc1
    buffer_load_dwordx4 a[68:71], v15, s[28:31], s12 offen sc1
    buffer_load_dwordx4 a[72:75], v16, s[28:31], s12 offen sc1
    buffer_load_dwordx4 a[76:79], v17, s[28:31], s12 offen sc1
    s_branch L_c5
L_w5:
    s_call_b64 s[58:59], L_sp
L_c5:
    s_bitcmp1_b32 s64, 5
    s_cbranch_scc0 L_w5
    buffer_load_dwordx4 a[80:83], v14, s[28:31], s13 offen sc1
    buffer_load_dwordx4 a[84:87], v15, s[28:31], s13 offen sc1
    buffer_load_dwordx4 a[88:91], v16, s[28:31], s13 offen sc1
    buffer_load_dwordx4 a[92:95], v17, s[28:31], s13 offen sc1
    s_branch L_c6
L_w6:
    s_call_b64 s[58:59], L_sp
L_c6:
    s_bitcmp1_b32 s64, 6
    s_cbranch_scc0 L_w6
    buffer_load_dwordx4 a[96:99], v14, s[28:31], s14 offen sc1
    buffer_load_dwordx4 a[100:103], v15, s[28:31], s14 offen sc1
    buffer_load_dwordx4 a[104:107], v16, s[28:31], s14 offen sc1
    buffer_load_dwordx4 a[108:111], v17, s[28:31], s14 offen sc1
    s_waitcnt vmcnt(24)
    v_mfma_f32_16x16x32_bf16 v[192:195], v[52:55], a[0:3], 0
    v_mfma_f32_16x16x32_bf16 v[192:195], v[52:55], a[4:7], v[192:195]
    v_mfma_f32_16x16x32_bf16 v[192:195], v[52:55], a[8:11], v[192:195]
    v_mfma_f32_16x16x32_bf16 v[192:195], v[52:55], a[12:15], v[192:195]
    s_waitcnt vmcnt(20)
    v_mfma_f32_16x16x32_bf16 v[196:199], v[52:55], a[16:19], 0
    v_mfma_f32_16x16x32_bf16 v[196:199], v[52:55], a[20:23], v[196:199]
    v_mfma_f32_16x16x32_bf16 v[196:199], v[52:55], a[24:27], v[196:199]
    v_mfma_f32_16x16x32_bf16 v[196:199], v[52:55], a[28:31], v[196:199]
    s_nop 2
    v_cvt_pk_bf16_f32 v192, v192, v193
    v_cvt_pk_bf16_f32 v193, v194, v195
    buffer_store_dwordx2 v[192:193], v57, s[40:43], s16 offen
    s_waitcnt vmcnt(17)
    v_mfma_f32_16x16x32_bf16 v[200:203], v[52:55], a[32:35], 0
    v_mfma_f32_16x16x32_bf16 v[200:203], v[52:55], a[36:39], v[200:203]
    v_mfma_f32_16x16x32_bf16 v[200:203], v[52:55], a[40:43], v[200:203]
    v_mfma_f32_16x16x32_bf16 v[200:203], v[52:55], a[44:47], v[200:203]
    v_cvt_pk_bf16_f32 v196, v196, v197
    v_cvt_pk_bf16_f32 v197, v198, v199
    buffer_store_dwordx2 v[196:197], v57, s[40:43], s17 offen
    s_waitcnt vmcnt(14)
    v_mfma_f32_16x16x32_bf16 v[204:207], v[52:55], a[48:51], 0
    v_mfma_f32_16x16x32_bf16 v[204:207], v[52:55], a[52:55], v[204:207]
    v_mfma_f32_16x16x32_bf16 v[204:207], v[52:55], a[56:59], v[204:207]
    v_mfma_f32_16x16x32_bf16 v[204:207], v[52:55], a[60:63], v[204:207]
    v_cvt_pk_bf16_f32 v200, v200, v201
    v_cvt_pk_bf16_f32 v201, v202, v203
    buffer_store_dwordx2 v[200:201], v57, s[40:43], s18 offen
    s_waitcnt vmcnt(11)
    v_mfma_f32_16x16x32_bf16 v[208:211], v[52:55], a[64:67], 0
    v_mfma_f32_16x16x32_bf16 v[208:211], v[52:55], a[68:71], v[208:211]
    v_mfma_f32_16x16x32_bf16 v[208:211], v[52:55], a[72:75], v[208:211]
    v_mfma_f32_16x16x32_bf16 v[208:211], v[52:55], a[76:79], v[208:211]
    v_cvt_pk_bf16_f32 v204, v204, v205
    v_cvt_pk_bf16_f32 v205, v206, v207
    buffer_store_dwordx2 v[204:205], v57, s[40:43], s19 offen
    s_waitcnt vmcnt(8)
    v_mfma_f32_16x16x32_bf16 v[212:215], v[52:55], a[80:83], 0
    v_mfma_f32_16x16x32_bf16 v[212:215], v[52:55], a[84:87], v[212:215]
    v_mfma_f32_16x16x32_bf16 v[212:215], v[52:55], a[88:91], v[212:215]
    v_mfma_f32_16x16x32_bf16 v[212:215], v[52:55], a[92:95], v[212:215]
    v_cvt_pk_bf16_f32 v208, v208, v209
    v_cvt_pk_bf16_f32 v209, v210, v211
    buffer_store_dwordx2 v[208:209], v57, s[40:43], s20 offen
    s_waitcnt vmcnt(5)
    v_mfma_f32_16x16x32_bf16 v[216:219], v[52:55], a[96:99], 0
    v_mfma_f32_16x16x32_bf16 v[216:219], v[52:55], a[100:103], v[216:219]
    v_mfma_f32_16x16x32_bf16 v[216:219], v[52:55], a[104:107], v[216:219]
    v_mfma_f32_16x16x32_bf16 v[216:219], v[52:55], a[108:111], v[216:219]
    v_cvt_pk_bf16_f32 v212, v212, v213
    v_cvt_pk_bf16_f32 v213, v214, v215
    buffer_store_dwordx2 v[212:213], v57, s[40:43], s21 offen
    s_nop 4
    v_cvt_pk_bf16_f32 v216, v216, v217
    v_cvt_pk_bf16_f32 v217, v218, v219
    buffer_store_dwordx2 v[216:217], v57, s[40:43], s22 offen
L_k1_done:
    s_endpgm
L_far0:
    buffer_store_byte v50, v45, s[32:35], 0 offen sc1
    s_branch L_bk0
L_far1:
    buffer_store_byte v50, v45, s[32:35], 0 offen sc1
    s_branch L_bk1
L_far2:
    buffer_store_byte v50, v45, s[32:35], 0 offen sc1
    s_branch L_bk2
L_far3:
    buffer_store_byte v50, v45, s[32:35], 0 offen sc1
    s_branch L_bk3
L_far4:
    buffer_store_byte v50, v45, s[32:35], 0 offen sc1
    s_branch L_bk4
L_far5:
    buffer_store_byte v50, v45, s[32:35], 0 offen sc1
    s_branch L_bk5
L_far6:
    buffer_store_byte v50, v45, s[32:35], 0 offen sc1
    s_branch L_bk6
L_far7:
    buffer_store_byte v50, v45, s[32:35], 0 offen sc1
    s_branch L_bk7
L_sp:
    s_cmp_lt_u32 s78, 524288
    s_cbranch_scc0 L_sp_v
    s_sleep 6
    s_buffer_load_dwordx4 s[64:67], s[32:35], s78
    s_add_u32 s78, s78, 0x10000
    s_waitcnt lgkmcnt(0)
    v_bfe_u32 v14, s64, v18, 1
    v_lshl_add_u32 v14, v14, 13, v56
    v_bfe_u32 v15, s65, v18, 1
    v_lshl_add_u32 v15, v15, 13, v11
    v_bfe_u32 v16, s66, v18, 1
    v_lshl_add_u32 v16, v16, 13, v12
    v_bfe_u32 v17, s67, v18, 1
    v_lshl_add_u32 v17, v17, 13, v13
    s_and_b64 s[64:65], s[64:65], s[66:67]
    s_and_b32 s64, s64, s65
    s_lshr_b32 s3, s64, 16
    s_and_b32 s64, s64, s3
    s_lshr_b32 s3, s64, 8
    s_and_b32 s64, s64, s3
    s_setpc_b64 s[58:59]
L_sp_v:
    buffer_load_dwordx4 v[96:99], v46, s[32:35], 0 offen sc1
    s_waitcnt vmcnt(0)
    v_readfirstlane_b32 s64, v96
    v_readfirstlane_b32 s65, v97
    v_readfirstlane_b32 s66, v98
    v_readfirstlane_b32 s67, v99
    v_bfe_u32 v14, s64, v18, 1
    v_lshl_add_u32 v14, v14, 13, v56
    v_bfe_u32 v15, s65, v18, 1
    v_lshl_add_u32 v15, v15, 13, v11
    v_bfe_u32 v16, s66, v18, 1
    v_lshl_add_u32 v16, v16, 13, v12
    v_bfe_u32 v17, s67, v18, 1
    v_lshl_add_u32 v17, v17, 13, v13
    s_and_b64 s[64:65], s[64:65], s[66:67]
    s_and_b32 s64, s64, s65
    s_lshr_b32 s3, s64, 16
    s_and_b32 s64, s64, s3
    s_lshr_b32 s3, s64, 8
    s_and_b32 s64, s64, s3
    s_sub_u32 s57, s57, 1
    s_cselect_b32 s64, -1, s64
    s_cselect_b32 s57, 0, s57
    s_setpc_b64 s[58:59]
L_poll:
    buffer_load_dwordx4 v[96:99], v46, s[32:35], 0 offen sc1
    s_sub_u32 s57, s57, 1
    s_cbranch_scc1 L_poll_to
    s_waitcnt vmcnt(0)
    v_and_b32 v96, v96, v97
    v_and_b32 v98, v98, v99
    v_and_b32 v96, v96, v98
    s_nop 0
    v_readfirstlane_b32 s64, v96
    s_nop 0
    s_and_b32 s3, s64, s45
    s_cmp_eq_u32 s3, s45
    s_cbranch_scc1 L_poll_ret
    s_sleep 1
    s_branch L_poll
    buffer_load_dword v49, v46, s[32:35], 0 offen sc1
    s_sub_u32 s57, s57, 1
    s_cbranch_scc1 L_poll_to
    s_waitcnt vmcnt(0)
    v_or_b32 v49, v49, v51
    v_cmp_gt_u32 vcc, s45, v49
    s_cbranch_vccz L_poll_ret
    s_sleep 1
    s_branch L_poll
L_poll_to:
    s_mov_b32 s57, 0
    s_waitcnt vmcnt(0)
L_poll_ret:
    s_setpc_b64 s[58:59]
L_chk_wait:
    buffer_load_dword v49, v48, s[36:39], 0 offen sc1
    s_sub_u32 s57, s57, 1
    s_cbranch_scc1 L_poll_to
    s_waitcnt vmcnt(0)
    v_cmp_eq_u32 vcc, 0, v49
    s_cbranch_vccz L_poll_ret
    s_sleep 4
    s_branch L_chk_wait
L_fix0:
    s_nop 7
    v_max3_f32 v39, v64, v65, v66
    v_max3_f32 v39, v39, v67, v68
    v_max3_f32 v39, v39, v69, v70
    v_max_f32 v39, v39, v71
    v_mov_b32 v41, v39
    s_nop 1
    v_permlane32_swap_b32 v39, v41
    s_nop 1
    v_max_f32 v39, v39, v41
    v_mov_b32 v41, v39
    s_nop 1
    v_permlane16_swap_b32 v39, v41
    s_nop 1
    v_max_f32 v39, v39, v41
    v_sub_f32 v64, v64, v39
    v_sub_f32 v80, v80, v39
    v_sub_f32 v65, v65, v39
    v_sub_f32 v81, v81, v39
    v_sub_f32 v66, v66, v39
    v_sub_f32 v82, v82, v39
    v_sub_f32 v67, v67, v39
    v_sub_f32 v83, v83, v39
    v_sub_f32 v68, v68, v39
    v_sub_f32 v84, v84, v39
    v_sub_f32 v69, v69, v39
    v_sub_f32 v85, v85, v39
    v_sub_f32 v70, v70, v39
    v_sub_f32 v86, v86, v39
    v_sub_f32 v71, v71, v39
    v_sub_f32 v87, v87, v39
    v_sub_f32 v112, v112, v39
    v_sub_f32 v113, v113, v39
    v_sub_f32 v114, v114, v39
    v_sub_f32 v115, v115, v39
    v_max3_f32 v40, v72, v73, v74
    v_max3_f32 v40, v40, v75, v76
    v_max3_f32 v40, v40, v77, v78
    v_max_f32 v40, v40, v79
    v_mov_b32 v41, v40
    s_nop 1
    v_permlane32_swap_b32 v40, v41
    s_nop 1
    v_max_f32 v40, v40, v41
    v_mov_b32 v41, v40
    s_nop 1
    v_permlane16_swap_b32 v40, v41
    s_nop 1
    v_max_f32 v40, v40, v41
    v_sub_f32 v72, v72, v40
    v_sub_f32 v88, v88, v40
    v_sub_f32 v73, v73, v40
    v_sub_f32 v89, v89, v40
    v_sub_f32 v74, v74, v40
    v_sub_f32 v90, v90, v40
    v_sub_f32 v75, v75, v40
    v_sub_f32 v91, v91, v40
    v_sub_f32 v76, v76, v40
    v_sub_f32 v92, v92, v40
    v_sub_f32 v77, v77, v40
    v_sub_f32 v93, v93, v40
    v_sub_f32 v78, v78, v40
    v_sub_f32 v94, v94, v40
    v_sub_f32 v79, v79, v40
    v_sub_f32 v95, v95, v40
    v_sub_f32 v116, v116, v40
    v_sub_f32 v117, v117, v40
    v_sub_f32 v118, v118, v40
    v_sub_f32 v119, v119, v40
    v_exp_f32 v96, v64
    v_exp_f32 v97, v65
    v_add_f32 v37, v35, v96
    v_exp_f32 v98, v66
    v_add_f32 v37, v37, v97
    v_cvt_pk_bf16_f32 v120, v96, v97
    v_exp_f32 v99, v67
    v_add_f32 v37, v37, v98
    v_exp_f32 v100, v72
    v_add_f32 v37, v37, v99
    v_cvt_pk_bf16_f32 v121, v98, v99
    v_exp_f32 v101, v73
    v_add_f32 v38, v36, v100
    v_exp_f32 v102, v74
    v_add_f32 v38, v38, v101
    v_cvt_pk_bf16_f32 v124, v100, v101
    v_exp_f32 v103, v75
    v_add_f32 v38, v38, v102
    v_exp_f32 v96, v68
    v_add_f32 v38, v38, v103
    v_cvt_pk_bf16_f32 v125, v102, v103
    v_exp_f32 v97, v69
    v_add_f32 v37, v37, v96
    v_exp_f32 v98, v70
    v_add_f32 v37, v37, v97
    v_cvt_pk_bf16_f32 v122, v96, v97
    v_exp_f32 v99, v71
    v_add_f32 v37, v37, v98
    v_exp_f32 v100, v76
    v_add_f32 v37, v37, v99
    v_cvt_pk_bf16_f32 v123, v98, v99
    v_exp_f32 v101, v77
    v_add_f32 v38, v38, v100
    v_exp_f32 v102, v78
    v_add_f32 v38, v38, v101
    v_cvt_pk_bf16_f32 v126, v100, v101
    v_exp_f32 v103, v79
    v_add_f32 v38, v38, v102
    v_add_f32 v38, v38, v103
    v_cvt_pk_bf16_f32 v127, v102, v103
    s_nop 3
    s_setpc_b64 s[58:59]
L_fixp0:
    s_nop 7
    v_max3_f32 v39, v64, v65, v66
    v_max3_f32 v39, v39, v67, v68
    v_max3_f32 v39, v39, v69, v70
    v_max_f32 v39, v39, v71
    v_mov_b32 v41, v39
    s_nop 1
    v_permlane32_swap_b32 v39, v41
    s_nop 1
    v_max_f32 v39, v39, v41
    v_mov_b32 v41, v39
    s_nop 1
    v_permlane16_swap_b32 v39, v41
    s_nop 1
    v_max_f32 v39, v39, v41
    v_max_f32 v39, 0, v39
    v_exp_f32 v43, -v39
    v_sub_f32 v64, v64, v39
    v_sub_f32 v80, v80, v39
    v_sub_f32 v65, v65, v39
    v_sub_f32 v81, v81, v39
    v_sub_f32 v66, v66, v39
    v_sub_f32 v82, v82, v39
    v_sub_f32 v67, v67, v39
    v_sub_f32 v83, v83, v39
    v_sub_f32 v68, v68, v39
    v_sub_f32 v84, v84, v39
    v_sub_f32 v69, v69, v39
    v_sub_f32 v85, v85, v39
    v_sub_f32 v70, v70, v39
    v_sub_f32 v86, v86, v39
    v_sub_f32 v71, v71, v39
    v_sub_f32 v87, v87, v39
    v_sub_f32 v112, v112, v39
    v_sub_f32 v113, v113, v39
    v_sub_f32 v114, v114, v39
    v_sub_f32 v115, v115, v39
    v_mul_f32 v35, v35, v43
    v_max3_f32 v40, v72, v73, v74
    v_max3_f32 v40, v40, v75, v76
    v_max3_f32 v40, v40, v77, v78
    v_max_f32 v40, v40, v79
    v_mov_b32 v41, v40
    s_nop 1
    v_permlane32_swap_b32 v40, v41
    s_nop 1
    v_max_f32 v40, v40, v41
    v_mov_b32 v41, v40
    s_nop 1
    v_permlane16_swap_b32 v40, v41
    s_nop 1
    v_max_f32 v40, v40, v41
    v_max_f32 v40, 0, v40
    v_exp_f32 v44, -v40
    v_sub_f32 v72, v72, v40
    v_sub_f32 v88, v88, v40
    v_sub_f32 v73, v73, v40
    v_sub_f32 v89, v89, v40
    v_sub_f32 v74, v74, v40
    v_sub_f32 v90, v90, v40
    v_sub_f32 v75, v75, v40
    v_sub_f32 v91, v91, v40
    v_sub_f32 v76, v76, v40
    v_sub_f32 v92, v92, v40
    v_sub_f32 v77, v77, v40
    v_sub_f32 v93, v93, v40
    v_sub_f32 v78, v78, v40
    v_sub_f32 v94, v94, v40
    v_sub_f32 v79, v79, v40
    v_sub_f32 v95, v95, v40
    v_sub_f32 v116, v116, v40
    v_sub_f32 v117, v117, v40
    v_sub_f32 v118, v118, v40
    v_sub_f32 v119, v119, v40
    v_mul_f32 v36, v36, v44
    v_exp_f32 v96, v64
    v_exp_f32 v97, v65
    v_add_f32 v37, v35, v96
    v_exp_f32 v98, v66
    v_add_f32 v37, v37, v97
    v_cvt_pk_bf16_f32 v120, v96, v97
    v_exp_f32 v99, v67
    v_add_f32 v37, v37, v98
    v_exp_f32 v100, v72
    v_add_f32 v37, v37, v99
    v_cvt_pk_bf16_f32 v121, v98, v99
    v_exp_f32 v101, v73
    v_add_f32 v38, v36, v100
    v_exp_f32 v102, v74
    v_add_f32 v38, v38, v101
    v_cvt_pk_bf16_f32 v124, v100, v101
    v_exp_f32 v103, v75
    v_add_f32 v38, v38, v102
    v_exp_f32 v96, v68
    v_add_f32 v38, v38, v103
    v_cvt_pk_bf16_f32 v125, v102, v103
    v_exp_f32 v97, v69
    v_add_f32 v37, v37, v96
    v_exp_f32 v98, v70
    v_add_f32 v37, v37, v97
    v_cvt_pk_bf16_f32 v122, v96, v97
    v_exp_f32 v99, v71
    v_add_f32 v37, v37, v98
    v_exp_f32 v100, v76
    v_add_f32 v37, v37, v99
    v_cvt_pk_bf16_f32 v123, v98, v99
    v_exp_f32 v101, v77
    v_add_f32 v38, v38, v100
    v_exp_f32 v102, v78
    v_add_f32 v38, v38, v101
    v_cvt_pk_bf16_f32 v126, v100, v101
    v_exp_f32 v103, v79
    v_add_f32 v38, v38, v102
    v_add_f32 v38, v38, v103
    v_cvt_pk_bf16_f32 v127, v102, v103
    v_mul_f32 v128, v128, v43
    v_mul_f32 v129, v129, v43
    v_mul_f32 v130, v130, v43
    v_mul_f32 v131, v131, v43
    v_mul_f32 v132, v132, v43
    v_mul_f32 v133, v133, v43
    v_mul_f32 v134, v134, v43
    v_mul_f32 v135, v135, v43
    v_mul_f32 v136, v136, v44
    v_mul_f32 v137, v137, v44
    v_mul_f32 v138, v138, v44
    v_mul_f32 v139, v139, v44
    v_mul_f32 v140, v140, v44
    v_mul_f32 v141, v141, v44
    v_mul_f32 v142, v142, v44
    v_mul_f32 v143, v143, v44
    v_mul_f32 v144, v144, v43
    v_mul_f32 v145, v145, v43
    v_mul_f32 v146, v146, v43
    v_mul_f32 v147, v147, v43
    v_mul_f32 v148, v148, v43
    v_mul_f32 v149, v149, v43
    v_mul_f32 v150, v150, v43
    v_mul_f32 v151, v151, v43
    v_mul_f32 v152, v152, v44
    v_mul_f32 v153, v153, v44
    v_mul_f32 v154, v154, v44
    v_mul_f32 v155, v155, v44
    v_mul_f32 v156, v156, v44
    v_mul_f32 v157, v157, v44
    v_mul_f32 v158, v158, v44
    v_mul_f32 v159, v159, v44
    v_mul_f32 v160, v160, v43
    v_mul_f32 v161, v161, v43
    v_mul_f32 v162, v162, v43
    v_mul_f32 v163, v163, v43
    v_mul_f32 v164, v164, v43
    v_mul_f32 v165, v165, v43
    v_mul_f32 v166, v166, v43
    v_mul_f32 v167, v167, v43
    v_mul_f32 v168, v168, v44
    v_mul_f32 v169, v169, v44
    v_mul_f32 v170, v170, v44
    v_mul_f32 v171, v171, v44
    v_mul_f32 v172, v172, v44
    v_mul_f32 v173, v173, v44
    v_mul_f32 v174, v174, v44
    v_mul_f32 v175, v175, v44
    v_mul_f32 v176, v176, v43
    v_mul_f32 v177, v177, v43
    v_mul_f32 v178, v178, v43
    v_mul_f32 v179, v179, v43
    v_mul_f32 v180, v180, v43
    v_mul_f32 v181, v181, v43
    v_mul_f32 v182, v182, v43
    v_mul_f32 v183, v183, v43
    v_mul_f32 v184, v184, v44
    v_mul_f32 v185, v185, v44
    v_mul_f32 v186, v186, v44
    v_mul_f32 v187, v187, v44
    v_mul_f32 v188, v188, v44
    v_mul_f32 v189, v189, v44
    v_mul_f32 v190, v190, v44
    v_mul_f32 v191, v191, v44
    v_mul_f32 v192, v192, v43
    v_mul_f32 v193, v193, v43
    v_mul_f32 v194, v194, v43
    v_mul_f32 v195, v195, v43
    v_mul_f32 v196, v196, v43
    v_mul_f32 v197, v197, v43
    v_mul_f32 v198, v198, v43
    v_mul_f32 v199, v199, v43
    v_mul_f32 v200, v200, v44
    v_mul_f32 v201, v201, v44
    v_mul_f32 v202, v202, v44
    v_mul_f32 v203, v203, v44
    v_mul_f32 v204, v204, v44
    v_mul_f32 v205, v205, v44
    v_mul_f32 v206, v206, v44
    v_mul_f32 v207, v207, v44
    v_mul_f32 v208, v208, v43
    v_mul_f32 v209, v209, v43
    v_mul_f32 v210, v210, v43
    v_mul_f32 v211, v211, v43
    v_mul_f32 v212, v212, v43
    v_mul_f32 v213, v213, v43
    v_mul_f32 v214, v214, v43
    v_mul_f32 v215, v215, v43
    v_mul_f32 v216, v216, v44
    v_mul_f32 v217, v217, v44
    v_mul_f32 v218, v218, v44
    v_mul_f32 v219, v219, v44
    v_mul_f32 v220, v220, v44
    v_mul_f32 v221, v221, v44
    v_mul_f32 v222, v222, v44
    v_mul_f32 v223, v223, v44
    v_mul_f32 v224, v224, v43
    v_mul_f32 v225, v225, v43
    v_mul_f32 v226, v226, v43
    v_mul_f32 v227, v227, v43
    v_mul_f32 v228, v228, v43
    v_mul_f32 v229, v229, v43
    v_mul_f32 v230, v230, v43
    v_mul_f32 v231, v231, v43
    v_mul_f32 v232, v232, v44
    v_mul_f32 v233, v233, v44
    v_mul_f32 v234, v234, v44
    v_mul_f32 v235, v235, v44
    v_mul_f32 v236, v236, v44
    v_mul_f32 v237, v237, v44
    v_mul_f32 v238, v238, v44
    v_mul_f32 v239, v239, v44
    v_mul_f32 v240, v240, v43
    v_mul_f32 v241, v241, v43
    v_mul_f32 v242, v242, v43
    v_mul_f32 v243, v243, v43
    v_mul_f32 v244, v244, v43
    v_mul_f32 v245, v245, v43
    v_mul_f32 v246, v246, v43
    v_mul_f32 v247, v247, v43
    v_mul_f32 v248, v248, v44
    v_mul_f32 v249, v249, v44
    v_mul_f32 v250, v250, v44
    v_mul_f32 v251, v251, v44
    v_mul_f32 v252, v252, v44
    v_mul_f32 v253, v253, v44
    v_mul_f32 v254, v254, v44
    v_mul_f32 v255, v255, v44
    s_nop 3
    s_setpc_b64 s[58:59]
L_fixp1:
    s_nop 7
    v_max3_f32 v39, v80, v81, v82
    v_max3_f32 v39, v39, v83, v84
    v_max3_f32 v39, v39, v85, v86
    v_max_f32 v39, v39, v87
    v_mov_b32 v41, v39
    s_nop 1
    v_permlane32_swap_b32 v39, v41
    s_nop 1
    v_max_f32 v39, v39, v41
    v_mov_b32 v41, v39
    s_nop 1
    v_permlane16_swap_b32 v39, v41
    s_nop 1
    v_max_f32 v39, v39, v41
    v_max_f32 v39, 0, v39
    v_exp_f32 v43, -v39
    v_sub_f32 v80, v80, v39
    v_sub_f32 v64, v64, v39
    v_sub_f32 v81, v81, v39
    v_sub_f32 v65, v65, v39
    v_sub_f32 v82, v82, v39
    v_sub_f32 v66, v66, v39
    v_sub_f32 v83, v83, v39
    v_sub_f32 v67, v67, v39
    v_sub_f32 v84, v84, v39
    v_sub_f32 v68, v68, v39
    v_sub_f32 v85, v85, v39
    v_sub_f32 v69, v69, v39
    v_sub_f32 v86, v86, v39
    v_sub_f32 v70, v70, v39
    v_sub_f32 v87, v87, v39
    v_sub_f32 v71, v71, v39
    v_sub_f32 v112, v112, v39
    v_sub_f32 v113, v113, v39
    v_sub_f32 v114, v114, v39
    v_sub_f32 v115, v115, v39
    v_mul_f32 v37, v37, v43
    v_max3_f32 v40, v88, v89, v90
    v_max3_f32 v40, v40, v91, v92
    v_max3_f32 v40, v40, v93, v94
    v_max_f32 v40, v40, v95
    v_mov_b32 v41, v40
    s_nop 1
    v_permlane32_swap_b32 v40, v41
    s_nop 1
    v_max_f32 v40, v40, v41
    v_mov_b32 v41, v40
    s_nop 1
    v_permlane16_swap_b32 v40, v41
    s_nop 1
    v_max_f32 v40, v40, v41
    v_max_f32 v40, 0, v40
    v_exp_f32 v44, -v40
    v_sub_f32 v88, v88, v40
    v_sub_f32 v72, v72, v40
    v_sub_f32 v89, v89, v40
    v_sub_f32 v73, v73, v40
    v_sub_f32 v90, v90, v40
    v_sub_f32 v74, v74, v40
    v_sub_f32 v91, v91, v40
    v_sub_f32 v75, v75, v40
    v_sub_f32 v92, v92, v40
    v_sub_f32 v76, v76, v40
    v_sub_f32 v93, v93, v40
    v_sub_f32 v77, v77, v40
    v_sub_f32 v94, v94, v40
    v_sub_f32 v78, v78, v40
    v_sub_f32 v95, v95, v40
    v_sub_f32 v79, v79, v40
    v_sub_f32 v116, v116, v40
    v_sub_f32 v117, v117, v40
    v_sub_f32 v118, v118, v40
    v_sub_f32 v119, v119, v40
    v_mul_f32 v38, v38, v44
    v_exp_f32 v96, v80
    v_exp_f32 v97, v81
    v_add_f32 v35, v37, v96
    v_exp_f32 v98, v82
    v_add_f32 v35, v35, v97
    v_cvt_pk_bf16_f32 v104, v96, v97
    v_exp_f32 v99, v83
    v_add_f32 v35, v35, v98
    v_exp_f32 v100, v88
    v_add_f32 v35, v35, v99
    v_cvt_pk_bf16_f32 v105, v98, v99
    v_exp_f32 v101, v89
    v_add_f32 v36, v38, v100
    v_exp_f32 v102, v90
    v_add_f32 v36, v36, v101
    v_cvt_pk_bf16_f32 v108, v100, v101
    v_exp_f32 v103, v91
    v_add_f32 v36, v36, v102
    v_exp_f32 v96, v84
    v_add_f32 v36, v36, v103
    v_cvt_pk_bf16_f32 v109, v102, v103
    v_exp_f32 v97, v85
    v_add_f32 v35, v35, v96
    v_exp_f32 v98, v86
    v_add_f32 v35, v35, v97
    v_cvt_pk_bf16_f32 v106, v96, v97
    v_exp_f32 v99, v87
    v_add_f32 v35, v35, v98
    v_exp_f32 v100, v92
    v_add_f32 v35, v35, v99
    v_cvt_pk_bf16_f32 v107, v98, v99
    v_exp_f32 v101, v93
    v_add_f32 v36, v36, v100
    v_exp_f32 v102, v94
    v_add_f32 v36, v36, v101
    v_cvt_pk_bf16_f32 v110, v100, v101
    v_exp_f32 v103, v95
    v_add_f32 v36, v36, v102
    v_add_f32 v36, v36, v103
    v_cvt_pk_bf16_f32 v111, v102, v103
    v_mul_f32 v128, v128, v43
    v_mul_f32 v129, v129, v43
    v_mul_f32 v130, v130, v43
    v_mul_f32 v131, v131, v43
    v_mul_f32 v132, v132, v43
    v_mul_f32 v133, v133, v43
    v_mul_f32 v134, v134, v43
    v_mul_f32 v135, v135, v43
    v_mul_f32 v136, v136, v44
    v_mul_f32 v137, v137, v44
    v_mul_f32 v138, v138, v44
    v_mul_f32 v139, v139, v44
    v_mul_f32 v140, v140, v44
    v_mul_f32 v141, v141, v44
    v_mul_f32 v142, v142, v44
    v_mul_f32 v143, v143, v44
    v_mul_f32 v144, v144, v43
    v_mul_f32 v145, v145, v43
    v_mul_f32 v146, v146, v43
    v_mul_f32 v147, v147, v43
    v_mul_f32 v148, v148, v43
    v_mul_f32 v149, v149, v43
    v_mul_f32 v150, v150, v43
    v_mul_f32 v151, v151, v43
    v_mul_f32 v152, v152, v44
    v_mul_f32 v153, v153, v44
    v_mul_f32 v154, v154, v44
    v_mul_f32 v155, v155, v44
    v_mul_f32 v156, v156, v44
    v_mul_f32 v157, v157, v44
    v_mul_f32 v158, v158, v44
    v_mul_f32 v159, v159, v44
    v_mul_f32 v160, v160, v43
    v_mul_f32 v161, v161, v43
    v_mul_f32 v162, v162, v43
    v_mul_f32 v163, v163, v43
    v_mul_f32 v164, v164, v43
    v_mul_f32 v165, v165, v43
    v_mul_f32 v166, v166, v43
    v_mul_f32 v167, v167, v43
    v_mul_f32 v168, v168, v44
    v_mul_f32 v169, v169, v44
    v_mul_f32 v170, v170, v44
    v_mul_f32 v171, v171, v44
    v_mul_f32 v172, v172, v44
    v_mul_f32 v173, v173, v44
    v_mul_f32 v174, v174, v44
    v_mul_f32 v175, v175, v44
    v_mul_f32 v176, v176, v43
    v_mul_f32 v177, v177, v43
    v_mul_f32 v178, v178, v43
    v_mul_f32 v179, v179, v43
    v_mul_f32 v180, v180, v43
    v_mul_f32 v181, v181, v43
    v_mul_f32 v182, v182, v43
    v_mul_f32 v183, v183, v43
    v_mul_f32 v184, v184, v44
    v_mul_f32 v185, v185, v44
    v_mul_f32 v186, v186, v44
    v_mul_f32 v187, v187, v44
    v_mul_f32 v188, v188, v44
    v_mul_f32 v189, v189, v44
    v_mul_f32 v190, v190, v44
    v_mul_f32 v191, v191, v44
    v_mul_f32 v192, v192, v43
    v_mul_f32 v193, v193, v43
    v_mul_f32 v194, v194, v43
    v_mul_f32 v195, v195, v43
    v_mul_f32 v196, v196, v43
    v_mul_f32 v197, v197, v43
    v_mul_f32 v198, v198, v43
    v_mul_f32 v199, v199, v43
    v_mul_f32 v200, v200, v44
    v_mul_f32 v201, v201, v44
    v_mul_f32 v202, v202, v44
    v_mul_f32 v203, v203, v44
    v_mul_f32 v204, v204, v44
    v_mul_f32 v205, v205, v44
    v_mul_f32 v206, v206, v44
    v_mul_f32 v207, v207, v44
    v_mul_f32 v208, v208, v43
    v_mul_f32 v209, v209, v43
    v_mul_f32 v210, v210, v43
    v_mul_f32 v211, v211, v43
    v_mul_f32 v212, v212, v43
    v_mul_f32 v213, v213, v43
    v_mul_f32 v214, v214, v43
    v_mul_f32 v215, v215, v43
    v_mul_f32 v216, v216, v44
    v_mul_f32 v217, v217, v44
    v_mul_f32 v218, v218, v44
    v_mul_f32 v219, v219, v44
    v_mul_f32 v220, v220, v44
    v_mul_f32 v221, v221, v44
    v_mul_f32 v222, v222, v44
    v_mul_f32 v223, v223, v44
    v_mul_f32 v224, v224, v43
    v_mul_f32 v225, v225, v43
    v_mul_f32 v226, v226, v43
    v_mul_f32 v227, v227, v43
    v_mul_f32 v228, v228, v43
    v_mul_f32 v229, v229, v43
    v_mul_f32 v230, v230, v43
    v_mul_f32 v231, v231, v43
    v_mul_f32 v232, v232, v44
    v_mul_f32 v233, v233, v44
    v_mul_f32 v234, v234, v44
    v_mul_f32 v235, v235, v44
    v_mul_f32 v236, v236, v44
    v_mul_f32 v237, v237, v44
    v_mul_f32 v238, v238, v44
    v_mul_f32 v239, v239, v44
    v_mul_f32 v240, v240, v43
    v_mul_f32 v241, v241, v43
    v_mul_f32 v242, v242, v43
    v_mul_f32 v243, v243, v43
    v_mul_f32 v244, v244, v43
    v_mul_f32 v245, v245, v43
    v_mul_f32 v246, v246, v43
    v_mul_f32 v247, v247, v43
    v_mul_f32 v248, v248, v44
    v_mul_f32 v249, v249, v44
    v_mul_f32 v250, v250, v44
    v_mul_f32 v251, v251, v44
    v_mul_f32 v252, v252, v44
    v_mul_f32 v253, v253, v44
    v_mul_f32 v254, v254, v44
    v_mul_f32 v255, v255, v44
    s_nop 3
    s_setpc_b64 s[58:59]
L_k1_end:
.section .rodata,"a"
.p2align 6
.amdhsa_kernel concat_heads__mha_block_cached__gqa_block_cached__near_ridge_kernel
  .amdhsa_next_free_vgpr 512
  .amdhsa_next_free_sgpr 102
  .amdhsa_accum_offset 256
  .amdhsa_group_segment_fixed_size 0
  .amdhsa_kernarg_size 104
  .amdhsa_user_sgpr_count 2
  .amdhsa_user_sgpr_kernarg_segment_ptr 1
  .amdhsa_system_sgpr_workgroup_id_x 1
.end_amdhsa_kernel
```
